```python
import torch

def _softmax(x, axis=-1):
    return torch.softmax(x, dim=axis)
def _gelu(x):
    return torch.nn.functional.gelu(x, approximate="tanh")
def _silu(x):
    return torch.nn.functional.silu(x)
def _sigmoid(x):
    return torch.sigmoid(x)
def _layernorm(x, axis=-1, eps=1e-5):
    m = x.mean(dim=axis, keepdim=True)
    v = x.var(dim=axis, keepdim=True, unbiased=False)
    return (x - m) / torch.sqrt(v + eps)
def _scatter_add(tgt, idx, src, axis=0):
    return tgt.clone().index_add_(axis, idx, src)
def _segment_sum(src, seg, n):
    out = torch.zeros((n,) + src.shape[1:], dtype=src.dtype)
    return out.index_add_(0, seg, src)
def _pad(x, pw):
    flat = tuple(v for pair in reversed(pw) for v in pair)
    return torch.nn.functional.pad(x, flat)

kernel_name = 'interleave_layers__linear_attn_block__glu_gated_glu__prompt'

def setup_inputs():

    _w = (lambda a: (lambda t: t.to(torch.bfloat16) if t.is_floating_point() else t)(torch.as_tensor(a)))
    def _A_setup():
        B, S, D = 1, 2048, 512
        return {
            "x": _w((lambda *s: torch.randn(*s, dtype=torch.bfloat16) * 0.05)(B, S, D)),
            "wqkv": _w((lambda *s: torch.randn(*s, dtype=torch.bfloat16) * 0.05)(D, 3 * D)),
            "wo": _w((lambda *s: torch.randn(*s, dtype=torch.bfloat16) * 0.05)(D, D)),
        }
    _A_in = _A_setup()

    def _B_setup():
        B, S, D, F = 1, 2048, 512, 1792
        return {
            "x": _w((lambda *s: torch.randn(*s, dtype=torch.bfloat16) * 0.05)(B, S, D)),
            "w_gate": _w((lambda *s: torch.randn(*s, dtype=torch.bfloat16) * 0.05)(D, F)),
            "w_up": _w((lambda *s: torch.randn(*s, dtype=torch.bfloat16) * 0.05)(D, F)),
            "w_down": _w((lambda *s: torch.randn(*s, dtype=torch.bfloat16) * 0.05)(F, D)),
        }
    _B_in = _B_setup()

    return {
        "A_x": _A_in["x"],
        "A_wqkv": _A_in["wqkv"],
        "A_wo": _A_in["wo"],
        "B_x": _B_in["x"],
        "B_w_gate": _B_in["w_gate"],
        "B_w_up": _B_in["w_up"],
        "B_w_down": _B_in["w_down"],
    }

def reference(A_x, A_wqkv, A_wo, B_x, B_w_gate, B_w_up, B_w_down):
    def _A_ref(x, wqkv, wo):
        B, S, D = x.shape
        H = 32; Dh = D // H
        qkv = (lambda x, *d: x.permute(*d))((x @ wqkv).reshape(B, S, 3, H, Dh), 2, 0, 3, 1, 4)
        q, k, v = qkv[0], qkv[1], qkv[2]
        phi = lambda t: torch.where(t > 0, t + 1, torch.exp(t)) + 1e-6
        pq, pk = phi(q), phi(k)
        kv = torch.einsum("bhsd,bhse->bhde", pk, v)
        z = torch.einsum("bhsd->bhd", pk)
        num = torch.einsum("bhqd,bhde->bhqe", pq, kv)
        den = torch.einsum("bhqd,bhd->bhq", pq, z)[..., None] + 1e-6
        o = num / den
        return (lambda x, *d: x.permute(*d))(o, 0, 2, 1, 3).reshape(B, S, D) @ wo

    def _B_ref(x, w_gate, w_up, w_down):
        g = torch.einsum("bsd,df->bsf", x, w_gate)
        u = torch.einsum("bsd,df->bsf", x, w_up)
        h = _sigmoid(g) * u
        return torch.einsum("bsf,fd->bsd", h, w_down)

    x = A_x
    x = x + _A_ref(_layernorm(x, axis=-1), A_wqkv, A_wo)
    x = x + _B_ref(_layernorm(x, axis=-1), B_w_gate, B_w_up, B_w_down)
    x = x + _A_ref(_layernorm(x, axis=-1), A_wqkv, A_wo)
    x = x + _B_ref(_layernorm(x, axis=-1), B_w_gate, B_w_up, B_w_down)
    return x
```

```asm
; @launch grid=(256,1,1) block=(256,1,1) lds=163840
.amdgcn_target "amdgcn-amd-amdhsa--gfx950"
.text
.globl interleave_layers__linear_attn_block__glu_gated_glu__prompt_kernel
.type interleave_layers__linear_attn_block__glu_gated_glu__prompt_kernel,@function
  .p2align 8
interleave_layers__linear_attn_block__glu_gated_glu__prompt_kernel:
  s_cmp_ge_u32 s2, 256
  s_cbranch_scc1 L_end
  s_getpc_b64 s[18:19]
  s_lshr_b32 s16, s2, 3
  s_lshl_b32 s16, s16, 10
  v_and_b32 v17, 7, v0
  v_lshl_add_u32 v17, v17, 7, s16
  global_load_dword v237, v17, s[18:19]
  s_load_dwordx2 s[72:73], s[0:1], 8
  s_load_dwordx2 s[68:69], s[0:1], 0
  v_lshrrev_b32 v1, 6, v0
  v_and_b32 v0, 63, v0
  v_readfirstlane_b32 s20, v1
  v_lshrrev_b32 v17, 2, v0
  v_and_b32 v18, 3, v0
  v_lshlrev_b32 v18, 4, v18
  v_mul_u32_u24 v160, 3072, v17
  v_add_u32 v160, v160, v18
  s_and_b32 s32, s2, 7
  s_bfe_u32 s22, s2, 0x40003
  s_mov_b32 s74, 1572864
  s_mov_b32 s75, 0x20000
  s_mul_i32 s36, s20, 3072
  s_lshl_b32 s34, s36, 4
  s_lshl_b32 s16, s22, 6
  s_add_u32 s34, s34, s16
  s_mul_i32 s98, s32, 196608
  s_add_u32 s98, s98, s34
  s_mov_b32 m0, s36
  s_waitcnt lgkmcnt(0)
  buffer_load_dwordx4 v160, s[72:75], s98 offen offset:1024 lds
  buffer_load_dwordx4 v160, s[72:75], s98 offen offset:0 lds
  buffer_load_dwordx4 v160, s[72:75], s98 offen offset:2048 lds
  s_load_dwordx2 s[8:9], s[0:1], 72
  s_load_dwordx4 s[60:63], s[0:1], 56
  s_lshl_b32 s16, s32, 1
  s_lshr_b32 s17, s2, 7
  s_add_u32 s21, s16, s17
  s_lshl_b32 s23, s21, 2
  s_add_u32 s23, s23, s20
  s_lshl_b32 s35, s23, 15
  s_lshl_b32 s42, s36, 2
  s_add_u32 s42, s42, 98304
  s_mov_b32 m0, s42
  s_mov_b32 s70, 2097152
  s_mov_b32 s71, 0x20000
  s_lshl_b32 s99, s32, 7
  s_add_u32 s99, s99, s35
  v_lshrrev_b32 v19, 3, v0
  v_lshlrev_b32 v19, 10, v19
  v_lshrrev_b32 v20, 4, v0
  v_and_b32 v21, 7, v0
  v_xor_b32 v20, v20, v21
  v_lshl_add_u32 v163, v20, 4, v19
  buffer_load_dwordx4 v163, s[68:71], s99 offen lds
  v_xor_b32 v164, 64, v163
  v_add_u32 v165, 14336, v163
  v_add_u32 v166, 21504, v164
  v_add_u32 v164, 7168, v164
  buffer_load_dwordx4 v165, s[68:71], s99 offen offset:2048 lds
  buffer_load_dwordx4 v166, s[68:71], s99 offen offset:3072 lds
  buffer_load_dwordx4 v164, s[68:71], s99 offen offset:1024 lds
  s_load_dwordx2 s[76:77], s[0:1], 16
  s_load_dwordx2 s[80:81], s[0:1], 32
  s_load_dwordx2 s[84:85], s[0:1], 40
  s_load_dwordx2 s[88:89], s[0:1], 48
  v_lshlrev_b32 v1, 4, v0
  s_getreg_b32 s27, hwreg(HW_REG_XCC_ID, 0, 4)
  s_mov_b32 s10, 268435456
  s_mov_b32 s11, 0x20000
  v_and_b32 v2, 31, v0
  v_lshrrev_b32 v3, 5, v0
  v_mul_u32_u24 v161, 3584, v17
  v_add_u32 v161, v161, v18
  v_lshl_add_u32 v162, v17, 10, v18
  s_add_u32 s32, s32, 1
  s_and_b32 s32, s32, 7
  s_waitcnt lgkmcnt(0)
  s_cmp_lg_u32 s2, 0
  s_cbranch_scc1 L_noclr0
  v_mov_b32 v24, 0
  v_mov_b32 v25, 0
  v_mov_b32 v26, 0
  v_mov_b32 v27, 0
  s_mul_i32 s16, s20, 5120
  s_add_u32 s16, s16, 37388288
  buffer_store_dwordx4 v[24:27], v1, s[8:11], s16 offen sc1
  buffer_store_dwordx4 v[24:27], v1, s[8:11], s16 offen offset:1024 sc1
  buffer_store_dwordx4 v[24:27], v1, s[8:11], s16 offen offset:2048 sc1
  buffer_store_dwordx4 v[24:27], v1, s[8:11], s16 offen offset:3072 sc1
  s_add_u32 s16, s16, 4096
  buffer_store_dwordx4 v[24:27], v1, s[8:11], s16 offen sc1
L_noclr0:
  s_lshl_b32 s24, s21, 1
  s_and_b32 s16, s22, 1
  s_add_u32 s24, s24, s16
  s_lshr_b32 s25, s22, 1
  s_lshr_b32 s16, s20, 1
  s_and_b32 s17, s20, 1
  s_lshl_b32 s18, s24, 1
  s_add_u32 s18, s18, s16
  s_lshl_b32 s19, s25, 1
  s_add_u32 s19, s19, s17
  s_lshl_b32 s28, s18, 4
  s_add_u32 s28, s28, s19
  s_lshl_b32 s29, s28, 8
  s_lshl_b32 s28, s28, 11
  s_lshl_b32 s30, s18, 7
  s_lshl_b32 s56, s19, 2
  s_add_u32 s30, s30, s56
  s_add_u32 s30, s30, 37388288
  s_lshl_b32 s57, s18, 15
  s_lshl_b32 s56, s19, 6
  s_add_u32 s57, s57, s56
  s_lshl_b32 s31, s20, 12
  s_lshl_b32 s16, s16, 10
  s_lshl_b32 s17, s17, 10
  v_add_u32 v8, s16, v1
  v_xor_b32 v9, 0x400, v8
  v_add_u32 v10, s17, v1
  v_xor_b32 v11, 0x400, v10
  v_lshlrev_b32 v12, 3, v2
  v_lshl_add_u32 v4, v3, 11, v12
  v_add_u32 v5, 0x10000, v1
  v_add_u32 v6, 0x20000, v1
  v_mov_b32 v13, 0
  s_mov_b32 s26, 0
  v_lshlrev_b32 v175, 10, v2
  v_lshl_add_u32 v175, v3, 4, v175
  s_mov_b32 s78, 524288
  s_mov_b32 s79, 0x20000
  s_mov_b32 s82, 1835008
  s_mov_b32 s83, 0x20000
  s_mov_b32 s86, 1835008
  s_mov_b32 s87, 0x20000
  s_mov_b32 s90, 1835008
  s_mov_b32 s91, 0x20000
  s_mov_b32 s14, 256
  s_mov_b32 s15, 0x20000
  s_lshl_b32 s16, s24, 14
  s_lshl_b32 s17, s25, 7
  s_add_u32 s16, s16, s17
  s_and_b32 s18, s20, 1
  s_lshl_b32 s18, s18, 6
  s_add_u32 s58, s16, s18
  s_lshl_b32 s43, s20, 11
  s_add_u32 s43, s43, 150528
  s_mov_b64 s[12:13], s[62:63]
  buffer_load_dwordx4 v[80:83], v175, s[68:71], s57 offen
  buffer_load_dwordx4 v[84:87], v175, s[68:71], s57 offen offset:32
  buffer_load_dwordx4 v[204:207], v162, s[76:79], s58 offen
  v_bfe_u32 v17, v2, 1, 3
  v_xor_b32 v17, v17, v3
  v_lshlrev_b32 v17, 4, v17
  v_lshl_add_u32 v17, v2, 7, v17
  v_add_u32 v167, s42, v17
  v_xor_b32 v168, 32, v167
  v_xor_b32 v169, 64, v167
  v_xor_b32 v170, 0x60, v167
  v_bfe_u32 v17, v0, 2, 2
  v_lshlrev_b32 v17, 6, v17
  v_and_b32 v18, 3, v0
  v_lshl_add_u32 v17, v18, 3, v17
  v_bfe_u32 v18, v0, 4, 1
  v_lshl_add_u32 v19, v18, 5, v17
  v_lshl_add_u32 v171, v3, 9, v19
  v_add_u32 v227, 0x10000, v171
  v_lshl_add_u32 v172, v3, 8, v19
  v_lshl_add_u32 v173, v18, 10, v17
  v_lshl_add_u32 v173, v3, 8, v173
  v_add_u32 v173, s43, v173
  v_add_u32 v230, s43, v1
  s_min_u32 s44, s20, 2
  s_and_b32 s16, s21, 1
  s_mul_i32 s16, s16, 6
  s_add_u32 s16, s16, s44
  s_lshl_b32 s16, s16, 10
  v_add_u32 v228, s16, v172
  v_add_u32 v229, s43, v172
  s_mov_b32 s59, 0x3f803f80
  v_lshlrev_b32 v174, 2, v2
  s_lshl_b32 s16, s22, 8
  s_add_u32 s33, s16, 37404672
  s_lshl_b32 s45, s21, 9
  s_add_u32 s45, s45, 37388288
  v_lshlrev_b32 v231, 5, v0
  v_and_b32 v231, 0x180, v231
  v_lshrrev_b32 v17, 2, v0
  v_and_b32 v17, 12, v17
  v_and_b32 v18, 3, v0
  v_add_u32 v17, v17, v18
  v_lshl_add_u32 v231, v17, 2, v231
  v_and_b32 v232, 3, v0
  v_lshlrev_b32 v232, 2, v232
  v_bfe_u32 v7, v0, 4, 1
  v_lshlrev_b32 v137, 4, v7
  v_bfe_u32 v7, v0, 2, 1
  v_lshl_add_u32 v137, v7, 3, v137
  v_bfe_u32 v7, v0, 3, 1
  v_lshl_add_u32 v137, v7, 2, v137
  v_and_b32 v7, 3, v0
  v_add_u32 v137, v137, v7
  s_mul_i32 s16, s20, 2176
  s_add_u32 s16, s16, 98304
  v_lshl_add_u32 v137, v137, 2, s16
  v_lshl_add_u32 v136, v2, 6, s16
  v_lshl_add_u32 v136, v3, 5, v136
  s_lshl_b32 s16, s20, 9
  v_lshl_add_u32 v138, v0, 3, s16
  v_add_u32 v139, 98304, v138
  s_lshl_b32 s16, s20, 5
  s_add_u32 s16, s16, 2048
  v_and_b32 v7, 7, v0
  v_lshl_add_u32 v142, v7, 2, s16
  v_add_u32 v143, 98304, v142
  s_mul_i32 s39, s26, 557056
  s_mul_i32 s16, s22, 34816
  s_add_u32 s39, s39, s16
  s_add_u32 s39, s39, 35913728
  s_mul_i32 s16, s21, 2176
  s_add_u32 s37, s39, s16
  v_and_b32 v7, 16, v0
  v_cmp_eq_u32 s[64:65], 0, v7
  v_mov_b32 v176, s59
  v_mov_b32 v177, s59
  v_mov_b32 v178, s59
  v_mov_b32 v179, s59
  v_mov_b32 v210, -1
  v_mov_b32 v211, -1
  v_lshlrev_b32 v209, 3, v0
  s_lshl_b32 s67, s22, 4
  s_add_u32 s67, s67, s21
  s_mul_i32 s16, s67, 2176
  s_add_u32 s16, s16, 35913728
  s_and_b32 s17, s20, 1
  s_mul_i32 s17, s17, 557056
  s_add_u32 s5, s16, s17
  s_lshl_b32 s17, s20, 9
  s_add_u32 s3, s16, s17
  s_add_u32 s4, s3, 557056
  s_lshl_b32 s16, s21, 2
  s_add_u32 s16, s16, s44
  s_sub_u32 s16, s16, 1
  s_lshl_b32 s17, s21, 1
  s_add_u32 s17, s17, 64
  s_cmp_eq_u32 s44, 0
  s_cselect_b32 s16, s17, s16
  s_cselect_b32 s7, 1, 2
  s_lshl_b32 s7, s7, 10
  s_mul_i32 s17, s22, 96
  s_add_u32 s16, s16, s17
  s_lshl_b32 s16, s16, 10
  s_add_u32 s6, s16, 0
  s_add_u32 s7, s7, s6
  s_lshl_b32 s16, s25, 5
  s_add_u32 s16, s16, s24
  s_lshl_b32 s16, s16, 1
  s_and_b32 s17, s20, 1
  s_add_u32 s16, s16, s17
  s_lshl_b32 s16, s16, 10
  s_add_u32 s48, s16, 1572864
  s_mul_i32 s17, s67, 384
  s_lshl_b32 s16, s44, 7
  s_add_u32 s17, s17, s16
  s_add_u32 s49, s17, 37027840
  s_mul_i32 s46, s22, 6144
  s_add_u32 s46, s46, s16
  s_add_u32 s46, s46, 37027840
  s_add_u32 s17, s44, 2
  s_cmp_ge_u32 s17, 3
  s_cselect_b32 s16, 3, 0
  s_sub_u32 s17, s17, s16
  s_lshl_b32 s17, s17, 10
  s_add_u32 s47, s17, 147456
  s_mul_i32 s17, s21, 114688
  s_mul_i32 s16, s22, 224
  s_add_u32 s17, s17, s16
  s_lshl_b32 s16, s20, 6
  s_add_u32 s50, s17, s16
  s_and_b32 s17, s22, 1
  s_lshl_b32 s17, s17, 2
  s_add_u32 s17, s17, s20
  s_min_u32 s66, s17, 6
  s_mul_i32 s17, s21, 7
  s_add_u32 s17, s17, s66
  s_lshl_b32 s17, s17, 14
  s_lshl_b32 s16, s25, 7
  s_add_u32 s51, s17, s16
  s_lshl_b32 s17, s67, 10
  s_lshl_b32 s16, s20, 8
  s_add_u32 s17, s17, s16
  s_add_u32 s52, s17, 37126144
  s_mul_i32 s16, s25, 112
  s_lshr_b32 s17, s21, 2
  s_mul_i32 s17, s17, 28
  s_add_u32 s16, s16, s17
  s_lshl_b32 s17, s66, 2
  s_add_u32 s16, s16, s17
  s_and_b32 s17, s21, 3
  s_add_u32 s16, s16, s17
  s_lshl_b32 s16, s16, 11
  s_add_u32 s66, s16, 5767168
  s_lshl_b32 s98, s23, 12
  s_add_u32 s98, s98, 15990784
  s_add_u32 s99, s29, 15990784
  v_mul_u32_u24 v7, 3072, v3
  v_add_u32 v7, v7, v174
  s_lshl_b32 s16, s20, 1
  s_add_u32 s16, s16, 0
  s_mul_i32 s17, s21, 6
  s_add_u32 s17, s17, s16
  s_lshl_b32 s54, s16, 5
  s_lshl_b32 s67, s21, 1
  s_add_u32 s54, s54, s67
  s_cmp_lt_u32 s16, 3
  s_cselect_b32 s17, s17, s54
  s_cselect_b32 s54, 3, 1
  s_lshl_b32 s54, s54, 10
  s_mul_i32 s67, s22, 224
  s_add_u32 s17, s17, s67
  s_lshl_b32 s17, s17, 10
  s_add_u32 s53, s17, 2097152
  s_add_u32 s54, s54, s53
  s_lshl_b32 s16, s20, 1
  s_add_u32 s16, s16, 1
  s_mul_i32 s17, s21, 6
  s_add_u32 s17, s17, s16
  s_lshl_b32 s56, s16, 5
  s_lshl_b32 s67, s21, 1
  s_add_u32 s56, s56, s67
  s_cmp_lt_u32 s16, 3
  s_cselect_b32 s17, s17, s56
  s_cselect_b32 s56, 3, 1
  s_lshl_b32 s56, s56, 10
  s_mul_i32 s67, s22, 224
  s_add_u32 s17, s17, s67
  s_lshl_b32 s17, s17, 10
  s_add_u32 s55, s17, 2097152
  s_add_u32 s56, s56, s55
  s_cmp_eq_u32 s20, 3
  s_cselect_b32 s55, 268435456, s55
  s_cselect_b32 s56, 268435456, s56
  s_and_b32 s96, s33, 4294967039
  s_add_u32 s96, s96, 0
  v_and_b32 v233, 1, v0
  v_lshlrev_b32 v233, 8, v233
  s_mul_i32 s18, s32, 196608
  s_add_u32 m0, s36, 12288
  s_add_u32 s18, s18, s34
  buffer_load_dwordx4 v160, s[72:75], s18 offen offset:1024 lds
  buffer_load_dwordx4 v160, s[72:75], s18 offen offset:2048 lds
  s_lshl_b32 s19, s32, 7
  s_add_u32 m0, s42, 4096
  s_add_u32 s19, s19, s35
  buffer_load_dwordx4 v163, s[68:71], s19 offen lds
  s_add_u32 s32, s32, 1
  s_and_b32 s32, s32, 7
  buffer_load_dwordx4 v164, s[68:71], s19 offen offset:1024 lds
  buffer_load_dwordx4 v165, s[68:71], s19 offen offset:2048 lds
  buffer_load_dwordx4 v166, s[68:71], s19 offen offset:3072 lds
  s_cmp_lg_u32 s2, 0
  s_cbranch_scc1 L_noclr
  s_waitcnt vmcnt(9)
  s_lshl_b32 s16, s20, 2
  v_mov_b32 v14, 1
  s_mov_b64 exec, 1
  buffer_store_dword v14, v13, s[12:15], s16 offen sc1
  s_mov_b64 exec, -1
L_noclr:
  s_waitcnt vmcnt(13)
  s_barrier
  s_waitcnt vmcnt(9)
  ds_read_b128 a[0:3], v167 offset:0
  ds_read_b64_tr_b16 v[92:93], v171 offset:1024
  ds_read_b64_tr_b16 v[94:95], v171 offset:1280
  ds_read_b64_tr_b16 v[96:97], v171 offset:2048
  ds_read_b64_tr_b16 v[98:99], v171 offset:2304
  s_mul_i32 s18, s32, 196608
  s_add_u32 m0, s36, 24576
  s_add_u32 s18, s18, s34
  buffer_load_dwordx4 v160, s[72:75], s18 offen offset:1024 lds
  buffer_load_dwordx4 v160, s[72:75], s18 offen offset:2048 lds
  s_lshl_b32 s19, s32, 7
  s_add_u32 m0, s42, 8192
  s_add_u32 s19, s19, s35
  buffer_load_dwordx4 v163, s[68:71], s19 offen lds
  s_add_u32 s32, s32, 1
  s_and_b32 s32, s32, 7
  buffer_load_dwordx4 v164, s[68:71], s19 offen offset:1024 lds
  buffer_load_dwordx4 v165, s[68:71], s19 offen offset:2048 lds
  buffer_load_dwordx4 v166, s[68:71], s19 offen offset:3072 lds
  ds_read_b128 a[4:7], v168 offset:0
  s_waitcnt lgkmcnt(3)
  v_mfma_f32_32x32x16_bf16 v[16:31], a[0:3], v[92:95], 0
  ds_read_b64_tr_b16 v[104:105], v171 offset:4096
  ds_read_b64_tr_b16 v[106:107], v171 offset:4352
  s_waitcnt lgkmcnt(3)
  v_mfma_f32_32x32x16_bf16 v[32:47], a[0:3], v[96:99], 0
  ds_read_b64_tr_b16 v[108:109], v171 offset:5120
  ds_read_b64_tr_b16 v[110:111], v171 offset:5376
  ds_read_b128 a[8:11], v169 offset:0
  s_waitcnt lgkmcnt(3)
  v_mfma_f32_32x32x16_bf16 v[16:31], a[4:7], v[104:107], v[16:31]
  ds_read_b64_tr_b16 v[92:93], v171 offset:7168
  ds_read_b64_tr_b16 v[94:95], v171 offset:7424
  s_waitcnt lgkmcnt(3)
  v_mfma_f32_32x32x16_bf16 v[32:47], a[4:7], v[108:111], v[32:47]
  ds_read_b64_tr_b16 v[96:97], v171 offset:8192
  ds_read_b64_tr_b16 v[98:99], v171 offset:8448
  ds_read_b64_tr_b16 v[196:197], v228 offset:0
  ds_read_b64_tr_b16 v[198:199], v228 offset:512
  ds_read_b64_tr_b16 v[200:201], v228 offset:3072
  ds_read_b64_tr_b16 v[202:203], v228 offset:3584
  s_waitcnt vmcnt(12)
  ds_write_b128 v230, v[204:207]
  ds_read_b64_tr_b16 v[204:205], v229 offset:0
  ds_read_b64_tr_b16 v[206:207], v229 offset:512
  buffer_store_dwordx2 v[210:211], v209, s[8:11], s3 offen sc1
  buffer_store_dwordx2 v[210:211], v209, s[8:11], s4 offen sc1
  buffer_store_dword v210, v174, s[8:11], s5 offen offset:2048 sc1
  s_mov_b32 s16, 0xffff0000
  s_waitcnt lgkmcnt(5)
  v_mfma_f32_32x32x16_bf16 a[152:167], v[176:179], v[196:199], 0
  s_waitcnt lgkmcnt(3)
  v_mfma_f32_32x32x16_bf16 a[152:167], v[176:179], v[200:203], a[152:167]
  buffer_store_dwordx4 v[196:199], v1, s[8:11], s6 offen sc1
  buffer_store_dwordx4 v[200:203], v1, s[8:11], s7 offen sc1
  s_waitcnt lgkmcnt(0)
  buffer_store_dwordx4 v[204:207], v1, s[8:11], s48 offen sc1
  v_lshlrev_b32 v112, 16, v80
  v_and_b32 v113, s16, v80
  v_lshlrev_b32 v114, 16, v81
  v_and_b32 v115, s16, v81
  v_lshlrev_b32 v116, 16, v82
  v_and_b32 v117, s16, v82
  v_lshlrev_b32 v118, 16, v83
  v_and_b32 v119, s16, v83
  v_lshlrev_b32 v120, 16, v84
  v_and_b32 v121, s16, v84
  v_lshlrev_b32 v122, 16, v85
  v_and_b32 v123, s16, v85
  v_lshlrev_b32 v124, 16, v86
  v_and_b32 v125, s16, v86
  v_lshlrev_b32 v126, 16, v87
  v_and_b32 v127, s16, v87
  v_accvgpr_read_b32 v208, a152
  buffer_store_dword v208, v174, s[8:11], s49 offen sc1
  v_pk_add_f32 v[192:193], v[112:113], v[114:115]
  v_pk_add_f32 v[194:195], v[116:117], v[118:119]
  v_pk_add_f32 v[192:193], v[192:193], v[120:121]
  v_pk_add_f32 v[194:195], v[194:195], v[122:123]
  v_pk_add_f32 v[192:193], v[192:193], v[124:125]
  v_pk_add_f32 v[194:195], v[194:195], v[126:127]
  v_pk_add_f32 v[192:193], v[192:193], v[194:195]
  v_add_f32 v192, v192, v193
  v_mov_b32 v194, v192
  s_nop 1
  v_permlane32_swap_b32 v194, v192
  v_add_f32 v192, v194, v192
  v_mul_f32 v192, 0x3d000000, v192
  v_pk_add_f32 v[112:113], v[112:113], v[192:193] op_sel_hi:[1,0] neg_lo:[0,1] neg_hi:[0,1]
  v_pk_add_f32 v[114:115], v[114:115], v[192:193] op_sel_hi:[1,0] neg_lo:[0,1] neg_hi:[0,1]
  v_pk_add_f32 v[116:117], v[116:117], v[192:193] op_sel_hi:[1,0] neg_lo:[0,1] neg_hi:[0,1]
  v_pk_add_f32 v[118:119], v[118:119], v[192:193] op_sel_hi:[1,0] neg_lo:[0,1] neg_hi:[0,1]
  v_pk_add_f32 v[120:121], v[120:121], v[192:193] op_sel_hi:[1,0] neg_lo:[0,1] neg_hi:[0,1]
  v_pk_add_f32 v[122:123], v[122:123], v[192:193] op_sel_hi:[1,0] neg_lo:[0,1] neg_hi:[0,1]
  v_pk_add_f32 v[124:125], v[124:125], v[192:193] op_sel_hi:[1,0] neg_lo:[0,1] neg_hi:[0,1]
  v_pk_add_f32 v[126:127], v[126:127], v[192:193] op_sel_hi:[1,0] neg_lo:[0,1] neg_hi:[0,1]
  v_pk_mul_f32 v[194:195], v[112:113], v[112:113]
  v_pk_mul_f32 v[112:113], v[114:115], v[114:115]
  v_pk_fma_f32 v[194:195], v[116:117], v[116:117], v[194:195]
  v_pk_fma_f32 v[112:113], v[118:119], v[118:119], v[112:113]
  v_pk_fma_f32 v[194:195], v[120:121], v[120:121], v[194:195]
  v_pk_fma_f32 v[112:113], v[122:123], v[122:123], v[112:113]
  v_pk_fma_f32 v[194:195], v[124:125], v[124:125], v[194:195]
  v_pk_fma_f32 v[112:113], v[126:127], v[126:127], v[112:113]
  v_pk_add_f32 v[194:195], v[194:195], v[112:113]
  v_add_f32 v193, v194, v195
  v_min_u32 v192, -2, v192
  v_mov_b32 v194, v193
  s_nop 1
  v_permlane32_swap_b32 v194, v193
  v_add_f32 v193, v194, v193
  buffer_store_dwordx2 v[192:193], v12, s[8:11], s99 offen sc1
  buffer_load_dword v224, v232, s[12:15], 0 offen sc1
  v_permlane32_swap_b32 v80, v82
  v_permlane32_swap_b32 v81, v83
  v_permlane32_swap_b32 v84, v86
  v_permlane32_swap_b32 v85, v87
  ds_read_b128 a[12:15], v170 offset:0
  v_mfma_f32_32x32x16_bf16 v[16:31], a[8:11], v[92:95], v[16:31]
  ds_read_b64_tr_b16 v[104:105], v171 offset:10240
  ds_read_b64_tr_b16 v[106:107], v171 offset:10496
  v_mfma_f32_32x32x16_bf16 v[32:47], a[8:11], v[96:99], v[32:47]
  ds_read_b64_tr_b16 v[108:109], v171 offset:11264
  ds_read_b64_tr_b16 v[110:111], v171 offset:11520
  s_waitcnt vmcnt(19)
  s_barrier
  s_waitcnt vmcnt(15)
  ds_read_b128 a[16:19], v167 offset:4096
  s_waitcnt lgkmcnt(3)
  v_mfma_f32_32x32x16_bf16 v[16:31], a[12:15], v[104:107], v[16:31]
  ds_read_b64_tr_b16 v[92:93], v171 offset:13312
  ds_read_b64_tr_b16 v[94:95], v171 offset:13568
  s_waitcnt lgkmcnt(3)
  v_mfma_f32_32x32x16_bf16 v[32:47], a[12:15], v[108:111], v[32:47]
  ds_read_b64_tr_b16 v[96:97], v171 offset:14336
  ds_read_b64_tr_b16 v[98:99], v171 offset:14592
  ds_read_b128 a[20:23], v168 offset:4096
  s_waitcnt lgkmcnt(3)
  v_mfma_f32_32x32x16_bf16 v[16:31], a[16:19], v[92:95], v[16:31]
  ds_read_b64_tr_b16 v[104:105], v171 offset:16384
  ds_read_b64_tr_b16 v[106:107], v171 offset:16640
  s_mul_i32 s18, s32, 196608
  s_add_u32 m0, s36, 36864
  s_add_u32 s18, s18, s34
  buffer_load_dwordx4 v160, s[72:75], s18 offen offset:1024 lds
  s_waitcnt lgkmcnt(3)
  v_mfma_f32_32x32x16_bf16 v[32:47], a[16:19], v[96:99], v[32:47]
  ds_read_b64_tr_b16 v[108:109], v171 offset:17408
  ds_read_b64_tr_b16 v[110:111], v171 offset:17664
  buffer_load_dwordx4 v160, s[72:75], s18 offen offset:2048 lds
  ds_read_b128 a[24:27], v169 offset:4096
  s_waitcnt lgkmcnt(3)
  v_mfma_f32_32x32x16_bf16 v[16:31], a[20:23], v[104:107], v[16:31]
  ds_read_b64_tr_b16 v[92:93], v171 offset:19456
  ds_read_b64_tr_b16 v[94:95], v171 offset:19712
  s_lshl_b32 s19, s32, 7
  s_add_u32 m0, s42, 0
  s_add_u32 s19, s19, s35
  buffer_load_dwordx4 v163, s[68:71], s19 offen lds
  s_add_u32 s32, s32, 1
  s_and_b32 s32, s32, 7
  s_waitcnt lgkmcnt(3)
  v_mfma_f32_32x32x16_bf16 v[32:47], a[20:23], v[108:111], v[32:47]
  ds_read_b64_tr_b16 v[96:97], v171 offset:20480
  ds_read_b64_tr_b16 v[98:99], v171 offset:20736
  buffer_load_dwordx4 v164, s[68:71], s19 offen offset:1024 lds
  ds_read_b128 a[28:31], v170 offset:4096
  s_waitcnt lgkmcnt(3)
  v_mfma_f32_32x32x16_bf16 v[16:31], a[24:27], v[92:95], v[16:31]
  ds_read_b64_tr_b16 v[104:105], v171 offset:22528
  ds_read_b64_tr_b16 v[106:107], v171 offset:22784
  buffer_load_dwordx4 v165, s[68:71], s19 offen offset:2048 lds
  s_waitcnt lgkmcnt(3)
  v_mfma_f32_32x32x16_bf16 v[32:47], a[24:27], v[96:99], v[32:47]
  ds_read_b64_tr_b16 v[108:109], v171 offset:23552
  ds_read_b64_tr_b16 v[110:111], v171 offset:23808
  buffer_load_dwordx4 v166, s[68:71], s19 offen offset:3072 lds
  s_waitcnt vmcnt(6)
  v_cmp_gt_u32 vcc, 1, v224
  s_nop 0
  s_cbranch_vccz poll_1_x
  s_mov_b32 s58, 0
poll_1:
  buffer_load_dword v224, v232, s[12:15], 0 offen sc1
  s_waitcnt vmcnt(0)
  v_cmp_gt_u32 vcc, 1, v224
  s_add_u32 s58, s58, 1
  s_cmp_gt_u32 s58, 0x200000
  s_cbranch_scc1 poll_1_x
  s_cbranch_vccnz poll_1
poll_1_x:
  s_or_b32 s17, s27, 16
  v_mov_b32 v14, s17
  s_mov_b64 exec, 1
  buffer_store_dword v14, v13, s[8:11], s30 offen sc1
  s_mov_b64 exec, -1
  s_barrier
  s_cmp_lg_u32 s20, 0
  s_cbranch_scc1 arr_2
  v_mov_b32 v14, 1
  s_mov_b64 exec, 1
  buffer_atomic_add v14, v13, s[8:11], s33 offen offset:0 sc1
  s_mov_b64 exec, -1
arr_2:
  ds_read_b128 a[32:35], v167 offset:8192
  s_waitcnt lgkmcnt(3)
  v_mfma_f32_32x32x16_bf16 v[16:31], a[28:31], v[104:107], v[16:31]
  ds_read_b64_tr_b16 v[92:93], v171 offset:25600
  ds_read_b64_tr_b16 v[94:95], v171 offset:25856
  s_waitcnt lgkmcnt(3)
  v_mfma_f32_32x32x16_bf16 v[32:47], a[28:31], v[108:111], v[32:47]
  ds_read_b64_tr_b16 v[96:97], v171 offset:26624
  ds_read_b64_tr_b16 v[98:99], v171 offset:26880
  ds_read_b128 a[36:39], v168 offset:8192
  s_waitcnt lgkmcnt(3)
  v_mfma_f32_32x32x16_bf16 v[16:31], a[32:35], v[92:95], v[16:31]
  ds_read_b64_tr_b16 v[104:105], v171 offset:28672
  ds_read_b64_tr_b16 v[106:107], v171 offset:28928
  s_mul_i32 s18, s32, 196608
  s_add_u32 m0, s36, 49152
  s_add_u32 s18, s18, s34
  buffer_load_dwordx4 v160, s[72:75], s18 offen offset:1024 lds
  s_waitcnt lgkmcnt(3)
  v_mfma_f32_32x32x16_bf16 v[32:47], a[32:35], v[96:99], v[32:47]
  ds_read_b64_tr_b16 v[108:109], v171 offset:29696
  ds_read_b64_tr_b16 v[110:111], v171 offset:29952
  buffer_load_dwordx4 v160, s[72:75], s18 offen offset:2048 lds
  ds_read_b128 a[40:43], v169 offset:8192
  s_waitcnt lgkmcnt(3)
  v_mfma_f32_32x32x16_bf16 v[16:31], a[36:39], v[104:107], v[16:31]
  ds_read_b64_tr_b16 v[92:93], v171 offset:31744
  ds_read_b64_tr_b16 v[94:95], v171 offset:32000
  s_lshl_b32 s19, s32, 7
  s_add_u32 m0, s42, 4096
  s_add_u32 s19, s19, s35
  buffer_load_dwordx4 v163, s[68:71], s19 offen lds
  s_add_u32 s32, s32, 1
  s_and_b32 s32, s32, 7
  s_waitcnt lgkmcnt(3)
  v_mfma_f32_32x32x16_bf16 v[32:47], a[36:39], v[108:111], v[32:47]
  ds_read_b64_tr_b16 v[96:97], v171 offset:32768
  ds_read_b64_tr_b16 v[98:99], v171 offset:33024
  buffer_load_dwordx4 v164, s[68:71], s19 offen offset:1024 lds
  ds_read_b128 a[44:47], v170 offset:8192
  s_waitcnt lgkmcnt(3)
  v_mfma_f32_32x32x16_bf16 v[16:31], a[40:43], v[92:95], v[16:31]
  ds_read_b64_tr_b16 v[104:105], v171 offset:34816
  ds_read_b64_tr_b16 v[106:107], v171 offset:35072
  buffer_load_dwordx4 v165, s[68:71], s19 offen offset:2048 lds
  s_waitcnt lgkmcnt(3)
  v_mfma_f32_32x32x16_bf16 v[32:47], a[40:43], v[96:99], v[32:47]
  ds_read_b64_tr_b16 v[108:109], v171 offset:35840
  ds_read_b64_tr_b16 v[110:111], v171 offset:36096
  buffer_load_dwordx4 v166, s[68:71], s19 offen offset:3072 lds
  s_waitcnt vmcnt(11)
  s_barrier
  s_waitcnt vmcnt(7)
  ds_read_b128 a[48:51], v167 offset:0
  s_waitcnt lgkmcnt(3)
  v_mfma_f32_32x32x16_bf16 v[16:31], a[44:47], v[104:107], v[16:31]
  ds_read_b64_tr_b16 v[92:93], v171 offset:37888
  ds_read_b64_tr_b16 v[94:95], v171 offset:38144
  s_waitcnt lgkmcnt(3)
  v_mfma_f32_32x32x16_bf16 v[32:47], a[44:47], v[108:111], v[32:47]
  ds_read_b64_tr_b16 v[96:97], v171 offset:38912
  ds_read_b64_tr_b16 v[98:99], v171 offset:39168
  ds_read_b128 a[52:55], v168 offset:0
  s_waitcnt lgkmcnt(3)
  v_mfma_f32_32x32x16_bf16 v[16:31], a[48:51], v[92:95], v[16:31]
  ds_read_b64_tr_b16 v[104:105], v171 offset:40960
  ds_read_b64_tr_b16 v[106:107], v171 offset:41216
  s_mul_i32 s18, s32, 196608
  s_add_u32 m0, s36, 61440
  s_add_u32 s18, s18, s34
  buffer_load_dwordx4 v160, s[72:75], s18 offen offset:1024 lds
  s_waitcnt lgkmcnt(3)
  v_mfma_f32_32x32x16_bf16 v[32:47], a[48:51], v[96:99], v[32:47]
  ds_read_b64_tr_b16 v[108:109], v171 offset:41984
  ds_read_b64_tr_b16 v[110:111], v171 offset:42240
  buffer_load_dwordx4 v160, s[72:75], s18 offen offset:2048 lds
  ds_read_b128 a[56:59], v169 offset:0
  s_waitcnt lgkmcnt(3)
  v_mfma_f32_32x32x16_bf16 v[16:31], a[52:55], v[104:107], v[16:31]
  ds_read_b64_tr_b16 v[92:93], v171 offset:44032
  ds_read_b64_tr_b16 v[94:95], v171 offset:44288
  s_lshl_b32 s19, s32, 7
  s_add_u32 m0, s42, 8192
  s_add_u32 s19, s19, s35
  buffer_load_dwordx4 v163, s[68:71], s19 offen lds
  s_add_u32 s32, s32, 1
  s_and_b32 s32, s32, 7
  s_waitcnt lgkmcnt(3)
  v_mfma_f32_32x32x16_bf16 v[32:47], a[52:55], v[108:111], v[32:47]
  ds_read_b64_tr_b16 v[96:97], v171 offset:45056
  ds_read_b64_tr_b16 v[98:99], v171 offset:45312
  buffer_load_dwordx4 v164, s[68:71], s19 offen offset:1024 lds
  ds_read_b128 a[60:63], v170 offset:0
  s_waitcnt lgkmcnt(3)
  v_mfma_f32_32x32x16_bf16 v[16:31], a[56:59], v[92:95], v[16:31]
  ds_read_b64_tr_b16 v[104:105], v171 offset:47104
  ds_read_b64_tr_b16 v[106:107], v171 offset:47360
  buffer_load_dwordx4 v165, s[68:71], s19 offen offset:2048 lds
  s_waitcnt lgkmcnt(3)
  v_mfma_f32_32x32x16_bf16 v[32:47], a[56:59], v[96:99], v[32:47]
  ds_read_b64_tr_b16 v[108:109], v171 offset:48128
  ds_read_b64_tr_b16 v[110:111], v171 offset:48384
  buffer_load_dwordx4 v166, s[68:71], s19 offen offset:3072 lds
  s_waitcnt vmcnt(10)
  s_barrier
  s_waitcnt vmcnt(6)
  ds_read_b128 a[64:67], v167 offset:4096
  s_waitcnt lgkmcnt(3)
  v_mfma_f32_32x32x16_bf16 v[16:31], a[60:63], v[104:107], v[16:31]
  ds_read_b64_tr_b16 v[92:93], v171 offset:50176
  ds_read_b64_tr_b16 v[94:95], v171 offset:50432
  s_waitcnt lgkmcnt(3)
  v_mfma_f32_32x32x16_bf16 v[32:47], a[60:63], v[108:111], v[32:47]
  ds_read_b64_tr_b16 v[96:97], v171 offset:51200
  ds_read_b64_tr_b16 v[98:99], v171 offset:51456
  ds_read_b128 a[68:71], v168 offset:4096
  s_waitcnt lgkmcnt(3)
  v_mfma_f32_32x32x16_bf16 v[16:31], a[64:67], v[92:95], v[16:31]
  ds_read_b64_tr_b16 v[104:105], v171 offset:53248
  ds_read_b64_tr_b16 v[106:107], v171 offset:53504
  s_mul_i32 s18, s32, 196608
  s_add_u32 m0, s36, 73728
  s_add_u32 s18, s18, s34
  buffer_load_dwordx4 v160, s[72:75], s18 offen offset:1024 lds
  s_waitcnt lgkmcnt(3)
  v_mfma_f32_32x32x16_bf16 v[32:47], a[64:67], v[96:99], v[32:47]
  ds_read_b64_tr_b16 v[108:109], v171 offset:54272
  ds_read_b64_tr_b16 v[110:111], v171 offset:54528
  buffer_load_dwordx4 v160, s[72:75], s18 offen offset:2048 lds
  ds_read_b128 a[72:75], v169 offset:4096
  s_waitcnt lgkmcnt(3)
  v_mfma_f32_32x32x16_bf16 v[16:31], a[68:71], v[104:107], v[16:31]
  ds_read_b64_tr_b16 v[92:93], v171 offset:56320
  ds_read_b64_tr_b16 v[94:95], v171 offset:56576
  s_lshl_b32 s19, s32, 7
  s_add_u32 m0, s42, 0
  s_add_u32 s19, s19, s35
  buffer_load_dwordx4 v163, s[68:71], s19 offen lds
  s_add_u32 s32, s32, 1
  s_and_b32 s32, s32, 7
  s_waitcnt lgkmcnt(3)
  v_mfma_f32_32x32x16_bf16 v[32:47], a[68:71], v[108:111], v[32:47]
  ds_read_b64_tr_b16 v[96:97], v171 offset:57344
  ds_read_b64_tr_b16 v[98:99], v171 offset:57600
  buffer_load_dwordx4 v164, s[68:71], s19 offen offset:1024 lds
  ds_read_b128 a[76:79], v170 offset:4096
  s_waitcnt lgkmcnt(3)
  v_mfma_f32_32x32x16_bf16 v[16:31], a[72:75], v[92:95], v[16:31]
  ds_read_b64_tr_b16 v[104:105], v171 offset:59392
  ds_read_b64_tr_b16 v[106:107], v171 offset:59648
  buffer_load_dwordx4 v165, s[68:71], s19 offen offset:2048 lds
  s_waitcnt lgkmcnt(3)
  v_mfma_f32_32x32x16_bf16 v[32:47], a[72:75], v[96:99], v[32:47]
  ds_read_b64_tr_b16 v[108:109], v171 offset:60416
  ds_read_b64_tr_b16 v[110:111], v171 offset:60672
  buffer_load_dwordx4 v166, s[68:71], s19 offen offset:3072 lds
  s_waitcnt vmcnt(10)
  s_barrier
  s_waitcnt vmcnt(6)
  ds_read_b128 a[80:83], v167 offset:8192
  s_waitcnt lgkmcnt(3)
  v_mfma_f32_32x32x16_bf16 v[16:31], a[76:79], v[104:107], v[16:31]
  ds_read_b64_tr_b16 v[92:93], v171 offset:62464
  ds_read_b64_tr_b16 v[94:95], v171 offset:62720
  s_waitcnt lgkmcnt(3)
  v_mfma_f32_32x32x16_bf16 v[32:47], a[76:79], v[108:111], v[32:47]
  ds_read_b64_tr_b16 v[96:97], v171 offset:63488
  ds_read_b64_tr_b16 v[98:99], v171 offset:63744
  buffer_load_dword v225, v233, s[8:11], s96 offen sc1
  buffer_load_dword v226, v231, s[8:11], s45 offen sc1
  ds_read_b128 a[84:87], v168 offset:8192
  s_waitcnt lgkmcnt(3)
  v_mfma_f32_32x32x16_bf16 v[16:31], a[80:83], v[92:95], v[16:31]
  ds_read_b64_tr_b16 v[104:105], v227 offset:0
  ds_read_b64_tr_b16 v[106:107], v227 offset:256
  s_mul_i32 s18, s32, 196608
  s_add_u32 m0, s36, 86016
  s_add_u32 s18, s18, s34
  buffer_load_dwordx4 v160, s[72:75], s18 offen offset:1024 lds
  s_waitcnt lgkmcnt(3)
  v_mfma_f32_32x32x16_bf16 v[32:47], a[80:83], v[96:99], v[32:47]
  ds_read_b64_tr_b16 v[108:109], v227 offset:1024
  ds_read_b64_tr_b16 v[110:111], v227 offset:1280
  buffer_load_dwordx4 v160, s[72:75], s18 offen offset:2048 lds
  ds_read_b128 a[88:91], v169 offset:8192
  s_waitcnt lgkmcnt(3)
  v_mfma_f32_32x32x16_bf16 v[16:31], a[84:87], v[104:107], v[16:31]
  ds_read_b64_tr_b16 v[92:93], v227 offset:3072
  ds_read_b64_tr_b16 v[94:95], v227 offset:3328
  s_lshl_b32 s19, s32, 7
  s_add_u32 m0, s42, 4096
  s_add_u32 s19, s19, s35
  buffer_load_dwordx4 v163, s[68:71], s19 offen lds
  s_add_u32 s32, s32, 1
  s_and_b32 s32, s32, 7
  s_waitcnt lgkmcnt(3)
  v_mfma_f32_32x32x16_bf16 v[32:47], a[84:87], v[108:111], v[32:47]
  ds_read_b64_tr_b16 v[96:97], v227 offset:4096
  ds_read_b64_tr_b16 v[98:99], v227 offset:4352
  buffer_load_dwordx4 v164, s[68:71], s19 offen offset:1024 lds
  ds_read_b128 a[92:95], v170 offset:8192
  s_waitcnt lgkmcnt(3)
  v_mfma_f32_32x32x16_bf16 v[16:31], a[88:91], v[92:95], v[16:31]
  ds_read_b64_tr_b16 v[104:105], v227 offset:6144
  ds_read_b64_tr_b16 v[106:107], v227 offset:6400
  buffer_load_dwordx4 v165, s[68:71], s19 offen offset:2048 lds
  s_waitcnt lgkmcnt(3)
  v_mfma_f32_32x32x16_bf16 v[32:47], a[88:91], v[96:99], v[32:47]
  ds_read_b64_tr_b16 v[108:109], v227 offset:7168
  ds_read_b64_tr_b16 v[110:111], v227 offset:7424
  buffer_load_dwordx4 v166, s[68:71], s19 offen offset:3072 lds
  s_waitcnt vmcnt(12)
  s_barrier
  s_waitcnt vmcnt(8)
  ds_read_b128 a[96:99], v167 offset:0
  s_waitcnt lgkmcnt(3)
  v_mfma_f32_32x32x16_bf16 v[16:31], a[92:95], v[104:107], v[16:31]
  ds_read_b64_tr_b16 v[92:93], v227 offset:9216
  ds_read_b64_tr_b16 v[94:95], v227 offset:9472
  s_waitcnt lgkmcnt(3)
  v_mfma_f32_32x32x16_bf16 v[32:47], a[92:95], v[108:111], v[32:47]
  ds_read_b64_tr_b16 v[96:97], v227 offset:10240
  ds_read_b64_tr_b16 v[98:99], v227 offset:10496
  v_mov_b32 v68, -1
  v_mov_b32 v69, -1
  v_mov_b32 v70, -1
  v_mov_b32 v71, -1
  s_mul_i32 s17, s26, 4194304
  s_add_u32 s17, s17, s28
  s_add_u32 s17, s17, 9699328
  s_mul_i32 s19, s26, 524288
  s_add_u32 s19, s19, s29
  s_add_u32 s19, s19, 16252928
  buffer_store_dwordx4 v[68:71], v1, s[8:11], s17 offen sc1
  buffer_store_dwordx4 v[68:71], v1, s[8:11], s17 offen offset:1024 sc1
  buffer_store_dwordx2 v[68:69], v12, s[8:11], s19 offen sc1
  s_waitcnt vmcnt(10)
  v_cmp_gt_u32 vcc, 16, v225
  s_nop 0
  s_cbranch_vccz poll_3_x
  s_mov_b32 s58, 0
poll_3:
  buffer_load_dword v225, v233, s[8:11], s96 offen sc1
  s_waitcnt vmcnt(0)
  v_cmp_gt_u32 vcc, 16, v225
  s_add_u32 s58, s58, 1
  s_cmp_gt_u32 s58, 0x200000
  s_cbranch_scc1 poll_3_x
  s_cbranch_vccnz poll_3
poll_3_x:
  buffer_load_dword v240, v7, s[8:11], s46 offen offset:0 sc1
  buffer_load_dword v241, v7, s[8:11], s46 offen offset:384 sc1
  buffer_load_dword v242, v7, s[8:11], s46 offen offset:768 sc1
  buffer_load_dword v243, v7, s[8:11], s46 offen offset:1152 sc1
  buffer_load_dword v244, v7, s[8:11], s46 offen offset:1536 sc1
  buffer_load_dword v245, v7, s[8:11], s46 offen offset:1920 sc1
  buffer_load_dword v246, v7, s[8:11], s46 offen offset:2304 sc1
  buffer_load_dword v247, v7, s[8:11], s46 offen offset:2688 sc1
  s_waitcnt vmcnt(17)
  v_cmp_gt_u32 vcc, 16, v226
  s_nop 0
  s_cbranch_vccz poll_4_x
  s_mov_b32 s58, 0
poll_4:
  buffer_load_dword v226, v231, s[8:11], s45 offen sc1
  s_waitcnt vmcnt(0)
  v_cmp_gt_u32 vcc, 16, v226
  s_add_u32 s58, s58, 1
  s_cmp_gt_u32 s58, 0x200000
  s_cbranch_scc1 poll_4_x
  s_cbranch_vccnz poll_4
poll_4_x:
  buffer_load_dwordx2 v[112:113], v4, s[8:11], s98 offen offset:0 sc1
  buffer_load_dwordx2 v[114:115], v4, s[8:11], s98 offen offset:256 sc1
  buffer_load_dwordx2 v[116:117], v4, s[8:11], s98 offen offset:512 sc1
  buffer_load_dwordx2 v[118:119], v4, s[8:11], s98 offen offset:768 sc1
  buffer_load_dwordx2 v[120:121], v4, s[8:11], s98 offen offset:1024 sc1
  buffer_load_dwordx2 v[122:123], v4, s[8:11], s98 offen offset:1280 sc1
  buffer_load_dwordx2 v[124:125], v4, s[8:11], s98 offen offset:1536 sc1
  buffer_load_dwordx2 v[126:127], v4, s[8:11], s98 offen offset:1792 sc1
  ds_read_b128 a[100:103], v168 offset:0
  s_waitcnt lgkmcnt(3)
  v_mfma_f32_32x32x16_bf16 v[16:31], a[96:99], v[92:95], v[16:31]
  ds_read_b64_tr_b16 v[104:105], v227 offset:12288
  ds_read_b64_tr_b16 v[106:107], v227 offset:12544
  s_add_u32 s32, s32, 1
  s_and_b32 s32, s32, 7
  s_mul_i32 s18, s32, 196608
  s_add_u32 m0, s36, 12288
  s_add_u32 s18, s18, s34
  buffer_load_dwordx4 v160, s[72:75], s18 offen lds
  s_waitcnt lgkmcnt(3)
  v_mfma_f32_32x32x16_bf16 v[32:47], a[96:99], v[96:99], v[32:47]
  ds_read_b64_tr_b16 v[108:109], v227 offset:13312
  ds_read_b64_tr_b16 v[110:111], v227 offset:13568
  s_add_u32 s32, s32, 1
  s_and_b32 s32, s32, 7
  s_mul_i32 s18, s32, 196608
  s_add_u32 m0, s36, 24576
  s_add_u32 s18, s18, s34
  buffer_load_dwordx4 v160, s[72:75], s18 offen lds
  s_add_u32 s32, s32, 1
  s_and_b32 s32, s32, 7
  s_mul_i32 s18, s32, 196608
  s_add_u32 m0, s36, 36864
  s_add_u32 s18, s18, s34
  buffer_load_dwordx4 v160, s[72:75], s18 offen lds
  ds_read_b128 a[104:107], v169 offset:0
  s_waitcnt lgkmcnt(3)
  v_mfma_f32_32x32x16_bf16 v[16:31], a[100:103], v[104:107], v[16:31]
  ds_read_b64_tr_b16 v[92:93], v227 offset:15360
  ds_read_b64_tr_b16 v[94:95], v227 offset:15616
  s_add_u32 s32, s32, 1
  s_and_b32 s32, s32, 7
  s_mul_i32 s18, s32, 196608
  s_add_u32 m0, s36, 49152
  s_add_u32 s18, s18, s34
  buffer_load_dwordx4 v160, s[72:75], s18 offen lds
  s_waitcnt lgkmcnt(3)
  v_mfma_f32_32x32x16_bf16 v[32:47], a[100:103], v[108:111], v[32:47]
  ds_read_b64_tr_b16 v[96:97], v227 offset:16384
  ds_read_b64_tr_b16 v[98:99], v227 offset:16640
  s_add_u32 s32, s32, 1
  s_and_b32 s32, s32, 7
  s_mul_i32 s18, s32, 196608
  s_add_u32 m0, s36, 61440
  s_add_u32 s18, s18, s34
  buffer_load_dwordx4 v160, s[72:75], s18 offen lds
  ds_read_b128 a[108:111], v170 offset:0
  s_waitcnt lgkmcnt(3)
  v_mfma_f32_32x32x16_bf16 v[16:31], a[104:107], v[92:95], v[16:31]
  ds_read_b64_tr_b16 v[104:105], v227 offset:18432
  ds_read_b64_tr_b16 v[106:107], v227 offset:18688
  s_add_u32 s32, s32, 1
  s_and_b32 s32, s32, 7
  s_mul_i32 s18, s32, 196608
  s_add_u32 m0, s36, 73728
  s_add_u32 s18, s18, s34
  buffer_load_dwordx4 v160, s[72:75], s18 offen lds
  s_waitcnt lgkmcnt(3)
  v_mfma_f32_32x32x16_bf16 v[32:47], a[104:107], v[96:99], v[32:47]
  ds_read_b64_tr_b16 v[108:109], v227 offset:19456
  ds_read_b64_tr_b16 v[110:111], v227 offset:19712
  s_add_u32 s32, s32, 1
  s_and_b32 s32, s32, 7
  s_mul_i32 s18, s32, 196608
  s_add_u32 m0, s36, 86016
  s_add_u32 s18, s18, s34
  buffer_load_dwordx4 v160, s[72:75], s18 offen lds
  s_waitcnt vmcnt(30)
  s_barrier
  s_waitcnt vmcnt(26)
  ds_read_b128 a[112:115], v167 offset:4096
  s_waitcnt lgkmcnt(3)
  v_mfma_f32_32x32x16_bf16 v[16:31], a[108:111], v[104:107], v[16:31]
  ds_read_b64_tr_b16 v[92:93], v227 offset:21504
  ds_read_b64_tr_b16 v[94:95], v227 offset:21760
  s_waitcnt lgkmcnt(3)
  v_mfma_f32_32x32x16_bf16 v[32:47], a[108:111], v[108:111], v[32:47]
  ds_read_b64_tr_b16 v[96:97], v227 offset:22528
  ds_read_b64_tr_b16 v[98:99], v227 offset:22784
  s_waitcnt vmcnt(21)
  v_add_f32 v240, v240, v241
  s_waitcnt vmcnt(20)
  v_add_f32 v240, v240, v242
  s_waitcnt vmcnt(19)
  v_add_f32 v240, v240, v243
  s_waitcnt vmcnt(18)
  v_add_f32 v240, v240, v244
  s_waitcnt vmcnt(17)
  v_add_f32 v240, v240, v245
  s_waitcnt vmcnt(16)
  v_add_f32 v240, v240, v246
  s_waitcnt vmcnt(15)
  v_add_f32 v240, v240, v247
  v_mov_b32 v241, v240
  s_nop 1
  v_permlane32_swap_b32 v241, v240
  v_add_f32 v240, v241, v240
  v_cvt_pk_bf16_f32 v248, v240, v240
  v_lshlrev_b32 v241, 16, v248
  v_sub_f32 v241, v240, v241
  v_cvt_pk_bf16_f32 v249, v241, 0
  v_cmp_eq_u32 vcc, 0, v3
  v_mov_b32 v250, 0
  v_mov_b32 v251, 0
  v_cndmask_b32 v248, 0, v248, vcc
  v_cndmask_b32 v249, 0, v249, vcc
  v_add_u32 v242, s47, v1
  ds_write_b128 v242, v[248:251]
  ds_read_b128 a[116:119], v168 offset:4096
  s_waitcnt lgkmcnt(4)
  v_mfma_f32_32x32x16_bf16 v[16:31], a[112:115], v[92:95], v[16:31]
  ds_read_b64_tr_b16 v[104:105], v227 offset:24576
  ds_read_b64_tr_b16 v[106:107], v227 offset:24832
  s_waitcnt vmcnt(13)
  v_add_f32 v128, v112, v114
  v_add_f32 v129, v113, v115
  s_waitcnt vmcnt(12)
  v_add_f32 v128, v128, v116
  v_add_f32 v129, v129, v117
  s_waitcnt vmcnt(11)
  v_add_f32 v128, v128, v118
  v_add_f32 v129, v129, v119
  s_waitcnt vmcnt(10)
  v_add_f32 v128, v128, v120
  v_add_f32 v129, v129, v121
  s_waitcnt vmcnt(9)
  v_add_f32 v128, v128, v122
  v_add_f32 v129, v129, v123
  s_waitcnt vmcnt(8)
  v_add_f32 v128, v128, v124
  v_add_f32 v129, v129, v125
  s_waitcnt lgkmcnt(4)
  v_mfma_f32_32x32x16_bf16 v[32:47], a[112:115], v[96:99], v[32:47]
  ds_read_b64_tr_b16 v[108:109], v227 offset:25600
  ds_read_b64_tr_b16 v[110:111], v227 offset:25856
  s_waitcnt vmcnt(7)
  v_add_f32 v128, v128, v126
  v_add_f32 v129, v129, v127
  v_mov_b32 v130, v128
  s_nop 1
  v_permlane32_swap_b32 v130, v128
  v_add_f32 v128, v130, v128
  v_mul_f32 v128, 0x3d800000, v128
  v_sub_f32 v112, v112, v128
  v_sub_f32 v114, v114, v128
  v_sub_f32 v116, v116, v128
  v_sub_f32 v118, v118, v128
  v_sub_f32 v120, v120, v128
  v_sub_f32 v122, v122, v128
  ds_read_b128 a[120:123], v169 offset:4096
  s_waitcnt lgkmcnt(3)
  v_mfma_f32_32x32x16_bf16 v[16:31], a[116:119], v[104:107], v[16:31]
  ds_read_b64_tr_b16 v[92:93], v227 offset:27648
  ds_read_b64_tr_b16 v[94:95], v227 offset:27904
  v_sub_f32 v124, v124, v128
  v_sub_f32 v126, v126, v128
  v_mul_f32 v130, v112, v112
  v_fmac_f32 v130, v114, v114
  v_fmac_f32 v130, v116, v116
  v_fmac_f32 v130, v118, v118
  v_fmac_f32 v130, v120, v120
  v_fmac_f32 v130, v122, v122
  v_fmac_f32 v130, v124, v124
  v_fmac_f32 v130, v126, v126
  v_fmamk_f32 v129, v130, 0x42000000, v129
  v_mov_b32 v130, v129
  s_waitcnt lgkmcnt(3)
  v_mfma_f32_32x32x16_bf16 v[32:47], a[116:119], v[108:111], v[32:47]
  ds_read_b64_tr_b16 v[96:97], v227 offset:28672
  ds_read_b64_tr_b16 v[98:99], v227 offset:28928
  v_permlane32_swap_b32 v130, v129
  v_add_f32 v129, v130, v129
  v_mov_b32 v130, 0x3727c5ac
  v_fmamk_f32 v129, v129, 0x3b000000, v130
  v_rsq_f32 v129, v129
  v_sub_f32 v130, 0, v128
  v_cvt_pk_bf16_f32 v133, v130, 0
  v_lshlrev_b32 v131, 16, v133
  v_sub_f32 v131, v130, v131
  v_cvt_pk_bf16_f32 v132, v130, v131
  v_mov_b32 v135, 0
  v_mov_b32 v134, 0
  ds_read_b128 a[124:127], v170 offset:4096
  s_waitcnt lgkmcnt(3)
  v_mfma_f32_32x32x16_bf16 v[16:31], a[120:123], v[92:95], v[16:31]
  ds_read_b64_tr_b16 v[104:105], v227 offset:30720
  ds_read_b64_tr_b16 v[106:107], v227 offset:30976
  s_lshl_b32 s16, s20, 7
  s_add_u32 s16, s16, 161792
  v_lshl_add_u32 v7, v2, 2, s16
  ds_write_b32 v7, v129
  v_lshl_add_u32 v7, v3, 4, s16
  ds_read_b128 v[112:115], v7 offset:0
  ds_read_b128 v[116:119], v7 offset:32
  ds_read_b128 v[120:123], v7 offset:64
  ds_read_b128 v[124:127], v7 offset:96
  s_mov_b32 s38, 0x3fb8aa3b
  v_mul_f32 v128, s38, v129
  s_mov_b32 s40, 0x358637bd
  s_waitcnt lgkmcnt(8)
  v_mfma_f32_32x32x16_bf16 v[32:47], a[120:123], v[96:99], v[32:47]
  ds_read_b64_tr_b16 v[108:109], v227 offset:31744
  ds_read_b64_tr_b16 v[110:111], v227 offset:32000
  s_mov_b32 s41, 0x358637bd
  s_waitcnt lgkmcnt(5)
  v_mul_f32 v144, s38, v112
  v_mul_f32 v145, s38, v113
  v_mul_f32 v146, s38, v114
  v_mul_f32 v147, s38, v115
  s_waitcnt lgkmcnt(4)
  v_mul_f32 v148, s38, v116
  v_mul_f32 v149, s38, v117
  v_mul_f32 v150, s38, v118
  v_mul_f32 v151, s38, v119
  s_waitcnt lgkmcnt(3)
  v_mul_f32 v152, s38, v120
  v_mul_f32 v153, s38, v121
  v_mul_f32 v154, s38, v122
  v_mfma_f32_32x32x16_bf16 v[16:31], a[124:127], v[104:107], v[16:31]
  v_mul_f32 v155, s38, v123
  s_waitcnt lgkmcnt(2)
  v_mul_f32 v156, s38, v124
  v_mul_f32 v157, s38, v125
  v_mul_f32 v158, s38, v126
  v_mul_f32 v159, s38, v127
  s_waitcnt lgkmcnt(0)
  v_mfma_f32_32x32x16_bf16 v[32:47], a[124:127], v[108:111], v[32:47]
  s_barrier
  buffer_load_dwordx4 a[128:131], v161, s[80:83], s50 offen
  buffer_load_dwordx4 a[132:135], v161, s[84:87], s50 offen
  s_add_u32 s50, s50, 57344
  buffer_load_dwordx4 a[136:139], v161, s[80:83], s50 offen
  buffer_load_dwordx4 a[140:143], v161, s[84:87], s50 offen
  buffer_load_dwordx4 a[144:147], v162, s[88:91], s51 offen
  buffer_load_dwordx4 a[148:151], v162, s[88:91], s51 offen offset:64
  ds_read_b128 v[88:91], v6 offset:16384
  ds_read_b128 v[92:95], v6 offset:17408
  s_waitcnt lgkmcnt(1)
  v_mfma_f32_32x32x16_bf16 v[16:31], v[132:135], v[88:91], v[16:31]
  s_waitcnt lgkmcnt(0)
  v_mfma_f32_32x32x16_bf16 v[32:47], v[132:135], v[92:95], v[32:47]
  s_mov_b32 s97, 1
  v_and_b32 v226, 15, v226
  v_cmp_ne_u32 vcc, s27, v226
  s_nop 0
  s_cbranch_vccnz L_safe_epi
  s_branch L_fast_epi
L_fast:
  s_mov_b32 s97, 0
  s_waitcnt vmcnt(10) lgkmcnt(2)
  v_mfma_f32_32x32x16_bf16 v[16:31], a[0:3], v[88:91], 0
  ds_read_b128 v[100:103], v1 offset:3072
  buffer_load_dwordx2 v[112:113], v4, s[8:11], s35 offen offset:0 sc1
  s_waitcnt lgkmcnt(2)
  v_mfma_f32_32x32x16_bf16 v[32:47], a[0:3], v[92:95], 0
  ds_read_b128 v[104:107], v1 offset:4096
  buffer_load_dwordx4 a[40:43], v1, s[8:11], s34 offen offset:2048 sc1
  buffer_load_dwordx2 v[114:115], v4, s[8:11], s35 offen offset:256 sc1
  s_waitcnt vmcnt(12) lgkmcnt(2)
  v_mfma_f32_32x32x16_bf16 v[16:31], a[4:7], v[96:99], v[16:31]
  ds_read_b128 v[108:111], v1 offset:5120
  buffer_load_dwordx2 v[116:117], v4, s[8:11], s35 offen offset:512 sc1
  v_bfe_u32 v7, v0, 4, 1
  s_waitcnt lgkmcnt(2)
  v_mfma_f32_32x32x16_bf16 v[32:47], a[4:7], v[100:103], v[32:47]
  ds_read_b128 v[88:91], v1 offset:6144
  buffer_load_dwordx4 a[44:47], v1, s[8:11], s34 offen offset:3072 sc1
  s_add_u32 s34, s34, 4096
  buffer_load_dwordx2 v[118:119], v4, s[8:11], s35 offen offset:768 sc1
  v_lshlrev_b32 v137, 4, v7
  s_waitcnt vmcnt(14) lgkmcnt(2)
  v_mfma_f32_32x32x16_bf16 v[16:31], a[8:11], v[104:107], v[16:31]
  ds_read_b128 v[92:95], v1 offset:7168
  buffer_load_dwordx2 v[120:121], v4, s[8:11], s35 offen offset:1024 sc1
  v_bfe_u32 v7, v0, 2, 1
  s_waitcnt lgkmcnt(2)
  v_mfma_f32_32x32x16_bf16 v[32:47], a[8:11], v[108:111], v[32:47]
  ds_read_b128 v[96:99], v1 offset:8192
  buffer_load_dwordx4 a[48:51], v1, s[8:11], s34 offen offset:0 sc1
  buffer_load_dwordx2 v[122:123], v4, s[8:11], s35 offen offset:1280 sc1
  v_lshl_add_u32 v137, v7, 3, v137
  s_waitcnt vmcnt(16) lgkmcnt(2)
  v_mfma_f32_32x32x16_bf16 v[16:31], a[12:15], v[88:91], v[16:31]
  ds_read_b128 v[100:103], v1 offset:9216
  buffer_load_dwordx2 v[124:125], v4, s[8:11], s35 offen offset:1536 sc1
  v_bfe_u32 v7, v0, 3, 1
  s_waitcnt lgkmcnt(2)
  v_mfma_f32_32x32x16_bf16 v[32:47], a[12:15], v[92:95], v[32:47]
  ds_read_b128 v[104:107], v1 offset:10240
  buffer_load_dwordx4 a[52:55], v1, s[8:11], s34 offen offset:1024 sc1
  buffer_load_dwordx2 v[126:127], v4, s[8:11], s35 offen offset:1792 sc1
  v_lshl_add_u32 v137, v7, 2, v137
  s_waitcnt vmcnt(18) lgkmcnt(2)
  v_mfma_f32_32x32x16_bf16 v[16:31], a[16:19], v[96:99], v[16:31]
  ds_read_b128 v[108:111], v1 offset:11264
  v_and_b32 v7, 3, v0
  v_add_u32 v137, v137, v7
  s_waitcnt lgkmcnt(2)
  v_mfma_f32_32x32x16_bf16 v[32:47], a[16:19], v[100:103], v[32:47]
  ds_read_b128 v[88:91], v1 offset:12288
  buffer_load_dwordx4 a[56:59], v1, s[8:11], s34 offen offset:2048 sc1
  s_mul_i32 s16, s20, 2176
  s_waitcnt vmcnt(18) lgkmcnt(2)
  v_mfma_f32_32x32x16_bf16 v[16:31], a[20:23], v[104:107], v[16:31]
  ds_read_b128 v[92:95], v1 offset:13312
  s_add_u32 s16, s16, 98304
  s_waitcnt lgkmcnt(2)
  v_mfma_f32_32x32x16_bf16 v[32:47], a[20:23], v[108:111], v[32:47]
  ds_read_b128 v[96:99], v1 offset:14336
  buffer_load_dwordx4 a[60:63], v1, s[8:11], s34 offen offset:3072 sc1
  s_add_u32 s34, s34, 4096
  v_lshl_add_u32 v137, v137, 2, s16
  s_waitcnt vmcnt(18) lgkmcnt(2)
  v_mfma_f32_32x32x16_bf16 v[16:31], a[24:27], v[88:91], v[16:31]
  ds_read_b128 v[100:103], v1 offset:15360
  v_lshl_add_u32 v136, v2, 6, s16
  s_waitcnt lgkmcnt(2)
  v_mfma_f32_32x32x16_bf16 v[32:47], a[24:27], v[92:95], v[32:47]
  ds_read_b128 v[104:107], v1 offset:16384
  buffer_load_dwordx4 a[64:67], v1, s[8:11], s34 offen offset:0 sc1
  v_lshl_add_u32 v136, v3, 5, v136
  s_waitcnt vmcnt(18) lgkmcnt(2)
  v_mfma_f32_32x32x16_bf16 v[16:31], a[28:31], v[96:99], v[16:31]
  ds_read_b128 v[108:111], v1 offset:17408
  s_lshl_b32 s16, s20, 9
  v_lshl_add_u32 v138, v0, 3, s16
  s_waitcnt lgkmcnt(2)
  v_mfma_f32_32x32x16_bf16 v[32:47], a[28:31], v[100:103], v[32:47]
  ds_read_b128 v[88:91], v1 offset:18432
  buffer_load_dwordx4 a[68:71], v1, s[8:11], s34 offen offset:1024 sc1
  v_add_u32 v139, 98304, v138
  s_waitcnt vmcnt(18) lgkmcnt(2)
  v_mfma_f32_32x32x16_bf16 v[16:31], a[32:35], v[104:107], v[16:31]
  ds_read_b128 v[92:95], v1 offset:19456
  s_lshl_b32 s16, s20, 5
  s_waitcnt lgkmcnt(2)
  v_mfma_f32_32x32x16_bf16 v[32:47], a[32:35], v[108:111], v[32:47]
  ds_read_b128 v[96:99], v1 offset:20480
  buffer_load_dwordx4 a[72:75], v1, s[8:11], s34 offen offset:2048 sc1
  s_add_u32 s16, s16, 2048
  s_waitcnt vmcnt(18) lgkmcnt(2)
  v_mfma_f32_32x32x16_bf16 v[16:31], a[36:39], v[88:91], v[16:31]
  ds_read_b128 v[100:103], v1 offset:21504
  v_and_b32 v7, 7, v0
  s_waitcnt lgkmcnt(2)
  v_mfma_f32_32x32x16_bf16 v[32:47], a[36:39], v[92:95], v[32:47]
  ds_read_b128 v[104:107], v1 offset:22528
  buffer_load_dwordx4 a[76:79], v1, s[8:11], s34 offen offset:3072 sc1
  s_add_u32 s34, s34, 4096
  v_lshl_add_u32 v142, v7, 2, s16
  s_waitcnt vmcnt(16) lgkmcnt(2)
  v_mfma_f32_32x32x16_bf16 v[16:31], a[40:43], v[96:99], v[16:31]
  ds_read_b128 v[108:111], v1 offset:23552
  v_add_u32 v143, 98304, v142
  s_mul_i32 s39, s26, 557056
  s_waitcnt lgkmcnt(2)
  v_mfma_f32_32x32x16_bf16 v[32:47], a[40:43], v[100:103], v[32:47]
  ds_read_b128 v[88:91], v1 offset:24576
  buffer_load_dwordx4 a[80:83], v1, s[8:11], s34 offen offset:0 sc1
  s_mul_i32 s16, s22, 34816
  s_waitcnt vmcnt(14) lgkmcnt(2)
  v_mfma_f32_32x32x16_bf16 v[16:31], a[44:47], v[104:107], v[16:31]
  ds_read_b128 v[92:95], v1 offset:25600
  s_add_u32 s39, s39, s16
  s_waitcnt lgkmcnt(2)
  v_mfma_f32_32x32x16_bf16 v[32:47], a[44:47], v[108:111], v[32:47]
  ds_read_b128 v[96:99], v1 offset:26624
  buffer_load_dwordx4 a[84:87], v1, s[8:11], s34 offen offset:1024 sc1
  s_add_u32 s39, s39, 35913728
  s_waitcnt vmcnt(12) lgkmcnt(2)
  v_mfma_f32_32x32x16_bf16 v[16:31], a[48:51], v[88:91], v[16:31]
  ds_read_b128 v[100:103], v1 offset:27648
  s_mul_i32 s16, s21, 2176
  s_waitcnt lgkmcnt(2)
  v_mfma_f32_32x32x16_bf16 v[32:47], a[48:51], v[92:95], v[32:47]
  ds_read_b128 v[104:107], v1 offset:28672
  buffer_load_dwordx4 a[88:91], v1, s[8:11], s34 offen offset:2048 sc1
  s_add_u32 s37, s39, s16
  s_waitcnt vmcnt(10) lgkmcnt(2)
  v_mfma_f32_32x32x16_bf16 v[16:31], a[52:55], v[96:99], v[16:31]
  ds_read_b128 v[108:111], v1 offset:29696
  v_and_b32 v7, 16, v0
  v_cmp_eq_u32 s[64:65], 0, v7
  s_waitcnt lgkmcnt(2)
  v_mfma_f32_32x32x16_bf16 v[32:47], a[52:55], v[100:103], v[32:47]
  ds_read_b128 v[88:91], v1 offset:30720
  buffer_load_dwordx4 a[92:95], v1, s[8:11], s34 offen offset:3072 sc1
  s_add_u32 s34, s34, 4096
  v_add_f32 v128, v112, v114
  v_add_f32 v129, v113, v115
  s_waitcnt vmcnt(9) lgkmcnt(2)
  v_mfma_f32_32x32x16_bf16 v[16:31], a[56:59], v[104:107], v[16:31]
  ds_read_b128 v[92:95], v1 offset:31744
  v_add_f32 v128, v128, v116
  v_add_f32 v129, v129, v117
  s_waitcnt lgkmcnt(2)
  v_mfma_f32_32x32x16_bf16 v[32:47], a[56:59], v[108:111], v[32:47]
  ds_read_b128 v[96:99], v1 offset:32768
  buffer_load_dwordx4 a[96:99], v1, s[8:11], s34 offen offset:0 sc1
  v_add_f32 v128, v128, v118
  v_add_f32 v129, v129, v119
  s_waitcnt vmcnt(9) lgkmcnt(2)
  v_mfma_f32_32x32x16_bf16 v[16:31], a[60:63], v[88:91], v[16:31]
  ds_read_b128 v[100:103], v1 offset:33792
  v_add_f32 v128, v128, v120
  v_add_f32 v129, v129, v121
  v_add_f32 v128, v128, v122
  s_waitcnt lgkmcnt(2)
  v_mfma_f32_32x32x16_bf16 v[32:47], a[60:63], v[92:95], v[32:47]
  ds_read_b128 v[104:107], v1 offset:34816
  buffer_load_dwordx4 a[100:103], v1, s[8:11], s34 offen offset:1024 sc1
  v_add_f32 v129, v129, v123
  v_add_f32 v128, v128, v124
  s_waitcnt vmcnt(9) lgkmcnt(2)
  v_mfma_f32_32x32x16_bf16 v[16:31], a[64:67], v[96:99], v[16:31]
  ds_read_b128 v[108:111], v1 offset:35840
  v_add_f32 v129, v129, v125
  v_add_f32 v128, v128, v126
  s_waitcnt lgkmcnt(2)
  v_mfma_f32_32x32x16_bf16 v[32:47], a[64:67], v[100:103], v[32:47]
  ds_read_b128 v[88:91], v1 offset:36864
  buffer_load_dwordx4 a[104:107], v1, s[8:11], s34 offen offset:2048 sc1
  v_add_f32 v129, v129, v127
  v_mov_b32 v130, v128
  s_waitcnt vmcnt(9) lgkmcnt(2)
  v_mfma_f32_32x32x16_bf16 v[16:31], a[68:71], v[104:107], v[16:31]
  ds_read_b128 v[92:95], v1 offset:37888
  v_permlane32_swap_b32 v130, v128
  v_add_f32 v128, v130, v128
  v_mul_f32 v128, 0x3d800000, v128
  s_waitcnt lgkmcnt(2)
  v_mfma_f32_32x32x16_bf16 v[32:47], a[68:71], v[108:111], v[32:47]
  ds_read_b128 v[96:99], v1 offset:38912
  buffer_load_dwordx4 a[108:111], v1, s[8:11], s34 offen offset:3072 sc1
  s_add_u32 s34, s34, 4096
  v_sub_f32 v112, v112, v128
  v_sub_f32 v114, v114, v128
  s_waitcnt vmcnt(9) lgkmcnt(2)
  v_mfma_f32_32x32x16_bf16 v[16:31], a[72:75], v[88:91], v[16:31]
  ds_read_b128 v[100:103], v1 offset:39936
  v_sub_f32 v116, v116, v128
  v_sub_f32 v118, v118, v128
  s_waitcnt lgkmcnt(2)
  v_mfma_f32_32x32x16_bf16 v[32:47], a[72:75], v[92:95], v[32:47]
  ds_read_b128 v[104:107], v1 offset:40960
  buffer_load_dwordx4 a[112:115], v1, s[8:11], s34 offen offset:0 sc1
  v_sub_f32 v120, v120, v128
  v_sub_f32 v122, v122, v128
  s_waitcnt vmcnt(9) lgkmcnt(2)
  v_mfma_f32_32x32x16_bf16 v[16:31], a[76:79], v[96:99], v[16:31]
  ds_read_b128 v[108:111], v1 offset:41984
  v_sub_f32 v124, v124, v128
  v_sub_f32 v126, v126, v128
  v_mul_f32 v130, v112, v112
  s_waitcnt lgkmcnt(2)
  v_mfma_f32_32x32x16_bf16 v[32:47], a[76:79], v[100:103], v[32:47]
  ds_read_b128 v[88:91], v1 offset:43008
  buffer_load_dwordx4 a[116:119], v1, s[8:11], s34 offen offset:1024 sc1
  v_fmac_f32 v130, v114, v114
  v_fmac_f32 v130, v116, v116
  s_waitcnt vmcnt(9) lgkmcnt(2)
  v_mfma_f32_32x32x16_bf16 v[16:31], a[80:83], v[104:107], v[16:31]
  ds_read_b128 v[92:95], v1 offset:44032
  v_fmac_f32 v130, v118, v118
  v_fmac_f32 v130, v120, v120
  s_waitcnt lgkmcnt(2)
  v_mfma_f32_32x32x16_bf16 v[32:47], a[80:83], v[108:111], v[32:47]
  ds_read_b128 v[96:99], v1 offset:45056
  buffer_load_dwordx4 a[120:123], v1, s[8:11], s34 offen offset:2048 sc1
  v_fmac_f32 v130, v122, v122
  v_fmac_f32 v130, v124, v124
  s_waitcnt vmcnt(9) lgkmcnt(2)
  v_mfma_f32_32x32x16_bf16 v[16:31], a[84:87], v[88:91], v[16:31]
  ds_read_b128 v[100:103], v1 offset:46080
  v_fmac_f32 v130, v126, v126
  v_fmamk_f32 v129, v130, 0x42000000, v129
  v_mov_b32 v130, v129
  s_waitcnt lgkmcnt(2)
  v_mfma_f32_32x32x16_bf16 v[32:47], a[84:87], v[92:95], v[32:47]
  ds_read_b128 v[104:107], v1 offset:47104
  buffer_load_dwordx4 a[124:127], v1, s[8:11], s34 offen offset:3072 sc1
  s_add_u32 s34, s34, 4096
  v_permlane32_swap_b32 v130, v129
  v_add_f32 v129, v130, v129
  s_waitcnt vmcnt(9) lgkmcnt(2)
  v_mfma_f32_32x32x16_bf16 v[16:31], a[88:91], v[96:99], v[16:31]
  ds_read_b128 v[108:111], v1 offset:48128
  s_add_u32 m0, s31, 65536
  s_nop 0
  buffer_load_dwordx4 v1, s[8:11], s32 offen offset:0 sc1 lds
  v_mov_b32 v130, 0x3727c5ac
  v_fmamk_f32 v129, v129, 0x3b000000, v130
  s_waitcnt lgkmcnt(2)
  v_mfma_f32_32x32x16_bf16 v[32:47], a[88:91], v[100:103], v[32:47]
  ds_read_b128 v[88:91], v1 offset:49152
  s_add_u32 m0, s31, 65536
  s_nop 0
  buffer_load_dwordx4 v1, s[8:11], s32 offen offset:1024 sc1 lds
  v_rsq_f32 v129, v129
  v_sub_f32 v130, 0, v128
  v_cvt_pk_bf16_f32 v133, v130, 0
  s_waitcnt vmcnt(10) lgkmcnt(2)
  v_mfma_f32_32x32x16_bf16 v[16:31], a[92:95], v[104:107], v[16:31]
  ds_read_b128 v[92:95], v1 offset:50176
  v_lshlrev_b32 v131, 16, v133
  v_sub_f32 v131, v130, v131
  s_waitcnt lgkmcnt(2)
  v_mfma_f32_32x32x16_bf16 v[32:47], a[92:95], v[108:111], v[32:47]
  ds_read_b128 v[96:99], v1 offset:51200
  s_add_u32 m0, s31, 65536
  s_nop 0
  buffer_load_dwordx4 v1, s[8:11], s32 offen offset:2048 sc1 lds
  v_cvt_pk_bf16_f32 v132, v130, v131
  v_mov_b32 v135, 0
  s_waitcnt vmcnt(10) lgkmcnt(2)
  v_mfma_f32_32x32x16_bf16 v[16:31], a[96:99], v[88:91], v[16:31]
  ds_read_b128 v[100:103], v1 offset:52224
  v_mov_b32 v134, 0
  s_lshl_b32 s16, s20, 7
  s_waitcnt lgkmcnt(2)
  v_mfma_f32_32x32x16_bf16 v[32:47], a[96:99], v[92:95], v[32:47]
  ds_read_b128 v[104:107], v1 offset:53248
  s_add_u32 m0, s31, 65536
  s_nop 0
  buffer_load_dwordx4 v1, s[8:11], s32 offen offset:3072 sc1 lds
  s_add_u32 s32, s32, 16384
  s_add_u32 s16, s16, 161792
  v_lshl_add_u32 v7, v2, 2, s16
  ds_write_b32 v7, v129
  s_waitcnt vmcnt(10) lgkmcnt(3)
  v_mfma_f32_32x32x16_bf16 v[16:31], a[100:103], v[96:99], v[16:31]
  ds_read_b128 v[108:111], v1 offset:54272
  v_lshl_add_u32 v7, v3, 4, s16
  ds_read_b128 v[112:115], v7 offset:0
  s_waitcnt lgkmcnt(4)
  v_mfma_f32_32x32x16_bf16 v[32:47], a[100:103], v[100:103], v[32:47]
  ds_read_b128 v[88:91], v1 offset:55296
  s_add_u32 m0, s31, 81920
  s_nop 0
  buffer_load_dwordx4 v1, s[8:11], s32 offen offset:0 sc1 lds
  ds_read_b128 v[116:119], v7 offset:32
  ds_read_b128 v[120:123], v7 offset:64
  s_waitcnt vmcnt(10) lgkmcnt(6)
  v_mfma_f32_32x32x16_bf16 v[16:31], a[104:107], v[104:107], v[16:31]
  ds_read_b128 v[92:95], v1 offset:56320
  ds_read_b128 v[124:127], v7 offset:96
  s_mov_b32 s38, 0x3fb8aa3b
  s_waitcnt lgkmcnt(6)
  v_mfma_f32_32x32x16_bf16 v[32:47], a[104:107], v[108:111], v[32:47]
  ds_read_b128 v[96:99], v1 offset:57344
  s_add_u32 m0, s31, 81920
  s_nop 0
  buffer_load_dwordx4 v1, s[8:11], s32 offen offset:1024 sc1 lds
  v_mul_f32 v128, s38, v129
  s_mov_b32 s40, 0x358637bd
  s_mov_b32 s41, 0x358637bd
  s_waitcnt vmcnt(10) lgkmcnt(5)
  v_mfma_f32_32x32x16_bf16 v[16:31], a[108:111], v[88:91], v[16:31]
  ds_read_b128 v[100:103], v1 offset:58368
  v_mul_f32 v144, s38, v112
  v_mul_f32 v145, s38, v113
  s_waitcnt lgkmcnt(3)
  v_mfma_f32_32x32x16_bf16 v[32:47], a[108:111], v[92:95], v[32:47]
  ds_read_b128 v[104:107], v1 offset:59392
  s_add_u32 m0, s31, 81920
  s_nop 0
  buffer_load_dwordx4 v1, s[8:11], s32 offen offset:2048 sc1 lds
  v_mul_f32 v146, s38, v114
  v_mul_f32 v147, s38, v115
  s_waitcnt vmcnt(10) lgkmcnt(2)
  v_mfma_f32_32x32x16_bf16 v[16:31], a[112:115], v[96:99], v[16:31]
  ds_read_b128 v[108:111], v1 offset:60416
  v_mul_f32 v148, s38, v116
  v_mul_f32 v149, s38, v117
  s_waitcnt lgkmcnt(2)
  v_mfma_f32_32x32x16_bf16 v[32:47], a[112:115], v[100:103], v[32:47]
  ds_read_b128 v[88:91], v1 offset:61440
  s_add_u32 m0, s31, 81920
  s_nop 0
  buffer_load_dwordx4 v1, s[8:11], s32 offen offset:3072 sc1 lds
  s_add_u32 s32, s32, 16384
  v_mul_f32 v150, s38, v118
  v_mul_f32 v151, s38, v119
  v_mul_f32 v152, s38, v120
  s_waitcnt vmcnt(10) lgkmcnt(2)
  v_mfma_f32_32x32x16_bf16 v[16:31], a[116:119], v[104:107], v[16:31]
  ds_read_b128 v[92:95], v1 offset:62464
  v_mul_f32 v153, s38, v121
  v_mul_f32 v154, s38, v122
  s_waitcnt lgkmcnt(2)
  v_mfma_f32_32x32x16_bf16 v[32:47], a[116:119], v[108:111], v[32:47]
  ds_read_b128 v[96:99], v1 offset:63488
  v_mov_b32 v68, -1
  v_mov_b32 v69, -1
  v_mov_b32 v70, -1
  v_mov_b32 v71, -1
  v_mul_f32 v155, s38, v123
  v_mul_f32 v156, s38, v124
  s_waitcnt vmcnt(9) lgkmcnt(2)
  v_mfma_f32_32x32x16_bf16 v[16:31], a[120:123], v[88:91], v[16:31]
  ds_read_b128 v[100:103], v1 offset:64512
  v_mul_f32 v157, s38, v125
  v_mul_f32 v158, s38, v126
  v_mul_f32 v159, s38, v127
  s_waitcnt lgkmcnt(2)
  v_mfma_f32_32x32x16_bf16 v[32:47], a[120:123], v[92:95], v[32:47]
  ds_read_b128 v[104:107], v6 offset:16384
  s_mul_i32 s17, s26, 4194304
  s_add_u32 s17, s17, s28
  s_add_u32 s17, s17, 9699328
  s_mul_i32 s19, s26, 524288
  s_add_u32 s19, s19, s29
  s_add_u32 s19, s19, 16252928
  buffer_store_dwordx4 v[68:71], v1, s[8:11], s17 offen sc1
  s_waitcnt vmcnt(9) lgkmcnt(2)
  v_mfma_f32_32x32x16_bf16 v[16:31], a[124:127], v[96:99], v[16:31]
  ds_read_b128 v[108:111], v6 offset:17408
  s_waitcnt lgkmcnt(2)
  v_mfma_f32_32x32x16_bf16 v[32:47], a[124:127], v[100:103], v[32:47]
  buffer_store_dwordx4 v[68:71], v1, s[8:11], s17 offen offset:1024 sc1
  s_waitcnt lgkmcnt(1)
  v_mfma_f32_32x32x16_bf16 v[16:31], v[132:135], v[104:107], v[16:31]
  s_waitcnt lgkmcnt(0)
  v_mfma_f32_32x32x16_bf16 v[32:47], v[132:135], v[108:111], v[32:47]
  buffer_store_dwordx2 v[68:69], v12, s[8:11], s19 offen sc1
L_fast_epi:
  s_nop 8
  v_pk_mul_f32 v[140:141], v[16:17], v[144:145]
  v_pk_fma_f32 v[16:17], v[16:17], v[112:113], s[40:41]
  v_exp_f32_e64 v140, v140 clamp
  v_exp_f32_e64 v141, v141 clamp
  v_pk_mul_f32 v[32:33], v[32:33], v[112:113]
  v_max_f32 v16, s40, v16
  v_max_f32 v17, s40, v17
  v_cvt_pk_bf16_f32 v104, v32, v33
  v_pk_add_f32 v[16:17], v[16:17], v[140:141]
  v_cvt_pk_bf16_f32 v96, v16, v17
  v_pk_mul_f32 v[130:131], v[18:19], v[146:147]
  v_pk_fma_f32 v[18:19], v[18:19], v[114:115], s[40:41]
  v_exp_f32_e64 v130, v130 clamp
  v_exp_f32_e64 v131, v131 clamp
  v_pk_mul_f32 v[34:35], v[34:35], v[114:115]
  v_max_f32 v18, s40, v18
  v_max_f32 v19, s40, v19
  v_cvt_pk_bf16_f32 v105, v34, v35
  v_pk_add_f32 v[18:19], v[18:19], v[130:131]
  v_cvt_pk_bf16_f32 v97, v18, v19
  v_pk_mul_f32 v[140:141], v[20:21], v[148:149]
  v_pk_fma_f32 v[20:21], v[20:21], v[116:117], s[40:41]
  v_exp_f32_e64 v140, v140 clamp
  v_exp_f32_e64 v141, v141 clamp
  v_pk_mul_f32 v[36:37], v[36:37], v[116:117]
  v_max_f32 v20, s40, v20
  v_max_f32 v21, s40, v21
  v_cvt_pk_bf16_f32 v106, v36, v37
  v_pk_add_f32 v[20:21], v[20:21], v[140:141]
  v_cvt_pk_bf16_f32 v98, v20, v21
  v_pk_mul_f32 v[130:131], v[22:23], v[150:151]
  v_pk_fma_f32 v[22:23], v[22:23], v[118:119], s[40:41]
  v_exp_f32_e64 v130, v130 clamp
  v_exp_f32_e64 v131, v131 clamp
  v_pk_mul_f32 v[38:39], v[38:39], v[118:119]
  v_max_f32 v22, s40, v22
  v_max_f32 v23, s40, v23
  v_cvt_pk_bf16_f32 v107, v38, v39
  v_pk_add_f32 v[22:23], v[22:23], v[130:131]
  v_cvt_pk_bf16_f32 v99, v22, v23
  s_nop 1
  v_mfma_f32_32x32x16_bf16 v[64:79], v[96:99], v[104:107], 0
  v_pk_mul_f32 v[140:141], v[24:25], v[152:153]
  v_pk_fma_f32 v[24:25], v[24:25], v[120:121], s[40:41]
  v_exp_f32_e64 v140, v140 clamp
  v_exp_f32_e64 v141, v141 clamp
  v_pk_mul_f32 v[40:41], v[40:41], v[120:121]
  v_max_f32 v24, s40, v24
  v_max_f32 v25, s40, v25
  v_cvt_pk_bf16_f32 v108, v40, v41
  v_pk_add_f32 v[24:25], v[24:25], v[140:141]
  v_cvt_pk_bf16_f32 v100, v24, v25
  v_pk_mul_f32 v[130:131], v[26:27], v[154:155]
  v_pk_fma_f32 v[26:27], v[26:27], v[122:123], s[40:41]
  v_exp_f32_e64 v130, v130 clamp
  v_exp_f32_e64 v131, v131 clamp
  v_pk_mul_f32 v[42:43], v[42:43], v[122:123]
  v_max_f32 v26, s40, v26
  v_max_f32 v27, s40, v27
  v_cvt_pk_bf16_f32 v109, v42, v43
  v_pk_add_f32 v[26:27], v[26:27], v[130:131]
  v_cvt_pk_bf16_f32 v101, v26, v27
  v_pk_mul_f32 v[140:141], v[28:29], v[156:157]
  v_pk_fma_f32 v[28:29], v[28:29], v[124:125], s[40:41]
  v_exp_f32_e64 v140, v140 clamp
  v_exp_f32_e64 v141, v141 clamp
  v_pk_mul_f32 v[44:45], v[44:45], v[124:125]
  v_max_f32 v28, s40, v28
  v_max_f32 v29, s40, v29
  v_cvt_pk_bf16_f32 v110, v44, v45
  v_pk_add_f32 v[28:29], v[28:29], v[140:141]
  v_cvt_pk_bf16_f32 v102, v28, v29
  v_pk_mul_f32 v[130:131], v[30:31], v[158:159]
  v_pk_fma_f32 v[30:31], v[30:31], v[126:127], s[40:41]
  v_exp_f32_e64 v130, v130 clamp
  v_exp_f32_e64 v131, v131 clamp
  v_pk_mul_f32 v[46:47], v[46:47], v[126:127]
  v_max_f32 v30, s40, v30
  v_max_f32 v31, s40, v31
  v_cvt_pk_bf16_f32 v111, v46, v47
  v_pk_add_f32 v[30:31], v[30:31], v[130:131]
  v_cvt_pk_bf16_f32 v103, v30, v31
  s_nop 1
  v_mfma_f32_32x32x16_bf16 v[64:79], v[100:103], v[108:111], v[64:79]
  v_pk_add_f32 v[16:17], v[16:17], v[20:21]
  v_pk_add_f32 v[18:19], v[18:19], v[22:23]
  v_pk_add_f32 v[16:17], v[16:17], v[24:25]
  v_pk_add_f32 v[18:19], v[18:19], v[26:27]
  v_pk_add_f32 v[16:17], v[16:17], v[28:29]
  v_pk_add_f32 v[18:19], v[18:19], v[30:31]
  v_pk_add_f32 v[16:17], v[16:17], v[18:19]
  v_add_f32 v16, v16, v17
  v_mov_b32 v130, v16
  s_nop 1
  v_permlane32_swap_b32 v130, v16
  v_add_f32 v16, v130, v16
  s_cmp_lg_u32 s97, 0
  s_cbranch_scc1 L_fast_k1ok
  v_cmp_u_f32 vcc, v64, v64
  s_nop 0
  s_cbranch_vccnz L_fast_k1redo
L_fast_k1ok:
  ds_write_b32 v137, v16 offset:2048
  s_mov_b64 exec, s[64:65]
  ds_write_b128 v136, v[64:67]
  ds_write_b128 v136, v[68:71] offset:16
  s_not_b64 exec, exec
  ds_write_b128 v136, v[72:75]
  ds_write_b128 v136, v[76:79] offset:16
  s_mov_b64 exec, -1
  s_cmp_lg_u32 s26, 0
  s_cbranch_scc1 lay_5_1
  s_waitcnt vmcnt(6)
  s_branch lay_5_2
lay_5_1:
  s_waitcnt vmcnt(3)
lay_5_2:
  s_waitcnt lgkmcnt(0)
  s_barrier
  ds_read_b64 v[16:17], v139 offset:0
  ds_read_b32 v24, v143 offset:0
  ds_read_b64 v[18:19], v139 offset:2176
  ds_read_b32 v25, v143 offset:2176
  ds_read_b64 v[20:21], v139 offset:4352
  ds_read_b32 v26, v143 offset:4352
  ds_read_b64 v[22:23], v139 offset:6528
  ds_read_b32 v27, v143 offset:6528
  ds_read_b128 v[88:91], v5 offset:16384
  ds_read_b128 v[92:95], v5 offset:17408
  ds_read_b128 v[96:99], v5 offset:18432
  s_waitcnt lgkmcnt(8)
  v_pk_add_f32 v[16:17], v[16:17], v[18:19]
  s_waitcnt lgkmcnt(7)
  v_add_f32 v24, v24, v25
  s_waitcnt lgkmcnt(4)
  v_pk_add_f32 v[20:21], v[20:21], v[22:23]
  s_waitcnt lgkmcnt(3)
  v_add_f32 v26, v26, v27
  v_pk_add_f32 v[16:17], v[16:17], v[20:21]
  v_add_f32 v24, v24, v26
  v_min_u32 v16, -2, v16
  v_min_u32 v17, -2, v17
  v_min_u32 v24, -2, v24
  buffer_store_dwordx2 v[16:17], v138, s[8:11], s37 offen sc1
  buffer_store_dword v24, v142, s[8:11], s37 offen sc1
  s_mul_i32 s32, s22, 229376
  s_add_u32 s32, s32, s31
  s_add_u32 s32, s32, 2097152
  s_cmp_lg_u32 s26, 0
  s_cbranch_scc1 lay_6_1
  s_and_b32 s96, s33, 4294967039
  s_add_u32 s96, s96, 128
  v_and_b32 v233, 1, v0
  v_lshlrev_b32 v233, 8, v233
  s_mul_i32 s36, s25, 229376
  s_mul_i32 s16, s20, 57344
  s_add_u32 s36, s36, s16
  s_add_u32 s36, s36, 5767168
  s_waitcnt lgkmcnt(2)
  ds_read_b64_tr_b16 v[88:89], v171 offset:49152
  ds_read_b64_tr_b16 v[90:91], v171 offset:49408
  s_waitcnt lgkmcnt(3)
  ds_read_b64_tr_b16 v[92:93], v171 offset:52224
  ds_read_b64_tr_b16 v[94:95], v171 offset:52480
  s_waitcnt lgkmcnt(4)
  ds_read_b64_tr_b16 v[96:97], v171 offset:55296
  ds_read_b64_tr_b16 v[98:99], v171 offset:55552
  s_waitcnt lgkmcnt(4)
  v_mfma_f32_32x32x16_bf16 v[48:63], v[88:91], a[64:67], 0
  ds_read_b64_tr_b16 v[100:101], v171 offset:58368
  ds_read_b64_tr_b16 v[102:103], v171 offset:58624
  s_lshl_b32 s34, s25, 16
  s_lshl_b32 s17, s20, 14
  s_add_u32 s34, s34, s17
  s_add_u32 s34, s34, 1572864
  v_mul_u32_u24 v136, 2176, v3
  v_lshl_add_u32 v136, v2, 4, v136
  v_lshrrev_b32 v137, 2, v0
  s_waitcnt lgkmcnt(4)
  v_mfma_f32_32x32x16_bf16 v[48:63], v[92:95], a[68:71], v[48:63]
  ds_read_b64_tr_b16 v[104:105], v171 offset:61440
  ds_read_b64_tr_b16 v[106:107], v171 offset:61696
  buffer_load_dwordx4 a[64:67], v10, s[8:11], s34 offen offset:0 sc1
  v_mul_u32_u24 v137, 2176, v137
  v_and_b32 v138, 3, v0
  v_lshl_add_u32 v137, v138, 3, v137
  s_waitcnt lgkmcnt(4)
  v_mfma_f32_32x32x16_bf16 v[48:63], v[96:99], a[72:75], v[48:63]
  ds_read_b64_tr_b16 v[108:109], v171 offset:64512
  ds_read_b64_tr_b16 v[110:111], v171 offset:64768
  buffer_load_dwordx4 a[68:71], v11, s[8:11], s34 offen offset:0 sc1
  s_lshl_b32 s17, s20, 9
  s_add_u32 s37, s39, s17
  s_lshl_b32 s17, s20, 5
  s_waitcnt lgkmcnt(4)
  v_mfma_f32_32x32x16_bf16 v[48:63], v[100:103], a[76:79], v[48:63]
  ds_read_b64_tr_b16 v[88:89], v227 offset:2048
  ds_read_b64_tr_b16 v[90:91], v227 offset:2304
  buffer_load_dwordx4 a[72:75], v10, s[8:11], s34 offen offset:2048 sc1
  s_add_u32 s44, s39, s17
  s_lshr_b32 s16, s20, 1
  s_lshl_b32 s17, s16, 6
  s_lshl_b32 s18, s20, 9
  s_waitcnt lgkmcnt(4)
  v_mfma_f32_32x32x16_bf16 v[48:63], v[104:107], a[80:83], v[48:63]
  ds_read_b64_tr_b16 v[92:93], v227 offset:5120
  ds_read_b64_tr_b16 v[94:95], v227 offset:5376
  buffer_load_dwordx4 a[76:79], v11, s[8:11], s34 offen offset:2048 sc1
  s_add_u32 s34, s34, 4096
  s_add_u32 s17, s17, s18
  s_add_u32 s17, s17, 158720
  v_lshl_add_u32 v142, v2, 4, s17
  s_waitcnt lgkmcnt(4)
  v_mfma_f32_32x32x16_bf16 v[48:63], v[108:111], a[84:87], v[48:63]
  ds_read_b64_tr_b16 v[96:97], v227 offset:8192
  ds_read_b64_tr_b16 v[98:99], v227 offset:8448
  s_mul_i32 s16, s16, 1088
  s_and_b32 s17, s20, 1
  s_lshl_b32 s17, s17, 5
  s_waitcnt lgkmcnt(4)
  v_mfma_f32_32x32x16_bf16 v[48:63], v[88:91], a[88:91], v[48:63]
  ds_read_b64_tr_b16 v[100:101], v227 offset:11264
  ds_read_b64_tr_b16 v[102:103], v227 offset:11520
  s_add_u32 s16, s16, s17
  s_add_u32 s16, s16, 159744
  v_lshl_add_u32 v143, v138, 3, s16
  v_min_u32 v138, 16, v2
  s_waitcnt lgkmcnt(4)
  v_mfma_f32_32x32x16_bf16 v[48:63], v[92:95], a[92:95], v[48:63]
  ds_read_b64_tr_b16 v[104:105], v227 offset:14336
  ds_read_b64_tr_b16 v[106:107], v227 offset:14592
  v_lshlrev_b32 v138, 6, v138
  v_lshl_add_u32 v138, v3, 5, v138
  v_add_u32 v138, 158720, v138
  s_waitcnt lgkmcnt(4)
  v_mfma_f32_32x32x16_bf16 v[48:63], v[96:99], a[96:99], v[48:63]
  ds_read_b64_tr_b16 v[108:109], v227 offset:17408
  ds_read_b64_tr_b16 v[110:111], v227 offset:17664
  s_lshr_b32 s16, s23, 1
  s_lshl_b32 s17, s16, 7
  s_lshl_b32 s16, s16, 4
  s_waitcnt lgkmcnt(4)
  v_mfma_f32_32x32x16_bf16 v[48:63], v[100:103], a[100:103], v[48:63]
  ds_read_b64_tr_b16 v[88:89], v227 offset:20480
  ds_read_b64_tr_b16 v[90:91], v227 offset:20736
  s_add_u32 s16, s16, s22
  s_lshl_b32 s16, s16, 12
  s_and_b32 s18, s20, 1
  s_lshl_b32 s19, s18, 10
  s_waitcnt lgkmcnt(4)
  v_mfma_f32_32x32x16_bf16 v[48:63], v[104:107], a[104:107], v[48:63]
  ds_read_b64_tr_b16 v[92:93], v227 offset:23552
  ds_read_b64_tr_b16 v[94:95], v227 offset:23808
  s_add_u32 s16, s16, s19
  s_mul_i32 s19, s26, 2097152
  s_add_u32 s16, s16, s19
  s_waitcnt lgkmcnt(4)
  v_mfma_f32_32x32x16_bf16 v[48:63], v[108:111], a[108:111], v[48:63]
  ds_read_b64_tr_b16 v[96:97], v227 offset:26624
  ds_read_b64_tr_b16 v[98:99], v227 offset:26880
  s_add_u32 s45, s16, 17039360
  s_lshl_b32 s19, s22, 1
  s_add_u32 s18, s18, s19
  s_waitcnt lgkmcnt(4)
  v_mfma_f32_32x32x16_bf16 v[48:63], v[88:91], a[112:115], v[48:63]
  ds_read_b64_tr_b16 v[100:101], v227 offset:29696
  ds_read_b64_tr_b16 v[102:103], v227 offset:29952
  s_lshl_b32 s18, s18, 2
  s_add_u32 s47, s17, s18
  s_add_u32 s46, s47, 37396480
  s_add_u32 s47, s47, 37400576
  s_waitcnt lgkmcnt(4)
  v_mfma_f32_32x32x16_bf16 v[48:63], v[92:95], a[116:119], v[48:63]
  ds_read_b64_tr_b16 v[104:105], v171 offset:0
  ds_read_b64_tr_b16 v[106:107], v171 offset:256
  s_waitcnt vmcnt(11)
  ds_write_b128 v230, a[128:131]
  s_waitcnt vmcnt(10)
  ds_write_b128 v230, a[132:135] offset:1024
  s_waitcnt lgkmcnt(6)
  v_mfma_f32_32x32x16_bf16 v[48:63], v[96:99], a[120:123], v[48:63]
  ds_read_b64_tr_b16 v[108:109], v171 offset:3072
  ds_read_b64_tr_b16 v[110:111], v171 offset:3328
  ds_read_b64_tr_b16 v[196:197], v173 offset:0
  ds_read_b64_tr_b16 v[198:199], v173 offset:512
  s_waitcnt lgkmcnt(8)
  v_mfma_f32_32x32x16_bf16 v[48:63], v[100:103], a[124:127], v[48:63]
  ds_read_b64_tr_b16 v[88:89], v171 offset:6144
  ds_read_b64_tr_b16 v[90:91], v171 offset:6400
  ds_read_b64_tr_b16 v[204:205], v173 offset:32
  ds_read_b64_tr_b16 v[206:207], v173 offset:544
  s_waitcnt lgkmcnt(10)
  v_mfma_f32_32x32x16_bf16 v[48:63], v[104:107], a[0:3], v[48:63]
  ds_read_b64_tr_b16 v[92:93], v171 offset:9216
  ds_read_b64_tr_b16 v[94:95], v171 offset:9472
  s_waitcnt lgkmcnt(6)
  buffer_store_dwordx4 v[196:199], v1, s[8:11], s53 offen sc1
  v_mfma_f32_32x32x16_bf16 v[48:63], v[108:111], a[4:7], v[48:63]
  ds_read_b64_tr_b16 v[96:97], v171 offset:12288
  ds_read_b64_tr_b16 v[98:99], v171 offset:12544
  s_waitcnt lgkmcnt(4)
  buffer_store_dwordx4 v[204:207], v1, s[8:11], s55 offen sc1
  v_mfma_f32_32x32x16_bf16 v[48:63], v[88:91], a[8:11], v[48:63]
  ds_read_b64_tr_b16 v[100:101], v171 offset:15360
  ds_read_b64_tr_b16 v[102:103], v171 offset:15616
  s_waitcnt vmcnt(11)
  ds_write_b128 v230, a[136:139]
  s_waitcnt vmcnt(10)
  ds_write_b128 v230, a[140:143] offset:1024
  s_waitcnt lgkmcnt(6)
  v_mfma_f32_32x32x16_bf16 v[48:63], v[92:95], a[12:15], v[48:63]
  ds_read_b64_tr_b16 v[104:105], v171 offset:18432
  ds_read_b64_tr_b16 v[106:107], v171 offset:18688
  ds_read_b64_tr_b16 v[200:201], v173 offset:0
  ds_read_b64_tr_b16 v[202:203], v173 offset:512
  s_waitcnt lgkmcnt(8)
  v_mfma_f32_32x32x16_bf16 v[48:63], v[96:99], a[16:19], v[48:63]
  ds_read_b64_tr_b16 v[108:109], v171 offset:21504
  ds_read_b64_tr_b16 v[110:111], v171 offset:21760
  ds_read_b64_tr_b16 v[208:209], v173 offset:32
  ds_read_b64_tr_b16 v[210:211], v173 offset:544
  s_waitcnt lgkmcnt(10)
  v_mfma_f32_32x32x16_bf16 v[48:63], v[100:103], a[20:23], v[48:63]
  ds_read_b64_tr_b16 v[88:89], v171 offset:24576
  ds_read_b64_tr_b16 v[90:91], v171 offset:24832
  s_waitcnt lgkmcnt(6)
  buffer_store_dwordx4 v[200:203], v1, s[8:11], s54 offen sc1
  v_mfma_f32_32x32x16_bf16 v[48:63], v[104:107], a[24:27], v[48:63]
  ds_read_b64_tr_b16 v[92:93], v171 offset:27648
  ds_read_b64_tr_b16 v[94:95], v171 offset:27904
  s_waitcnt lgkmcnt(4)
  buffer_store_dwordx4 v[208:211], v1, s[8:11], s56 offen sc1
  v_mfma_f32_32x32x16_bf16 v[48:63], v[108:111], a[28:31], v[48:63]
  ds_read_b64_tr_b16 v[96:97], v171 offset:30720
  ds_read_b64_tr_b16 v[98:99], v171 offset:30976
  v_mfma_f32_32x32x16_bf16 a[152:167], v[176:179], v[196:199], 0
  v_mfma_f32_32x32x16_bf16 a[152:167], v[176:179], v[200:203], a[152:167]
  s_waitcnt lgkmcnt(4)
  v_mfma_f32_32x32x16_bf16 v[48:63], v[88:91], a[32:35], v[48:63]
  ds_read_b64_tr_b16 v[100:101], v171 offset:33792
  ds_read_b64_tr_b16 v[102:103], v171 offset:34048
  v_mfma_f32_32x32x16_bf16 a[168:183], v[176:179], v[204:207], 0
  v_mfma_f32_32x32x16_bf16 a[168:183], v[176:179], v[208:211], a[168:183]
  s_waitcnt lgkmcnt(4)
  v_mfma_f32_32x32x16_bf16 v[48:63], v[92:95], a[36:39], v[48:63]
  ds_read_b64_tr_b16 v[104:105], v171 offset:36864
  ds_read_b64_tr_b16 v[106:107], v171 offset:37120
  s_nop 0
  s_waitcnt lgkmcnt(4)
  v_mfma_f32_32x32x16_bf16 v[48:63], v[96:99], a[40:43], v[48:63]
  ds_read_b64_tr_b16 v[108:109], v171 offset:39936
  ds_read_b64_tr_b16 v[110:111], v171 offset:40192
  s_nop 0
  s_waitcnt lgkmcnt(4)
  v_mfma_f32_32x32x16_bf16 v[48:63], v[100:103], a[44:47], v[48:63]
  ds_read_b64_tr_b16 v[88:89], v171 offset:43008
  ds_read_b64_tr_b16 v[90:91], v171 offset:43264
  v_accvgpr_read_b32 v220, a152
  buffer_store_dword v220, v174, s[8:11], s52 offen offset:0 sc1
  s_waitcnt lgkmcnt(4)
  v_mfma_f32_32x32x16_bf16 v[48:63], v[104:107], a[48:51], v[48:63]
  ds_read_b64_tr_b16 v[92:93], v171 offset:46080
  ds_read_b64_tr_b16 v[94:95], v171 offset:46336
  v_accvgpr_read_b32 v221, a168
  buffer_store_dword v221, v174, s[8:11], s52 offen offset:128 sc1
  s_waitcnt lgkmcnt(4)
  v_mfma_f32_32x32x16_bf16 v[48:63], v[108:111], a[52:55], v[48:63]
  ds_read_b128 v[96:99], v6 offset:18432
  s_waitcnt vmcnt(13)
  ds_write_b128 v230, a[144:147]
  s_waitcnt vmcnt(12)
  ds_write_b128 v230, a[148:151] offset:1024
  s_waitcnt lgkmcnt(5)
  v_mfma_f32_32x32x16_bf16 v[48:63], v[88:91], a[56:59], v[48:63]
  ds_read_b64_tr_b16 v[212:213], v229 offset:0
  ds_read_b64_tr_b16 v[214:215], v229 offset:512
  s_waitcnt lgkmcnt(5)
  v_mfma_f32_32x32x16_bf16 v[48:63], v[92:95], a[60:63], v[48:63]
  ds_read_b64_tr_b16 v[216:217], v229 offset:1024
  ds_read_b64_tr_b16 v[218:219], v229 offset:1536
  s_waitcnt lgkmcnt(6)
  v_mfma_f32_32x32x16_bf16 v[48:63], v[96:99], v[132:135], v[48:63]
  s_waitcnt lgkmcnt(2)
  buffer_store_dwordx4 v[212:215], v1, s[8:11], s66 offen sc1
  s_waitcnt lgkmcnt(0)
  buffer_store_dwordx4 v[216:219], v1, s[8:11], s66 offen offset:1024 sc1
  s_lshl_b32 s98, s20, 11
  s_add_u32 s98, s98, 150528
  s_add_u32 s99, s98, 1024
  s_branch lay_6_2
lay_6_1:
  s_waitcnt lgkmcnt(2)
  v_mfma_f32_32x32x16_bf16 v[48:63], v[88:91], a[64:67], 0
  ds_read_b128 v[100:103], v5 offset:19456
  s_lshl_b32 s34, s25, 16
  s_lshl_b32 s17, s20, 14
  s_add_u32 s34, s34, s17
  s_add_u32 s34, s34, 1572864
  s_waitcnt lgkmcnt(2)
  v_mfma_f32_32x32x16_bf16 v[48:63], v[92:95], a[68:71], v[48:63]
  ds_read_b128 v[104:107], v5 offset:20480
  buffer_load_dwordx4 a[64:67], v10, s[8:11], s34 offen offset:0 sc1
  v_mul_u32_u24 v136, 2176, v3
  s_waitcnt lgkmcnt(2)
  v_mfma_f32_32x32x16_bf16 v[48:63], v[96:99], a[72:75], v[48:63]
  ds_read_b128 v[108:111], v5 offset:21504
  buffer_load_dwordx4 a[68:71], v11, s[8:11], s34 offen offset:0 sc1
  v_lshl_add_u32 v136, v2, 4, v136
  s_waitcnt lgkmcnt(2)
  v_mfma_f32_32x32x16_bf16 v[48:63], v[100:103], a[76:79], v[48:63]
  ds_read_b128 v[88:91], v5 offset:22528
  buffer_load_dwordx4 a[72:75], v10, s[8:11], s34 offen offset:2048 sc1
  v_lshrrev_b32 v137, 2, v0
  s_waitcnt lgkmcnt(2)
  v_mfma_f32_32x32x16_bf16 v[48:63], v[104:107], a[80:83], v[48:63]
  ds_read_b128 v[92:95], v5 offset:23552
  buffer_load_dwordx4 a[76:79], v11, s[8:11], s34 offen offset:2048 sc1
  s_add_u32 s34, s34, 4096
  s_waitcnt lgkmcnt(2)
  v_mfma_f32_32x32x16_bf16 v[48:63], v[108:111], a[84:87], v[48:63]
  ds_read_b128 v[96:99], v5 offset:24576
  buffer_load_dwordx4 a[80:83], v10, s[8:11], s34 offen offset:0 sc1
  v_mul_u32_u24 v137, 2176, v137
  s_waitcnt lgkmcnt(2)
  v_mfma_f32_32x32x16_bf16 v[48:63], v[88:91], a[88:91], v[48:63]
  ds_read_b128 v[100:103], v5 offset:25600
  buffer_load_dwordx4 a[84:87], v11, s[8:11], s34 offen offset:0 sc1
  v_and_b32 v138, 3, v0
  s_waitcnt lgkmcnt(2)
  v_mfma_f32_32x32x16_bf16 v[48:63], v[92:95], a[92:95], v[48:63]
  ds_read_b128 v[104:107], v5 offset:26624
  buffer_load_dwordx4 a[88:91], v10, s[8:11], s34 offen offset:2048 sc1
  v_lshl_add_u32 v137, v138, 3, v137
  s_waitcnt lgkmcnt(2)
  v_mfma_f32_32x32x16_bf16 v[48:63], v[96:99], a[96:99], v[48:63]
  ds_read_b128 v[108:111], v5 offset:27648
  buffer_load_dwordx4 a[92:95], v11, s[8:11], s34 offen offset:2048 sc1
  s_add_u32 s34, s34, 4096
  s_waitcnt lgkmcnt(2)
  v_mfma_f32_32x32x16_bf16 v[48:63], v[100:103], a[100:103], v[48:63]
  ds_read_b128 v[88:91], v5 offset:28672
  buffer_load_dwordx4 a[96:99], v10, s[8:11], s34 offen offset:0 sc1
  s_lshl_b32 s17, s20, 9
  s_waitcnt lgkmcnt(2)
  v_mfma_f32_32x32x16_bf16 v[48:63], v[104:107], a[104:107], v[48:63]
  ds_read_b128 v[92:95], v5 offset:29696
  buffer_load_dwordx4 a[100:103], v11, s[8:11], s34 offen offset:0 sc1
  s_add_u32 s37, s39, s17
  s_waitcnt lgkmcnt(2)
  v_mfma_f32_32x32x16_bf16 v[48:63], v[108:111], a[108:111], v[48:63]
  ds_read_b128 v[96:99], v5 offset:30720
  buffer_load_dwordx4 a[104:107], v10, s[8:11], s34 offen offset:2048 sc1
  s_lshl_b32 s17, s20, 5
  s_waitcnt lgkmcnt(2)
  v_mfma_f32_32x32x16_bf16 v[48:63], v[88:91], a[112:115], v[48:63]
  ds_read_b128 v[100:103], v5 offset:31744
  buffer_load_dwordx4 a[108:111], v11, s[8:11], s34 offen offset:2048 sc1
  s_add_u32 s34, s34, 4096
  s_waitcnt lgkmcnt(2)
  v_mfma_f32_32x32x16_bf16 v[48:63], v[92:95], a[116:119], v[48:63]
  ds_read_b128 v[104:107], v5 offset:0
  buffer_load_dwordx4 a[112:115], v10, s[8:11], s34 offen offset:0 sc1
  s_add_u32 s44, s39, s17
  s_waitcnt lgkmcnt(2)
  v_mfma_f32_32x32x16_bf16 v[48:63], v[96:99], a[120:123], v[48:63]
  ds_read_b128 v[108:111], v5 offset:1024
  buffer_load_dwordx4 a[116:119], v11, s[8:11], s34 offen offset:0 sc1
  s_lshr_b32 s16, s20, 1
  s_waitcnt lgkmcnt(2)
  v_mfma_f32_32x32x16_bf16 v[48:63], v[100:103], a[124:127], v[48:63]
  ds_read_b128 v[88:91], v5 offset:2048
  buffer_load_dwordx4 a[120:123], v10, s[8:11], s34 offen offset:2048 sc1
  s_lshl_b32 s17, s16, 6
  s_waitcnt lgkmcnt(2)
  v_mfma_f32_32x32x16_bf16 v[48:63], v[104:107], a[0:3], v[48:63]
  ds_read_b128 v[92:95], v5 offset:3072
  buffer_load_dwordx4 a[124:127], v11, s[8:11], s34 offen offset:2048 sc1
  s_add_u32 s34, s34, 4096
  s_lshl_b32 s18, s20, 9
  s_waitcnt lgkmcnt(2)
  v_mfma_f32_32x32x16_bf16 v[48:63], v[108:111], a[4:7], v[48:63]
  ds_read_b128 v[96:99], v5 offset:4096
  s_add_u32 s17, s17, s18
  s_add_u32 s17, s17, 158720
  s_waitcnt lgkmcnt(2)
  v_mfma_f32_32x32x16_bf16 v[48:63], v[88:91], a[8:11], v[48:63]
  ds_read_b128 v[100:103], v5 offset:5120
  v_lshl_add_u32 v142, v2, 4, s17
  s_mul_i32 s16, s16, 1088
  s_waitcnt lgkmcnt(2)
  v_mfma_f32_32x32x16_bf16 v[48:63], v[92:95], a[12:15], v[48:63]
  ds_read_b128 v[104:107], v5 offset:6144
  s_and_b32 s17, s20, 1
  s_lshl_b32 s17, s17, 5
  s_waitcnt lgkmcnt(2)
  v_mfma_f32_32x32x16_bf16 v[48:63], v[96:99], a[16:19], v[48:63]
  ds_read_b128 v[108:111], v5 offset:7168
  s_add_u32 s16, s16, s17
  s_add_u32 s16, s16, 159744
  s_waitcnt lgkmcnt(2)
  v_mfma_f32_32x32x16_bf16 v[48:63], v[100:103], a[20:23], v[48:63]
  ds_read_b128 v[88:91], v5 offset:8192
  v_lshl_add_u32 v143, v138, 3, s16
  s_waitcnt lgkmcnt(2)
  v_mfma_f32_32x32x16_bf16 v[48:63], v[104:107], a[24:27], v[48:63]
  ds_read_b128 v[92:95], v5 offset:9216
  v_min_u32 v138, 16, v2
  v_lshlrev_b32 v138, 6, v138
  s_waitcnt lgkmcnt(2)
  v_mfma_f32_32x32x16_bf16 v[48:63], v[108:111], a[28:31], v[48:63]
  ds_read_b128 v[96:99], v5 offset:10240
  v_lshl_add_u32 v138, v3, 5, v138
  v_add_u32 v138, 158720, v138
  s_waitcnt lgkmcnt(2)
  v_mfma_f32_32x32x16_bf16 v[48:63], v[88:91], a[32:35], v[48:63]
  ds_read_b128 v[100:103], v5 offset:11264
  s_lshr_b32 s16, s23, 1
  s_lshl_b32 s17, s16, 7
  s_waitcnt lgkmcnt(2)
  v_mfma_f32_32x32x16_bf16 v[48:63], v[92:95], a[36:39], v[48:63]
  ds_read_b128 v[104:107], v5 offset:12288
  s_lshl_b32 s16, s16, 4
  s_add_u32 s16, s16, s22
  s_waitcnt lgkmcnt(2)
  v_mfma_f32_32x32x16_bf16 v[48:63], v[96:99], a[40:43], v[48:63]
  ds_read_b128 v[108:111], v5 offset:13312
  s_mov_b32 s43, s37
  buffer_load_dwordx2 v[64:65], v137, s[8:11], s44 offen offset:2048 sc1
  buffer_load_dwordx4 v[16:19], v136, s[8:11], s43 offen sc1
  s_add_u32 s43, s43, 4352
  s_lshl_b32 s16, s16, 12
  s_and_b32 s18, s20, 1
  s_waitcnt lgkmcnt(2)
  v_mfma_f32_32x32x16_bf16 v[48:63], v[100:103], a[44:47], v[48:63]
  ds_read_b128 v[88:91], v5 offset:14336
  buffer_load_dwordx4 v[20:23], v136, s[8:11], s43 offen sc1
  s_add_u32 s43, s43, 4352
  buffer_load_dwordx4 v[24:27], v136, s[8:11], s43 offen sc1
  s_add_u32 s43, s43, 4352
  s_lshl_b32 s19, s18, 10
  s_waitcnt lgkmcnt(2)
  v_mfma_f32_32x32x16_bf16 v[48:63], v[104:107], a[48:51], v[48:63]
  ds_read_b128 v[92:95], v5 offset:15360
  buffer_load_dwordx4 v[28:31], v136, s[8:11], s43 offen sc1
  s_add_u32 s43, s43, 4352
  s_add_u32 s16, s16, s19
  s_mul_i32 s19, s26, 2097152
  s_waitcnt lgkmcnt(2)
  v_mfma_f32_32x32x16_bf16 v[48:63], v[108:111], a[52:55], v[48:63]
  ds_read_b128 v[96:99], v6 offset:18432
  buffer_load_dwordx4 v[32:35], v136, s[8:11], s43 offen sc1
  s_add_u32 s43, s43, 4352
  s_add_u32 s16, s16, s19
  s_add_u32 s45, s16, 17039360
  s_waitcnt lgkmcnt(2)
  v_mfma_f32_32x32x16_bf16 v[48:63], v[88:91], a[56:59], v[48:63]
  buffer_load_dwordx4 v[36:39], v136, s[8:11], s43 offen sc1
  s_add_u32 s43, s43, 4352
  s_lshl_b32 s19, s22, 1
  s_add_u32 s18, s18, s19
  s_waitcnt lgkmcnt(1)
  v_mfma_f32_32x32x16_bf16 v[48:63], v[92:95], a[60:63], v[48:63]
  buffer_load_dwordx4 v[40:43], v136, s[8:11], s43 offen sc1
  s_add_u32 s43, s43, 4352
  s_lshl_b32 s18, s18, 2
  s_add_u32 s47, s17, s18
  s_waitcnt lgkmcnt(0)
  v_mfma_f32_32x32x16_bf16 v[48:63], v[96:99], v[132:135], v[48:63]
  buffer_load_dwordx4 v[44:47], v136, s[8:11], s43 offen sc1
  s_add_u32 s43, s43, 4352
  s_add_u32 s46, s47, 37396480
  s_add_u32 s47, s47, 37400576
lay_6_2:
  s_nop 7
  v_pk_mul_f32 v[140:141], v[48:49], v[128:129] op_sel_hi:[1,0]
  v_pk_fma_f32 v[48:49], v[48:49], v[128:129], s[40:41] op_sel:[0,1,0] op_sel_hi:[1,1,1]
  v_exp_f32_e64 v140, v140 clamp
  v_exp_f32_e64 v141, v141 clamp
  v_max_f32 v48, s40, v48
  v_max_f32 v49, s40, v49
  v_pk_add_f32 v[48:49], v[48:49], v[140:141]
  v_cvt_pk_bf16_f32 v88, v48, v49
  v_pk_mul_f32 v[130:131], v[50:51], v[128:129] op_sel_hi:[1,0]
  v_pk_fma_f32 v[50:51], v[50:51], v[128:129], s[40:41] op_sel:[0,1,0] op_sel_hi:[1,1,1]
  v_exp_f32_e64 v130, v130 clamp
  v_exp_f32_e64 v131, v131 clamp
  v_max_f32 v50, s40, v50
  v_max_f32 v51, s40, v51
  v_pk_add_f32 v[50:51], v[50:51], v[130:131]
  v_cvt_pk_bf16_f32 v89, v50, v51
  v_pk_mul_f32 v[140:141], v[52:53], v[128:129] op_sel_hi:[1,0]
  v_pk_fma_f32 v[52:53], v[52:53], v[128:129], s[40:41] op_sel:[0,1,0] op_sel_hi:[1,1,1]
  v_exp_f32_e64 v140, v140 clamp
  v_exp_f32_e64 v141, v141 clamp
  v_max_f32 v52, s40, v52
  v_max_f32 v53, s40, v53
  v_pk_add_f32 v[52:53], v[52:53], v[140:141]
  v_cvt_pk_bf16_f32 v90, v52, v53
  v_pk_mul_f32 v[130:131], v[54:55], v[128:129] op_sel_hi:[1,0]
  v_pk_fma_f32 v[54:55], v[54:55], v[128:129], s[40:41] op_sel:[0,1,0] op_sel_hi:[1,1,1]
  v_exp_f32_e64 v130, v130 clamp
  v_exp_f32_e64 v131, v131 clamp
  v_max_f32 v54, s40, v54
  v_max_f32 v55, s40, v55
  v_pk_add_f32 v[54:55], v[54:55], v[130:131]
  v_cvt_pk_bf16_f32 v91, v54, v55
  v_pk_mul_f32 v[140:141], v[56:57], v[128:129] op_sel_hi:[1,0]
  v_pk_fma_f32 v[56:57], v[56:57], v[128:129], s[40:41] op_sel:[0,1,0] op_sel_hi:[1,1,1]
  v_exp_f32_e64 v140, v140 clamp
  v_exp_f32_e64 v141, v141 clamp
  v_max_f32 v56, s40, v56
  v_max_f32 v57, s40, v57
  v_pk_add_f32 v[56:57], v[56:57], v[140:141]
  v_cvt_pk_bf16_f32 v92, v56, v57
  v_pk_mul_f32 v[130:131], v[58:59], v[128:129] op_sel_hi:[1,0]
  v_pk_fma_f32 v[58:59], v[58:59], v[128:129], s[40:41] op_sel:[0,1,0] op_sel_hi:[1,1,1]
  v_exp_f32_e64 v130, v130 clamp
  v_exp_f32_e64 v131, v131 clamp
  v_max_f32 v58, s40, v58
  v_max_f32 v59, s40, v59
  v_pk_add_f32 v[58:59], v[58:59], v[130:131]
  v_cvt_pk_bf16_f32 v93, v58, v59
  v_pk_mul_f32 v[140:141], v[60:61], v[128:129] op_sel_hi:[1,0]
  v_pk_fma_f32 v[60:61], v[60:61], v[128:129], s[40:41] op_sel:[0,1,0] op_sel_hi:[1,1,1]
  v_exp_f32_e64 v140, v140 clamp
  v_exp_f32_e64 v141, v141 clamp
  v_max_f32 v60, s40, v60
  v_max_f32 v61, s40, v61
  v_pk_add_f32 v[60:61], v[60:61], v[140:141]
  v_cvt_pk_bf16_f32 v94, v60, v61
  v_pk_mul_f32 v[130:131], v[62:63], v[128:129] op_sel_hi:[1,0]
  v_pk_fma_f32 v[62:63], v[62:63], v[128:129], s[40:41] op_sel:[0,1,0] op_sel_hi:[1,1,1]
  v_exp_f32_e64 v130, v130 clamp
  v_exp_f32_e64 v131, v131 clamp
  v_max_f32 v62, s40, v62
  v_max_f32 v63, s40, v63
  v_pk_add_f32 v[62:63], v[62:63], v[130:131]
  v_cvt_pk_bf16_f32 v95, v62, v63
  s_cmp_lg_u32 s26, 0
  s_cbranch_scc1 lay_7
  s_mov_b32 s43, s37
  buffer_load_dwordx2 v[64:65], v137, s[8:11], s44 offen offset:2048 sc1
  buffer_load_dwordx4 v[16:19], v136, s[8:11], s43 offen sc1
  s_add_u32 s43, s43, 4352
  buffer_load_dwordx4 v[20:23], v136, s[8:11], s43 offen sc1
  s_add_u32 s43, s43, 4352
  buffer_load_dwordx4 v[24:27], v136, s[8:11], s43 offen sc1
  s_add_u32 s43, s43, 4352
  buffer_load_dwordx4 v[28:31], v136, s[8:11], s43 offen sc1
  s_add_u32 s43, s43, 4352
  buffer_load_dwordx4 v[32:35], v136, s[8:11], s43 offen sc1
  s_add_u32 s43, s43, 4352
  buffer_load_dwordx4 v[36:39], v136, s[8:11], s43 offen sc1
  s_add_u32 s43, s43, 4352
  buffer_load_dwordx4 v[40:43], v136, s[8:11], s43 offen sc1
  s_add_u32 s43, s43, 4352
  buffer_load_dwordx4 v[44:47], v136, s[8:11], s43 offen sc1
lay_7:
  s_cmp_lg_u32 s26, 0
  s_cbranch_scc1 lay_8
  s_waitcnt vmcnt(9)
  s_barrier
  s_cmp_lg_u32 s20, 0
  s_cbranch_scc1 arr_9
  v_mov_b32 v14, 1
  s_mov_b64 exec, 1
  buffer_atomic_add v14, v13, s[8:11], s33 offen offset:128 sc1
  s_mov_b64 exec, -1
arr_9:
lay_8:
  s_waitcnt vmcnt(8)
  v_max_u32 v66, v64, v65
  s_waitcnt vmcnt(7)
  v_max3_u32 v66, v66, v16, v17
  v_max3_u32 v66, v66, v18, v19
  s_waitcnt vmcnt(6)
  v_max3_u32 v66, v66, v20, v21
  v_max3_u32 v66, v66, v22, v23
  s_waitcnt vmcnt(5)
  v_max3_u32 v66, v66, v24, v25
  v_max3_u32 v66, v66, v26, v27
  s_waitcnt vmcnt(4)
  v_max3_u32 v66, v66, v28, v29
  v_max3_u32 v66, v66, v30, v31
  s_waitcnt vmcnt(3)
  v_max3_u32 v66, v66, v32, v33
  v_max3_u32 v66, v66, v34, v35
  s_waitcnt vmcnt(2)
  v_max3_u32 v66, v66, v36, v37
  v_max3_u32 v66, v66, v38, v39
  s_waitcnt vmcnt(1)
  v_max3_u32 v66, v66, v40, v41
  v_max3_u32 v66, v66, v42, v43
  s_waitcnt vmcnt(0)
  v_max3_u32 v66, v66, v44, v45
  v_max3_u32 v66, v66, v46, v47
  v_cmp_eq_u32 vcc, -1, v66
  s_mov_b32 s58, 0
  s_cbranch_vccz L_fast_kvx
L_fast_kvr:
  s_mov_b32 s43, s37
  buffer_load_dwordx2 v[64:65], v137, s[8:11], s44 offen offset:2048 sc1
  buffer_load_dwordx4 v[16:19], v136, s[8:11], s43 offen sc1
  s_add_u32 s43, s43, 4352
  buffer_load_dwordx4 v[20:23], v136, s[8:11], s43 offen sc1
  s_add_u32 s43, s43, 4352
  buffer_load_dwordx4 v[24:27], v136, s[8:11], s43 offen sc1
  s_add_u32 s43, s43, 4352
  buffer_load_dwordx4 v[28:31], v136, s[8:11], s43 offen sc1
  s_add_u32 s43, s43, 4352
  buffer_load_dwordx4 v[32:35], v136, s[8:11], s43 offen sc1
  s_add_u32 s43, s43, 4352
  buffer_load_dwordx4 v[36:39], v136, s[8:11], s43 offen sc1
  s_add_u32 s43, s43, 4352
  buffer_load_dwordx4 v[40:43], v136, s[8:11], s43 offen sc1
  s_add_u32 s43, s43, 4352
  buffer_load_dwordx4 v[44:47], v136, s[8:11], s43 offen sc1
  s_add_u32 s58, s58, 1
  s_waitcnt vmcnt(8)
  v_max_u32 v66, v64, v65
  s_waitcnt vmcnt(7)
  v_max3_u32 v66, v66, v16, v17
  v_max3_u32 v66, v66, v18, v19
  s_waitcnt vmcnt(6)
  v_max3_u32 v66, v66, v20, v21
  v_max3_u32 v66, v66, v22, v23
  s_waitcnt vmcnt(5)
  v_max3_u32 v66, v66, v24, v25
  v_max3_u32 v66, v66, v26, v27
  s_waitcnt vmcnt(4)
  v_max3_u32 v66, v66, v28, v29
  v_max3_u32 v66, v66, v30, v31
  s_waitcnt vmcnt(3)
  v_max3_u32 v66, v66, v32, v33
  v_max3_u32 v66, v66, v34, v35
  s_waitcnt vmcnt(2)
  v_max3_u32 v66, v66, v36, v37
  v_max3_u32 v66, v66, v38, v39
  s_waitcnt vmcnt(1)
  v_max3_u32 v66, v66, v40, v41
  v_max3_u32 v66, v66, v42, v43
  s_waitcnt vmcnt(0)
  v_max3_u32 v66, v66, v44, v45
  v_max3_u32 v66, v66, v46, v47
  v_cmp_eq_u32 vcc, -1, v66
  s_cmp_gt_u32 s58, 0x100000
  s_cbranch_scc1 L_fast_kvx
  s_cbranch_vccnz L_fast_kvr
L_fast_kvx:
  s_cmp_lg_u32 s26, 0
  s_cbranch_scc1 lay_10_1
  buffer_load_dwordx4 a[80:83], v10, s[8:11], s34 offen offset:0 sc1
  buffer_load_dwordx4 a[84:87], v11, s[8:11], s34 offen offset:0 sc1
  buffer_load_dwordx4 a[88:91], v10, s[8:11], s34 offen offset:2048 sc1
  buffer_load_dwordx4 a[92:95], v11, s[8:11], s34 offen offset:2048 sc1
  s_add_u32 s34, s34, 4096
  buffer_load_dwordx4 a[96:99], v10, s[8:11], s34 offen offset:0 sc1
  buffer_load_dwordx4 a[100:103], v11, s[8:11], s34 offen offset:0 sc1
  buffer_load_dwordx4 a[104:107], v10, s[8:11], s34 offen offset:2048 sc1
  buffer_load_dwordx4 a[108:111], v11, s[8:11], s34 offen offset:2048 sc1
  s_add_u32 s34, s34, 4096
  buffer_load_dwordx4 a[112:115], v10, s[8:11], s34 offen offset:0 sc1
  buffer_load_dwordx4 a[116:119], v11, s[8:11], s34 offen offset:0 sc1
  buffer_load_dwordx4 a[120:123], v10, s[8:11], s34 offen offset:2048 sc1
  buffer_load_dwordx4 a[124:127], v11, s[8:11], s34 offen offset:2048 sc1
  s_add_u32 s34, s34, 4096
  s_branch lay_10_2
lay_10_1:
  s_add_u32 m0, s31, 0
  s_nop 0
  buffer_load_dwordx4 v1, s[8:11], s32 offen offset:0 sc1 lds
  s_add_u32 m0, s31, 0
  s_nop 0
  buffer_load_dwordx4 v1, s[8:11], s32 offen offset:1024 sc1 lds
  s_add_u32 m0, s31, 0
  s_nop 0
  buffer_load_dwordx4 v1, s[8:11], s32 offen offset:2048 sc1 lds
  s_add_u32 m0, s31, 0
  s_nop 0
  buffer_load_dwordx4 v1, s[8:11], s32 offen offset:3072 sc1 lds
  s_add_u32 s32, s32, 16384
  s_add_u32 m0, s31, 16384
  s_nop 0
  buffer_load_dwordx4 v1, s[8:11], s32 offen offset:0 sc1 lds
  s_add_u32 m0, s31, 16384
  s_nop 0
  buffer_load_dwordx4 v1, s[8:11], s32 offen offset:1024 sc1 lds
  s_add_u32 m0, s31, 16384
  s_nop 0
  buffer_load_dwordx4 v1, s[8:11], s32 offen offset:2048 sc1 lds
  s_add_u32 m0, s31, 16384
  s_nop 0
  buffer_load_dwordx4 v1, s[8:11], s32 offen offset:3072 sc1 lds
  s_add_u32 s32, s32, 16384
lay_10_2:
  v_add_f32_dpp v64, v64, v64 row_ror:4 row_mask:0xf bank_mask:0xf
  v_add_f32_dpp v65, v65, v65 row_ror:4 row_mask:0xf bank_mask:0xf
  v_pk_add_f32 v[16:17], v[16:17], v[20:21]
  v_pk_add_f32 v[18:19], v[18:19], v[22:23]
  v_add_f32_dpp v64, v64, v64 row_ror:8 row_mask:0xf bank_mask:0xf
  v_add_f32_dpp v65, v65, v65 row_ror:8 row_mask:0xf bank_mask:0xf
  v_pk_add_f32 v[16:17], v[16:17], v[24:25]
  v_pk_add_f32 v[18:19], v[18:19], v[26:27]
  v_mov_b32 v66, v64
  v_mov_b32 v67, v65
  v_pk_add_f32 v[16:17], v[16:17], v[28:29]
  v_pk_add_f32 v[18:19], v[18:19], v[30:31]
  v_permlane16_swap_b32 v66, v64
  v_permlane16_swap_b32 v67, v65
  v_pk_add_f32 v[64:65], v[66:67], v[64:65]
  v_pk_add_f32 v[16:17], v[16:17], v[32:33]
  v_pk_add_f32 v[18:19], v[18:19], v[34:35]
  v_mov_b32 v66, v64
  v_mov_b32 v67, v65
  v_pk_add_f32 v[16:17], v[16:17], v[36:37]
  v_pk_add_f32 v[18:19], v[18:19], v[38:39]
  v_permlane32_swap_b32 v66, v64
  v_permlane32_swap_b32 v67, v65
  v_pk_add_f32 v[64:65], v[66:67], v[64:65]
  v_pk_add_f32 v[16:17], v[16:17], v[40:41]
  v_pk_add_f32 v[18:19], v[18:19], v[42:43]
  ds_write_b64 v143, v[64:65]
  v_pk_add_f32 v[16:17], v[16:17], v[44:45]
  v_pk_add_f32 v[18:19], v[18:19], v[46:47]
  v_mov_b32 v20, v16
  v_mov_b32 v21, v17
  v_mov_b32 v22, v18
  v_mov_b32 v23, v19
  v_permlane32_swap_b32 v20, v16
  v_permlane32_swap_b32 v21, v17
  v_permlane32_swap_b32 v22, v18
  v_permlane32_swap_b32 v23, v19
  v_pk_add_f32 v[16:17], v[20:21], v[16:17]
  v_pk_add_f32 v[18:19], v[22:23], v[18:19]
  ds_write_b128 v142, v[16:19]
  s_waitcnt lgkmcnt(0)
  s_barrier
  ds_read_b128 v[16:19], v138 offset:0
  ds_read_b128 v[20:23], v138 offset:16
  ds_read_b128 v[24:27], v138 offset:1088
  ds_read_b128 v[28:31], v138 offset:1104
  s_waitcnt lgkmcnt(3)
  v_cvt_pk_bf16_f32 v16, v16, v17
  v_cvt_pk_bf16_f32 v17, v18, v19
  s_waitcnt lgkmcnt(2)
  v_cvt_pk_bf16_f32 v18, v20, v21
  v_cvt_pk_bf16_f32 v19, v22, v23
  s_nop 1
  v_mfma_f32_32x32x16_bf16 v[32:47], v[16:19], v[88:91], 0
  s_waitcnt lgkmcnt(1)
  v_cvt_pk_bf16_f32 v24, v24, v25
  v_cvt_pk_bf16_f32 v25, v26, v27
  s_waitcnt lgkmcnt(0)
  v_cvt_pk_bf16_f32 v26, v28, v29
  v_cvt_pk_bf16_f32 v27, v30, v31
  s_nop 1
  v_mfma_f32_32x32x16_bf16 v[48:63], v[24:27], v[92:95], 0
  s_lshl_b32 s16, s24, 7
  s_lshl_b32 s17, s20, 5
  s_add_u32 s51, s16, s17
  s_add_u32 s55, s51, 37396480
  s_add_u32 s51, s51, 37400576
  v_and_b32 v7, 7, v0
  v_lshlrev_b32 v139, 2, v7
  s_lshl_b32 s56, s26, 1
  s_add_u32 s56, s56, 1
  v_add_f32 v130, s40, v40
  v_rcp_f32 v130, v130
  s_nop 0
  v_pk_mul_f32 v[32:33], v[32:33], v[130:131] op_sel_hi:[1,0]
  v_pk_mul_f32 v[34:35], v[34:35], v[130:131] op_sel_hi:[1,0]
  v_pk_mul_f32 v[36:37], v[36:37], v[130:131] op_sel_hi:[1,0]
  v_pk_mul_f32 v[38:39], v[38:39], v[130:131] op_sel_hi:[1,0]
  v_cvt_pk_bf16_f32 v96, v32, v33
  v_cvt_pk_bf16_f32 v97, v34, v35
  v_cvt_pk_bf16_f32 v98, v36, v37
  v_cvt_pk_bf16_f32 v99, v38, v39
  buffer_store_dwordx4 v[96:99], v1, s[8:11], s45 offen offset:0 sc1
  v_add_f32 v130, s40, v56
  v_rcp_f32 v130, v130
  s_nop 0
  v_pk_mul_f32 v[48:49], v[48:49], v[130:131] op_sel_hi:[1,0]
  v_pk_mul_f32 v[50:51], v[50:51], v[130:131] op_sel_hi:[1,0]
  v_pk_mul_f32 v[52:53], v[52:53], v[130:131] op_sel_hi:[1,0]
  v_pk_mul_f32 v[54:55], v[54:55], v[130:131] op_sel_hi:[1,0]
  v_cvt_pk_bf16_f32 v100, v48, v49
  v_cvt_pk_bf16_f32 v101, v50, v51
  v_cvt_pk_bf16_f32 v102, v52, v53
  v_cvt_pk_bf16_f32 v103, v54, v55
  buffer_store_dwordx4 v[100:103], v1, s[8:11], s45 offen offset:2048 sc1
  s_lshl_b32 s34, s24, 16
  s_lshl_b32 s17, s20, 14
  s_add_u32 s34, s34, s17
  s_mul_i32 s17, s26, 2097152
  s_add_u32 s34, s34, s17
  s_add_u32 s34, s34, 17039360
  s_waitcnt vmcnt(0)
  v_mov_b32 v14, s56
  s_mov_b64 exec, 1
  buffer_store_dword v14, v13, s[8:11], s46 offen
  s_mov_b64 exec, -1
  s_mul_i32 s48, s26, 4194304
  s_add_u32 s48, s48, s28
  s_add_u32 s48, s48, 9699328
  s_mul_i32 s49, s26, 524288
  s_add_u32 s49, s49, s29
  s_add_u32 s49, s49, 16252928
  s_mul_i32 s50, s26, 48
  s_add_u32 s50, s50, 48
  s_lshl_b32 s42, s23, 7
  s_add_u32 s42, s42, 37388288
  v_and_b32 v138, 15, v0
  v_lshlrev_b32 v138, 2, v138
  s_cmp_lg_u32 s26, 0
  s_cbranch_scc1 lay_11_1
  buffer_load_dword v234, v233, s[8:11], s96 offen sc1
  s_branch lay_11_2
lay_11_1:
lay_11_2:
  s_mov_b32 s58, 0
poll_12:
  buffer_load_dword v14, v139, s[8:11], s55 offen sc1
  s_waitcnt vmcnt(0)
  v_cmp_gt_u32 vcc, s56, v14
  s_add_u32 s58, s58, 1
  s_cmp_gt_u32 s58, 0x200000
  s_cbranch_scc1 poll_12_x
  s_cbranch_vccnz poll_12
poll_12_x:
  s_add_u32 s16, s34, 0
  buffer_load_dwordx4 a[0:3], v8, s[8:11], s16 offen offset:0 sc1
  buffer_load_dwordx4 a[4:7], v9, s[8:11], s16 offen offset:0 sc1
  buffer_load_dwordx4 a[8:11], v8, s[8:11], s16 offen offset:2048 sc1
  buffer_load_dwordx4 a[12:15], v9, s[8:11], s16 offen offset:2048 sc1
  s_add_u32 s16, s34, 4096
  buffer_load_dwordx4 a[16:19], v8, s[8:11], s16 offen offset:0 sc1
  buffer_load_dwordx4 a[20:23], v9, s[8:11], s16 offen offset:0 sc1
  buffer_load_dwordx4 a[24:27], v8, s[8:11], s16 offen offset:2048 sc1
  buffer_load_dwordx4 a[28:31], v9, s[8:11], s16 offen offset:2048 sc1
  s_add_u32 s16, s34, 8192
  buffer_load_dwordx4 a[32:35], v8, s[8:11], s16 offen offset:0 sc1
  buffer_load_dwordx4 a[36:39], v9, s[8:11], s16 offen offset:0 sc1
  buffer_load_dwordx4 a[40:43], v8, s[8:11], s16 offen offset:2048 sc1
  buffer_load_dwordx4 a[44:47], v9, s[8:11], s16 offen offset:2048 sc1
  s_add_u32 s16, s34, 12288
  buffer_load_dwordx4 a[48:51], v8, s[8:11], s16 offen offset:0 sc1
  buffer_load_dwordx4 a[52:55], v9, s[8:11], s16 offen offset:0 sc1
  buffer_load_dwordx4 a[56:59], v8, s[8:11], s16 offen offset:2048 sc1
  buffer_load_dwordx4 a[60:63], v9, s[8:11], s16 offen offset:2048 sc1
  s_cmp_lg_u32 s26, 0
  s_cbranch_scc1 lay_13
  v_cmp_gt_u32 vcc, 16, v234
  s_nop 0
  s_cbranch_vccz poll_14_x
  s_mov_b32 s58, 0
poll_14:
  buffer_load_dword v234, v233, s[8:11], s96 offen sc1
  s_waitcnt vmcnt(0)
  v_cmp_gt_u32 vcc, 16, v234
  s_add_u32 s58, s58, 1
  s_cmp_gt_u32 s58, 0x200000
  s_cbranch_scc1 poll_14_x
  s_cbranch_vccnz poll_14
poll_14_x:
  s_add_u32 m0, s31, 0
  s_nop 0
  buffer_load_dwordx4 v1, s[8:11], s32 offen offset:0 sc1 lds
  buffer_load_dwordx4 v1, s[8:11], s32 offen offset:1024 sc1 lds
  buffer_load_dwordx4 v1, s[8:11], s32 offen offset:2048 sc1 lds
  buffer_load_dwordx4 v1, s[8:11], s32 offen offset:3072 sc1 lds
  s_add_u32 s32, s32, 16384
  s_add_u32 m0, s31, 16384
  s_nop 0
  buffer_load_dwordx4 v1, s[8:11], s32 offen offset:0 sc1 lds
  buffer_load_dwordx4 v1, s[8:11], s32 offen offset:1024 sc1 lds
  buffer_load_dwordx4 v1, s[8:11], s32 offen offset:2048 sc1 lds
  buffer_load_dwordx4 v1, s[8:11], s32 offen offset:3072 sc1 lds
  s_add_u32 s32, s32, 16384
lay_13:
  s_xor_b32 s16, s20, 3
  s_mul_i32 s16, s16, 12288
  s_add_u32 s16, s16, 106496
  v_add_u32 v95, s16, v1
  s_xor_b32 s16, s20, 2
  s_mul_i32 s16, s16, 12288
  s_add_u32 s16, s16, 102400
  v_add_u32 v94, s16, v1
  s_xor_b32 s16, s20, 1
  s_mul_i32 s16, s16, 12288
  s_add_u32 s16, s16, 98304
  v_add_u32 v93, s16, v1
  s_mul_i32 s16, s20, 12288
  s_add_u32 s16, s16, 98304
  v_add_u32 v92, s16, v1
  s_mov_b32 s17, 0xffff0000
  v_lshlrev_b32 v96, 16, v80
  v_and_b32 v97, s17, v80
  v_lshlrev_b32 v98, 16, v81
  v_and_b32 v99, s17, v81
  v_lshlrev_b32 v100, 16, v82
  v_and_b32 v101, s17, v82
  v_lshlrev_b32 v102, 16, v83
  v_and_b32 v103, s17, v83
  v_lshlrev_b32 v104, 16, v84
  v_and_b32 v105, s17, v84
  v_lshlrev_b32 v106, 16, v85
  v_and_b32 v107, s17, v85
  v_lshlrev_b32 v108, 16, v86
  v_and_b32 v109, s17, v86
  v_lshlrev_b32 v110, 16, v87
  v_and_b32 v111, s17, v87
  s_waitcnt vmcnt(14)
  v_mfma_f32_32x32x16_bf16 v[64:79], a[68:71], a[4:7], 0
  v_mfma_f32_32x32x16_bf16 v[48:63], a[64:67], a[4:7], 0
  v_mfma_f32_32x32x16_bf16 v[32:47], a[68:71], a[0:3], 0
  v_mfma_f32_32x32x16_bf16 v[16:31], a[64:67], a[0:3], 0
  s_waitcnt vmcnt(12)
  v_mfma_f32_32x32x16_bf16 v[64:79], a[76:79], a[12:15], v[64:79]
  v_mfma_f32_32x32x16_bf16 v[48:63], a[72:75], a[12:15], v[48:63]
  v_mfma_f32_32x32x16_bf16 v[32:47], a[76:79], a[8:11], v[32:47]
  v_mfma_f32_32x32x16_bf16 v[16:31], a[72:75], a[8:11], v[16:31]
  s_waitcnt vmcnt(10)
  v_mfma_f32_32x32x16_bf16 v[64:79], a[84:87], a[20:23], v[64:79]
  v_mfma_f32_32x32x16_bf16 v[48:63], a[80:83], a[20:23], v[48:63]
  v_mfma_f32_32x32x16_bf16 v[32:47], a[84:87], a[16:19], v[32:47]
  v_mfma_f32_32x32x16_bf16 v[16:31], a[80:83], a[16:19], v[16:31]
  s_waitcnt vmcnt(8)
  v_mfma_f32_32x32x16_bf16 v[64:79], a[92:95], a[28:31], v[64:79]
  v_mfma_f32_32x32x16_bf16 v[48:63], a[88:91], a[28:31], v[48:63]
  v_mfma_f32_32x32x16_bf16 v[32:47], a[92:95], a[24:27], v[32:47]
  v_mfma_f32_32x32x16_bf16 v[16:31], a[88:91], a[24:27], v[16:31]
  s_waitcnt vmcnt(6)
  v_mfma_f32_32x32x16_bf16 v[64:79], a[100:103], a[36:39], v[64:79]
  s_add_u32 m0, s31, 32768
  s_nop 0
  buffer_load_dwordx4 v1, s[8:11], s32 offen offset:0 sc1 lds
  s_waitcnt vmcnt(5)
  v_mfma_f32_32x32x16_bf16 v[64:79], a[108:111], a[44:47], v[64:79]
  buffer_load_dwordx4 v1, s[8:11], s32 offen offset:1024 sc1 lds
  s_waitcnt vmcnt(4)
  v_mfma_f32_32x32x16_bf16 v[64:79], a[116:119], a[52:55], v[64:79]
  buffer_load_dwordx4 v1, s[8:11], s32 offen offset:2048 sc1 lds
  s_waitcnt vmcnt(3)
  v_mfma_f32_32x32x16_bf16 v[64:79], a[124:127], a[60:63], v[64:79]
  buffer_load_dwordx4 v1, s[8:11], s32 offen offset:3072 sc1 lds
  s_add_u32 s32, s32, 16384
  v_mfma_f32_32x32x16_bf16 v[48:63], a[96:99], a[36:39], v[48:63]
  s_add_u32 m0, s31, 49152
  s_nop 0
  buffer_load_dwordx4 v1, s[8:11], s32 offen offset:0 sc1 lds
  v_mfma_f32_32x32x16_bf16 v[48:63], a[104:107], a[44:47], v[48:63]
  buffer_load_dwordx4 v1, s[8:11], s32 offen offset:1024 sc1 lds
  s_nop 3
  ds_write_b128 v95, v[64:67] offset:0
  ds_write_b128 v95, v[68:71] offset:1024
  v_mfma_f32_32x32x16_bf16 v[48:63], a[112:115], a[52:55], v[48:63]
  buffer_load_dwordx4 v1, s[8:11], s32 offen offset:2048 sc1 lds
  ds_write_b128 v95, v[72:75] offset:2048
  v_mfma_f32_32x32x16_bf16 v[48:63], a[120:123], a[60:63], v[48:63]
  buffer_load_dwordx4 v1, s[8:11], s32 offen offset:3072 sc1 lds
  s_add_u32 s32, s32, 16384
  ds_write_b128 v95, v[76:79] offset:3072
  v_mfma_f32_32x32x16_bf16 v[32:47], a[100:103], a[32:35], v[32:47]
  s_add_u32 m0, s31, 65536
  s_nop 0
  buffer_load_dwordx4 v1, s[8:11], s32 offen offset:0 sc1 lds
  v_mfma_f32_32x32x16_bf16 v[32:47], a[108:111], a[40:43], v[32:47]
  buffer_load_dwordx4 v1, s[8:11], s32 offen offset:1024 sc1 lds
  s_nop 2
  ds_write_b128 v94, v[48:51] offset:0
  ds_write_b128 v94, v[52:55] offset:1024
  v_mfma_f32_32x32x16_bf16 v[32:47], a[116:119], a[48:51], v[32:47]
  buffer_load_dwordx4 v1, s[8:11], s32 offen offset:2048 sc1 lds
  ds_write_b128 v94, v[56:59] offset:2048
  v_mfma_f32_32x32x16_bf16 v[32:47], a[124:127], a[56:59], v[32:47]
  buffer_load_dwordx4 v1, s[8:11], s32 offen offset:3072 sc1 lds
  s_add_u32 s32, s32, 16384
  ds_write_b128 v94, v[60:63] offset:3072
  v_mfma_f32_32x32x16_bf16 v[16:31], a[96:99], a[32:35], v[16:31]
  v_mfma_f32_32x32x16_bf16 v[16:31], a[104:107], a[40:43], v[16:31]
  s_nop 6
  ds_write_b128 v93, v[32:35] offset:0
  ds_write_b128 v93, v[36:39] offset:1024
  v_mfma_f32_32x32x16_bf16 v[16:31], a[112:115], a[48:51], v[16:31]
  ds_write_b128 v93, v[40:43] offset:2048
  v_mfma_f32_32x32x16_bf16 v[16:31], a[120:123], a[56:59], v[16:31]
  ds_write_b128 v93, v[44:47] offset:3072
L_fast_k2ok:
  s_waitcnt lgkmcnt(0)
  s_barrier
  ds_read_b128 v[32:35], v92 offset:0
  ds_read_b128 v[48:51], v92 offset:4096
  ds_read_b128 v[64:67], v92 offset:8192
  ds_read_b128 v[36:39], v92 offset:1024
  ds_read_b128 v[52:55], v92 offset:5120
  ds_read_b128 v[68:71], v92 offset:9216
  ds_read_b128 v[40:43], v92 offset:2048
  ds_read_b128 v[56:59], v92 offset:6144
  ds_read_b128 v[72:75], v92 offset:10240
  ds_read_b128 v[44:47], v92 offset:3072
  ds_read_b128 v[60:63], v92 offset:7168
  ds_read_b128 v[76:79], v92 offset:11264
  s_add_u32 m0, s31, 81920
  s_nop 0
  buffer_load_dwordx4 v1, s[8:11], s32 offen offset:0 sc1 lds
  buffer_load_dwordx4 v1, s[8:11], s32 offen offset:1024 sc1 lds
  buffer_load_dwordx4 v1, s[8:11], s32 offen offset:2048 sc1 lds
  buffer_load_dwordx4 v1, s[8:11], s32 offen offset:3072 sc1 lds
  s_add_u32 s32, s32, 16384
  v_pk_add_f32 v[16:17], v[16:17], v[96:97]
  v_pk_add_f32 v[18:19], v[18:19], v[98:99]
  v_pk_add_f32 v[20:21], v[20:21], v[100:101]
  v_pk_add_f32 v[22:23], v[22:23], v[102:103]
  v_pk_add_f32 v[24:25], v[24:25], v[104:105]
  v_pk_add_f32 v[26:27], v[26:27], v[106:107]
  v_pk_add_f32 v[28:29], v[28:29], v[108:109]
  v_pk_add_f32 v[30:31], v[30:31], v[110:111]
  s_waitcnt lgkmcnt(11)
  v_pk_add_f32 v[16:17], v[16:17], v[32:33]
  v_pk_add_f32 v[18:19], v[18:19], v[34:35]
  s_waitcnt lgkmcnt(10)
  v_pk_add_f32 v[16:17], v[16:17], v[48:49]
  v_pk_add_f32 v[18:19], v[18:19], v[50:51]
  s_waitcnt lgkmcnt(9)
  v_pk_add_f32 v[16:17], v[16:17], v[64:65]
  v_pk_add_f32 v[18:19], v[18:19], v[66:67]
  v_cvt_pk_bf16_f32 v80, v16, v17
  v_cvt_pk_bf16_f32 v81, v18, v19
  s_waitcnt lgkmcnt(8)
  v_pk_add_f32 v[20:21], v[20:21], v[36:37]
  v_pk_add_f32 v[22:23], v[22:23], v[38:39]
  s_waitcnt lgkmcnt(7)
  v_pk_add_f32 v[20:21], v[20:21], v[52:53]
  v_pk_add_f32 v[22:23], v[22:23], v[54:55]
  s_waitcnt lgkmcnt(6)
  v_pk_add_f32 v[20:21], v[20:21], v[68:69]
  v_pk_add_f32 v[22:23], v[22:23], v[70:71]
  v_cvt_pk_bf16_f32 v82, v20, v21
  v_cvt_pk_bf16_f32 v83, v22, v23
  buffer_store_dwordx4 v[80:83], v1, s[8:11], s48 offen offset:0 sc1
  s_waitcnt lgkmcnt(5)
  v_pk_add_f32 v[24:25], v[24:25], v[40:41]
  v_pk_add_f32 v[26:27], v[26:27], v[42:43]
  s_waitcnt lgkmcnt(4)
  v_pk_add_f32 v[24:25], v[24:25], v[56:57]
  v_pk_add_f32 v[26:27], v[26:27], v[58:59]
  s_waitcnt lgkmcnt(3)
  v_pk_add_f32 v[24:25], v[24:25], v[72:73]
  v_pk_add_f32 v[26:27], v[26:27], v[74:75]
  v_cvt_pk_bf16_f32 v84, v24, v25
  v_cvt_pk_bf16_f32 v85, v26, v27
  s_waitcnt lgkmcnt(2)
  v_pk_add_f32 v[28:29], v[28:29], v[44:45]
  v_pk_add_f32 v[30:31], v[30:31], v[46:47]
  s_waitcnt lgkmcnt(1)
  v_pk_add_f32 v[28:29], v[28:29], v[60:61]
  v_pk_add_f32 v[30:31], v[30:31], v[62:63]
  s_waitcnt lgkmcnt(0)
  v_pk_add_f32 v[28:29], v[28:29], v[76:77]
  v_pk_add_f32 v[30:31], v[30:31], v[78:79]
  v_cvt_pk_bf16_f32 v86, v28, v29
  v_cvt_pk_bf16_f32 v87, v30, v31
  buffer_store_dwordx4 v[84:87], v1, s[8:11], s48 offen offset:1024 sc1
  v_pk_add_f32 v[112:113], v[16:17], v[18:19]
  v_pk_add_f32 v[114:115], v[20:21], v[22:23]
  v_pk_add_f32 v[112:113], v[112:113], v[24:25]
  v_pk_add_f32 v[114:115], v[114:115], v[26:27]
  v_pk_add_f32 v[112:113], v[112:113], v[28:29]
  v_pk_add_f32 v[114:115], v[114:115], v[30:31]
  v_pk_add_f32 v[112:113], v[112:113], v[114:115]
  v_add_f32 v112, v112, v113
  v_mov_b32 v114, v112
  s_nop 1
  v_permlane32_swap_b32 v114, v112
  v_add_f32 v112, v114, v112
  v_mul_f32 v112, 0x3d000000, v112
  v_pk_add_f32 v[16:17], v[16:17], v[112:113] op_sel_hi:[1,0] neg_lo:[0,1] neg_hi:[0,1]
  v_pk_add_f32 v[18:19], v[18:19], v[112:113] op_sel_hi:[1,0] neg_lo:[0,1] neg_hi:[0,1]
  v_pk_add_f32 v[20:21], v[20:21], v[112:113] op_sel_hi:[1,0] neg_lo:[0,1] neg_hi:[0,1]
  v_pk_add_f32 v[22:23], v[22:23], v[112:113] op_sel_hi:[1,0] neg_lo:[0,1] neg_hi:[0,1]
  v_pk_add_f32 v[24:25], v[24:25], v[112:113] op_sel_hi:[1,0] neg_lo:[0,1] neg_hi:[0,1]
  v_pk_add_f32 v[26:27], v[26:27], v[112:113] op_sel_hi:[1,0] neg_lo:[0,1] neg_hi:[0,1]
  v_pk_add_f32 v[28:29], v[28:29], v[112:113] op_sel_hi:[1,0] neg_lo:[0,1] neg_hi:[0,1]
  v_pk_add_f32 v[30:31], v[30:31], v[112:113] op_sel_hi:[1,0] neg_lo:[0,1] neg_hi:[0,1]
  v_pk_mul_f32 v[114:115], v[16:17], v[16:17]
  v_pk_mul_f32 v[16:17], v[18:19], v[18:19]
  v_pk_fma_f32 v[114:115], v[20:21], v[20:21], v[114:115]
  v_pk_fma_f32 v[16:17], v[22:23], v[22:23], v[16:17]
  v_pk_fma_f32 v[114:115], v[24:25], v[24:25], v[114:115]
  v_pk_fma_f32 v[16:17], v[26:27], v[26:27], v[16:17]
  v_pk_fma_f32 v[114:115], v[28:29], v[28:29], v[114:115]
  v_pk_fma_f32 v[16:17], v[30:31], v[30:31], v[16:17]
  v_pk_add_f32 v[114:115], v[114:115], v[16:17]
  v_add_f32 v113, v114, v115
  v_min_u32 v112, -2, v112
  v_mov_b32 v114, v113
  s_nop 1
  v_permlane32_swap_b32 v114, v113
  v_add_f32 v113, v114, v113
  buffer_store_dwordx2 v[112:113], v12, s[8:11], s49 offen sc1
  v_mov_b32 v14, s50
  s_mov_b64 exec, 1
  buffer_store_dword v14, v13, s[8:11], s30 offen
  s_mov_b64 exec, -1
  s_waitcnt vmcnt(4)
  s_barrier
  ds_read_b128 v[88:91], v1 offset:0
  ds_read_b128 v[92:95], v1 offset:1024
  ds_read_b128 v[96:99], v1 offset:2048
  ds_read_b128 v[100:103], v1 offset:3072
  s_cmp_lg_u32 s26, 0
  s_cbranch_scc1 lay_15
  s_lshl_b32 s16, s22, 14
  s_lshl_b32 s17, s20, 8
  s_add_u32 s16, s16, s17
  s_add_u32 s16, s16, 37126144
  s_add_u32 s17, s16, 128
  v_lshlrev_b32 v7, 2, v2
  v_lshl_add_u32 v7, v3, 13, v7
  buffer_load_dword v196, v7, s[8:11], s16 offen offset:0 sc1
  buffer_load_dword v197, v7, s[8:11], s16 offen offset:1024 sc1
  buffer_load_dword v198, v7, s[8:11], s16 offen offset:2048 sc1
  buffer_load_dword v199, v7, s[8:11], s16 offen offset:3072 sc1
  s_add_u32 s19, s16, 4096
  buffer_load_dword v200, v7, s[8:11], s19 offen offset:0 sc1
  buffer_load_dword v201, v7, s[8:11], s19 offen offset:1024 sc1
  buffer_load_dword v202, v7, s[8:11], s19 offen offset:2048 sc1
  buffer_load_dword v203, v7, s[8:11], s19 offen offset:3072 sc1
  buffer_load_dword v204, v7, s[8:11], s17 offen offset:0 sc1
  buffer_load_dword v205, v7, s[8:11], s17 offen offset:1024 sc1
  buffer_load_dword v206, v7, s[8:11], s17 offen offset:2048 sc1
  buffer_load_dword v207, v7, s[8:11], s17 offen offset:3072 sc1
  s_add_u32 s19, s17, 4096
  buffer_load_dword v208, v7, s[8:11], s19 offen offset:0 sc1
  buffer_load_dword v209, v7, s[8:11], s19 offen offset:1024 sc1
  buffer_load_dword v210, v7, s[8:11], s19 offen offset:2048 sc1
  buffer_load_dword v211, v7, s[8:11], s19 offen offset:3072 sc1
lay_15:
  s_add_u32 m0, s31, 98304
  s_nop 0
  buffer_load_dwordx4 v1, s[8:11], s32 offen offset:0 sc1 lds
  buffer_load_dwordx4 v1, s[8:11], s32 offen offset:1024 sc1 lds
  buffer_load_dwordx4 v1, s[8:11], s32 offen offset:2048 sc1 lds
  buffer_load_dwordx4 v1, s[8:11], s32 offen offset:3072 sc1 lds
  s_add_u32 s32, s32, 16384
  s_lshr_b32 s16, s23, 1
  s_mul_i32 s16, s16, 112
  s_lshr_b32 s17, s22, 2
  s_mul_i32 s17, s17, 28
  s_add_u32 s16, s16, s17
  s_and_b32 s17, s22, 3
  s_add_u32 s16, s16, s17
  s_lshl_b32 s16, s16, 1
  s_and_b32 s17, s20, 1
  s_add_u32 s16, s16, s17
  s_lshl_b32 s16, s16, 10
  s_mul_i32 s17, s26, 7340032
  s_add_u32 s16, s16, s17
  s_add_u32 s52, s16, 21233664
  s_lshl_b32 s53, s26, 2
  s_add_u32 s54, s53, 2
  s_add_u32 s55, s53, 3
  s_add_u32 s53, s53, 1
  s_mul_i32 s37, s24, 229376
  s_mul_i32 s16, s20, 57344
  s_add_u32 s37, s37, s16
  s_add_u32 s37, s37, s17
  s_add_u32 s37, s37, 21233664
  s_mul_i32 s34, s26, 4194304
  s_lshl_b32 s16, s23, 15
  s_add_u32 s34, s34, s16
  s_add_u32 s34, s34, 9699328
  s_mul_i32 s35, s26, 524288
  s_lshl_b32 s16, s23, 12
  s_add_u32 s35, s35, s16
  s_add_u32 s35, s35, 16252928
  s_mov_b32 s58, 0
poll_16:
  buffer_load_dword v14, v138, s[8:11], s42 offen sc1
  s_waitcnt vmcnt(0)
  v_cmp_gt_u32 vcc, s50, v14
  s_add_u32 s58, s58, 1
  s_cmp_gt_u32 s58, 0x200000
  s_cbranch_scc1 poll_16_x
  s_cbranch_vccnz poll_16
poll_16_x:
  buffer_load_dwordx4 a[0:3], v1, s[8:11], s34 offen offset:0 sc1
  buffer_load_dwordx4 a[4:7], v1, s[8:11], s34 offen offset:1024 sc1
  buffer_load_dwordx4 a[8:11], v1, s[8:11], s34 offen offset:2048 sc1
  buffer_load_dwordx4 a[12:15], v1, s[8:11], s34 offen offset:3072 sc1
  s_add_u32 s34, s34, 4096
  buffer_load_dwordx4 a[16:19], v1, s[8:11], s34 offen offset:0 sc1
  buffer_load_dwordx4 a[20:23], v1, s[8:11], s34 offen offset:1024 sc1
  buffer_load_dwordx4 a[24:27], v1, s[8:11], s34 offen offset:2048 sc1
  buffer_load_dwordx4 a[28:31], v1, s[8:11], s34 offen offset:3072 sc1
  s_add_u32 s34, s34, 4096
  buffer_load_dwordx4 a[32:35], v1, s[8:11], s34 offen offset:0 sc1
  buffer_load_dwordx4 a[36:39], v1, s[8:11], s34 offen offset:1024 sc1
  s_add_u32 s16, s50, 8
  v_mov_b32 v14, s16
  s_mov_b64 exec, 1
  buffer_store_dword v14, v13, s[8:11], s30 offen
  s_mov_b64 exec, -1
  s_waitcnt vmcnt(10) lgkmcnt(3)
  v_mfma_f32_32x32x16_bf16 v[16:31], v[88:91], a[0:3], 0
  ds_read_b128 v[104:107], v1 offset:4096
  s_waitcnt lgkmcnt(3)
  v_mfma_f32_32x32x16_bf16 v[32:47], v[92:95], a[0:3], 0
  ds_read_b128 v[108:111], v1 offset:5120
  s_waitcnt lgkmcnt(2)
  v_mfma_f32_32x32x16_bf16 v[48:63], v[96:99], a[0:3], 0
  ds_read_b128 v[112:115], v1 offset:6144
  buffer_load_dwordx4 a[40:43], v1, s[8:11], s34 offen offset:2048 sc1
  s_waitcnt vmcnt(10)
  v_mfma_f32_32x32x16_bf16 v[16:31], v[100:103], a[4:7], v[16:31]
  ds_read_b128 v[116:119], v1 offset:7168
  buffer_load_dwordx2 v[120:121], v4, s[8:11], s35 offen offset:0 sc1
  s_waitcnt lgkmcnt(2)
  v_mfma_f32_32x32x16_bf16 v[32:47], v[104:107], a[4:7], v[32:47]
  ds_read_b128 v[88:91], v1 offset:8192
  s_add_u32 m0, s31, 114688
  s_nop 0
  buffer_load_dwordx4 v1, s[8:11], s32 offen offset:0 sc1 lds
  buffer_load_dwordx2 v[122:123], v4, s[8:11], s35 offen offset:256 sc1
  v_mfma_f32_32x32x16_bf16 v[48:63], v[108:111], a[4:7], v[48:63]
  ds_read_b128 v[92:95], v1 offset:9216
  buffer_load_dwordx4 a[44:47], v1, s[8:11], s34 offen offset:3072 sc1
  s_add_u32 s34, s34, 4096
  buffer_load_dwordx2 v[124:125], v4, s[8:11], s35 offen offset:512 sc1
  s_waitcnt lgkmcnt(2)
  s_waitcnt vmcnt(14)
  v_mfma_f32_32x32x16_bf16 v[16:31], v[112:115], a[8:11], v[16:31]
  ds_read_b128 v[96:99], v1 offset:10240
  buffer_load_dwordx2 v[126:127], v4, s[8:11], s35 offen offset:768 sc1
  v_mfma_f32_32x32x16_bf16 v[32:47], v[116:119], a[8:11], v[32:47]
  ds_read_b128 v[100:103], v1 offset:11264
  buffer_load_dwordx2 v[128:129], v4, s[8:11], s35 offen offset:1024 sc1
  s_waitcnt lgkmcnt(2)
  v_mfma_f32_32x32x16_bf16 v[48:63], v[88:91], a[8:11], v[48:63]
  ds_read_b128 v[104:107], v1 offset:12288
  buffer_load_dwordx4 a[48:51], v1, s[8:11], s34 offen offset:0 sc1
  buffer_load_dwordx2 v[130:131], v4, s[8:11], s35 offen offset:1280 sc1
  s_waitcnt vmcnt(17)
  v_mfma_f32_32x32x16_bf16 v[16:31], v[92:95], a[12:15], v[16:31]
  ds_read_b128 v[108:111], v1 offset:13312
  buffer_load_dwordx2 v[132:133], v4, s[8:11], s35 offen offset:1536 sc1
  s_waitcnt lgkmcnt(2)
  v_mfma_f32_32x32x16_bf16 v[32:47], v[96:99], a[12:15], v[32:47]
  ds_read_b128 v[112:115], v1 offset:14336
  buffer_load_dwordx2 v[134:135], v4, s[8:11], s35 offen offset:1792 sc1
  v_mfma_f32_32x32x16_bf16 v[48:63], v[100:103], a[12:15], v[48:63]
  ds_read_b128 v[116:119], v1 offset:15360
  buffer_load_dwordx4 a[52:55], v1, s[8:11], s34 offen offset:1024 sc1
  buffer_load_dwordx4 v1, s[8:11], s32 offen offset:1024 sc1 lds
  s_waitcnt lgkmcnt(2)
  s_waitcnt vmcnt(20)
  v_mfma_f32_32x32x16_bf16 v[16:31], v[104:107], a[16:19], v[16:31]
  ds_read_b128 v[88:91], v1 offset:16384
  v_mfma_f32_32x32x16_bf16 v[32:47], v[108:111], a[16:19], v[32:47]
  ds_read_b128 v[92:95], v1 offset:17408
  s_waitcnt lgkmcnt(2)
  v_mfma_f32_32x32x16_bf16 v[48:63], v[112:115], a[16:19], v[48:63]
  ds_read_b128 v[96:99], v1 offset:18432
  buffer_load_dwordx4 a[56:59], v1, s[8:11], s34 offen offset:2048 sc1
  s_waitcnt vmcnt(20)
  v_mfma_f32_32x32x16_bf16 v[16:31], v[116:119], a[20:23], v[16:31]
  ds_read_b128 v[100:103], v1 offset:19456
  s_waitcnt lgkmcnt(2)
  v_mfma_f32_32x32x16_bf16 v[32:47], v[88:91], a[20:23], v[32:47]
  ds_read_b128 v[104:107], v1 offset:20480
  v_mfma_f32_32x32x16_bf16 v[48:63], v[92:95], a[20:23], v[48:63]
  ds_read_b128 v[108:111], v1 offset:21504
  buffer_load_dwordx4 a[60:63], v1, s[8:11], s34 offen offset:3072 sc1
  s_add_u32 s34, s34, 4096
  s_waitcnt lgkmcnt(2)
  s_waitcnt vmcnt(20)
  v_mfma_f32_32x32x16_bf16 v[16:31], v[96:99], a[24:27], v[16:31]
  ds_read_b128 v[112:115], v1 offset:22528
  buffer_load_dwordx4 v1, s[8:11], s32 offen offset:2048 sc1 lds
  v_mfma_f32_32x32x16_bf16 v[32:47], v[100:103], a[24:27], v[32:47]
  ds_read_b128 v[116:119], v1 offset:23552
  s_waitcnt lgkmcnt(2)
  v_mfma_f32_32x32x16_bf16 v[48:63], v[104:107], a[24:27], v[48:63]
  ds_read_b128 v[88:91], v1 offset:24576
  buffer_load_dwordx4 a[64:67], v1, s[8:11], s34 offen offset:0 sc1
  s_waitcnt vmcnt(21)
  v_mfma_f32_32x32x16_bf16 v[16:31], v[108:111], a[28:31], v[16:31]
  ds_read_b128 v[92:95], v1 offset:25600
  s_waitcnt lgkmcnt(2)
  v_mfma_f32_32x32x16_bf16 v[32:47], v[112:115], a[28:31], v[32:47]
  ds_read_b128 v[96:99], v1 offset:26624
  v_mfma_f32_32x32x16_bf16 v[48:63], v[116:119], a[28:31], v[48:63]
  ds_read_b128 v[100:103], v1 offset:27648
  buffer_load_dwordx4 a[68:71], v1, s[8:11], s34 offen offset:1024 sc1
  s_waitcnt lgkmcnt(2)
  s_waitcnt vmcnt(21)
  v_mfma_f32_32x32x16_bf16 v[16:31], v[88:91], a[32:35], v[16:31]
  ds_read_b128 v[104:107], v1 offset:28672
  v_mfma_f32_32x32x16_bf16 v[32:47], v[92:95], a[32:35], v[32:47]
  ds_read_b128 v[108:111], v1 offset:29696
  buffer_load_dwordx4 v1, s[8:11], s32 offen offset:3072 sc1 lds
  s_add_u32 s32, s32, 16384
  s_waitcnt lgkmcnt(2)
  v_mfma_f32_32x32x16_bf16 v[48:63], v[96:99], a[32:35], v[48:63]
  ds_read_b128 v[112:115], v1 offset:30720
  buffer_load_dwordx4 a[72:75], v1, s[8:11], s34 offen offset:2048 sc1
  s_waitcnt vmcnt(22)
  v_mfma_f32_32x32x16_bf16 v[16:31], v[100:103], a[36:39], v[16:31]
  ds_read_b128 v[116:119], v1 offset:31744
  s_waitcnt lgkmcnt(2)
  v_mfma_f32_32x32x16_bf16 v[32:47], v[104:107], a[36:39], v[32:47]
  s_cmp_lg_u32 s26, 0
  s_cbranch_scc1 lay_17
  v_add_f32 v196, v196, v197
  v_add_f32 v196, v196, v198
  v_add_f32 v196, v196, v199
  v_add_f32 v196, v196, v200
  v_add_f32 v196, v196, v201
  v_add_f32 v196, v196, v202
  v_add_f32 v196, v196, v203
  v_mov_b32 v197, v196
  s_nop 1
  v_permlane32_swap_b32 v197, v196
  v_add_f32 v196, v197, v196
  v_cvt_pk_bf16_f32 v212, v196, v196
  v_lshlrev_b32 v197, 16, v212
  v_sub_f32 v197, v196, v197
  v_cvt_pk_bf16_f32 v213, v197, 0
  v_cmp_eq_u32 vcc, 0, v3
  v_mov_b32 v214, 0
  v_mov_b32 v215, 0
  v_cndmask_b32 v212, 0, v212, vcc
  v_cndmask_b32 v213, 0, v213, vcc
  v_add_u32 v198, s98, v1
  ds_write_b128 v198, v[212:215]
  s_cmp_eq_u32 s20, 3
  s_cbranch_scc1 cs_18
  v_add_f32 v204, v204, v205
  v_add_f32 v204, v204, v206
  v_add_f32 v204, v204, v207
  v_add_f32 v204, v204, v208
  v_add_f32 v204, v204, v209
  v_add_f32 v204, v204, v210
  v_add_f32 v204, v204, v211
  v_mov_b32 v205, v204
  s_nop 1
  v_permlane32_swap_b32 v205, v204
  v_add_f32 v204, v205, v204
  v_cvt_pk_bf16_f32 v216, v204, v204
  v_lshlrev_b32 v205, 16, v216
  v_sub_f32 v205, v204, v205
  v_cvt_pk_bf16_f32 v217, v205, 0
  v_cmp_eq_u32 vcc, 0, v3
  v_mov_b32 v218, 0
  v_mov_b32 v219, 0
  v_cndmask_b32 v216, 0, v216, vcc
  v_cndmask_b32 v217, 0, v217, vcc
  v_add_u32 v206, s99, v1
  ds_write_b128 v206, v[216:219]
cs_18:
lay_17:
  s_waitcnt lgkmcnt(0)
  s_barrier
  ds_read_b128 v[88:91], v1 offset:32768
  v_mfma_f32_32x32x16_bf16 v[48:63], v[108:111], a[36:39], v[48:63]
  ds_read_b128 v[92:95], v1 offset:33792
  buffer_load_dwordx4 a[76:79], v1, s[8:11], s34 offen offset:3072 sc1
  s_add_u32 s34, s34, 4096
  s_waitcnt lgkmcnt(2)
  s_waitcnt vmcnt(21)
  v_mfma_f32_32x32x16_bf16 v[16:31], v[112:115], a[40:43], v[16:31]
  ds_read_b128 v[96:99], v1 offset:34816
  v_mfma_f32_32x32x16_bf16 v[32:47], v[116:119], a[40:43], v[32:47]
  ds_read_b128 v[100:103], v1 offset:35840
  s_waitcnt lgkmcnt(2)
  v_mfma_f32_32x32x16_bf16 v[48:63], v[88:91], a[40:43], v[48:63]
  ds_read_b128 v[104:107], v1 offset:36864
  buffer_load_dwordx4 a[80:83], v1, s[8:11], s34 offen offset:0 sc1
  s_add_u32 m0, s31, 131072
  s_nop 0
  buffer_load_dwordx4 v1, s[8:11], s32 offen offset:0 sc1 lds
  s_waitcnt vmcnt(19)
  v_mfma_f32_32x32x16_bf16 v[16:31], v[92:95], a[44:47], v[16:31]
  ds_read_b128 v[108:111], v1 offset:37888
  s_waitcnt lgkmcnt(2)
  v_mfma_f32_32x32x16_bf16 v[32:47], v[96:99], a[44:47], v[32:47]
  ds_read_b128 v[112:115], v1 offset:38912
  v_mfma_f32_32x32x16_bf16 v[48:63], v[100:103], a[44:47], v[48:63]
  ds_read_b128 v[116:119], v1 offset:39936
  buffer_load_dwordx4 a[84:87], v1, s[8:11], s34 offen offset:1024 sc1
  s_waitcnt lgkmcnt(2)
  s_waitcnt vmcnt(16)
  v_mfma_f32_32x32x16_bf16 v[16:31], v[104:107], a[48:51], v[16:31]
  ds_read_b128 v[88:91], v1 offset:40960
  v_mfma_f32_32x32x16_bf16 v[32:47], v[108:111], a[48:51], v[32:47]
  ds_read_b128 v[92:95], v1 offset:41984
  s_waitcnt lgkmcnt(2)
  v_mfma_f32_32x32x16_bf16 v[48:63], v[112:115], a[48:51], v[48:63]
  ds_read_b128 v[96:99], v1 offset:43008
  buffer_load_dwordx4 a[88:91], v1, s[8:11], s34 offen offset:2048 sc1
  s_waitcnt vmcnt(13)
  v_mfma_f32_32x32x16_bf16 v[16:31], v[116:119], a[52:55], v[16:31]
  ds_read_b128 v[100:103], v1 offset:44032
  buffer_load_dwordx4 v1, s[8:11], s32 offen offset:1024 sc1 lds
  s_waitcnt lgkmcnt(2)
  v_mfma_f32_32x32x16_bf16 v[32:47], v[88:91], a[52:55], v[32:47]
  ds_read_b128 v[104:107], v1 offset:45056
  v_add_f32 v136, v120, v122
  v_mfma_f32_32x32x16_bf16 v[48:63], v[92:95], a[52:55], v[48:63]
  ds_read_b128 v[108:111], v1 offset:46080
  buffer_load_dwordx4 a[92:95], v1, s[8:11], s34 offen offset:3072 sc1
  s_add_u32 s34, s34, 4096
  v_add_f32 v137, v121, v123
  s_waitcnt lgkmcnt(2)
  s_waitcnt vmcnt(13)
  v_mfma_f32_32x32x16_bf16 v[16:31], v[96:99], a[56:59], v[16:31]
  ds_read_b128 v[112:115], v1 offset:47104
  v_add_f32 v136, v136, v124
  v_mfma_f32_32x32x16_bf16 v[32:47], v[100:103], a[56:59], v[32:47]
  ds_read_b128 v[116:119], v1 offset:48128
  v_add_f32 v137, v137, v125
  s_waitcnt lgkmcnt(2)
  v_mfma_f32_32x32x16_bf16 v[48:63], v[104:107], a[56:59], v[48:63]
  ds_read_b128 v[88:91], v1 offset:49152
  buffer_load_dwordx4 a[96:99], v1, s[8:11], s34 offen offset:0 sc1
  v_add_f32 v136, v136, v126
  s_waitcnt vmcnt(13)
  v_mfma_f32_32x32x16_bf16 v[16:31], v[108:111], a[60:63], v[16:31]
  ds_read_b128 v[92:95], v1 offset:50176
  v_add_f32 v137, v137, v127
  s_waitcnt lgkmcnt(2)
  v_mfma_f32_32x32x16_bf16 v[32:47], v[112:115], a[60:63], v[32:47]
  ds_read_b128 v[96:99], v1 offset:51200
  buffer_load_dwordx4 v1, s[8:11], s32 offen offset:2048 sc1 lds
  v_add_f32 v136, v136, v128
  v_mfma_f32_32x32x16_bf16 v[48:63], v[116:119], a[60:63], v[48:63]
  ds_read_b128 v[100:103], v1 offset:52224
  buffer_load_dwordx4 a[100:103], v1, s[8:11], s34 offen offset:1024 sc1
  v_add_f32 v137, v137, v129
  s_waitcnt lgkmcnt(2)
  s_waitcnt vmcnt(13)
  v_mfma_f32_32x32x16_bf16 v[16:31], v[88:91], a[64:67], v[16:31]
  ds_read_b128 v[104:107], v1 offset:53248
  v_add_f32 v136, v136, v130
  v_mfma_f32_32x32x16_bf16 v[32:47], v[92:95], a[64:67], v[32:47]
  ds_read_b128 v[108:111], v1 offset:54272
  v_add_f32 v137, v137, v131
  s_waitcnt lgkmcnt(2)
  v_mfma_f32_32x32x16_bf16 v[48:63], v[96:99], a[64:67], v[48:63]
  ds_read_b128 v[112:115], v1 offset:55296
  buffer_load_dwordx4 a[104:107], v1, s[8:11], s34 offen offset:2048 sc1
  v_add_f32 v136, v136, v132
  s_waitcnt vmcnt(13)
  v_mfma_f32_32x32x16_bf16 v[16:31], v[100:103], a[68:71], v[16:31]
  ds_read_b128 v[116:119], v1 offset:56320
  v_add_f32 v137, v137, v133
  s_waitcnt lgkmcnt(2)
  v_mfma_f32_32x32x16_bf16 v[32:47], v[104:107], a[68:71], v[32:47]
  ds_read_b128 v[88:91], v1 offset:57344
  v_add_f32 v136, v136, v134
  v_mfma_f32_32x32x16_bf16 v[48:63], v[108:111], a[68:71], v[48:63]
  ds_read_b128 v[92:95], v1 offset:58368
  buffer_load_dwordx4 a[108:111], v1, s[8:11], s34 offen offset:3072 sc1
  s_add_u32 s34, s34, 4096
  buffer_load_dwordx4 v1, s[8:11], s32 offen offset:3072 sc1 lds
  s_add_u32 s32, s32, 16384
  v_add_f32 v137, v137, v135
  s_waitcnt lgkmcnt(2)
  s_waitcnt vmcnt(13)
  v_mfma_f32_32x32x16_bf16 v[16:31], v[112:115], a[72:75], v[16:31]
  ds_read_b128 v[96:99], v1 offset:59392
  v_mov_b32 v156, v136
  v_mfma_f32_32x32x16_bf16 v[32:47], v[116:119], a[72:75], v[32:47]
  ds_read_b128 v[100:103], v1 offset:60416
  v_permlane32_swap_b32 v156, v136
  s_waitcnt lgkmcnt(2)
  v_mfma_f32_32x32x16_bf16 v[48:63], v[88:91], a[72:75], v[48:63]
  ds_read_b128 v[104:107], v1 offset:61440
  buffer_load_dwordx4 a[112:115], v1, s[8:11], s34 offen offset:0 sc1
  v_add_f32 v136, v156, v136
  s_waitcnt vmcnt(13)
  v_mfma_f32_32x32x16_bf16 v[16:31], v[92:95], a[76:79], v[16:31]
  ds_read_b128 v[108:111], v1 offset:62464
  v_mul_f32 v136, 0x3d800000, v136
  s_waitcnt lgkmcnt(2)
  v_mfma_f32_32x32x16_bf16 v[32:47], v[96:99], a[76:79], v[32:47]
  ds_read_b128 v[112:115], v1 offset:63488
  v_sub_f32 v120, v120, v136
  v_mfma_f32_32x32x16_bf16 v[48:63], v[100:103], a[76:79], v[48:63]
  ds_read_b128 v[116:119], v1 offset:64512
  buffer_load_dwordx4 a[116:119], v1, s[8:11], s34 offen offset:1024 sc1
  v_sub_f32 v122, v122, v136
  s_waitcnt lgkmcnt(2)
  s_waitcnt vmcnt(13)
  v_mfma_f32_32x32x16_bf16 v[16:31], v[104:107], a[80:83], v[16:31]
  ds_read_b128 v[88:91], v5 offset:0
  s_add_u32 m0, s31, 0
  s_nop 0
  buffer_load_dwordx4 v1, s[8:11], s32 offen offset:0 sc1 lds
  v_sub_f32 v124, v124, v136
  v_mfma_f32_32x32x16_bf16 v[32:47], v[108:111], a[80:83], v[32:47]
  ds_read_b128 v[92:95], v5 offset:1024
  v_sub_f32 v126, v126, v136
  s_waitcnt lgkmcnt(2)
  v_mfma_f32_32x32x16_bf16 v[48:63], v[112:115], a[80:83], v[48:63]
  ds_read_b128 v[96:99], v5 offset:2048
  buffer_load_dwordx4 a[120:123], v1, s[8:11], s34 offen offset:2048 sc1
  v_sub_f32 v128, v128, v136
  s_waitcnt vmcnt(13)
  v_mfma_f32_32x32x16_bf16 v[16:31], v[116:119], a[84:87], v[16:31]
  ds_read_b128 v[100:103], v5 offset:3072
  v_sub_f32 v130, v130, v136
  v_sub_f32 v132, v132, v136
  s_waitcnt lgkmcnt(2)
  v_mfma_f32_32x32x16_bf16 v[32:47], v[88:91], a[84:87], v[32:47]
  ds_read_b128 v[104:107], v5 offset:4096
  v_sub_f32 v134, v134, v136
  v_mfma_f32_32x32x16_bf16 v[48:63], v[92:95], a[84:87], v[48:63]
  ds_read_b128 v[108:111], v5 offset:5120
  buffer_load_dwordx4 a[124:127], v1, s[8:11], s34 offen offset:3072 sc1
  s_add_u32 s34, s34, 4096
  v_mul_f32 v156, v120, v120
  s_waitcnt lgkmcnt(2)
  s_waitcnt vmcnt(13)
  v_mfma_f32_32x32x16_bf16 v[16:31], v[96:99], a[88:91], v[16:31]
  ds_read_b128 v[112:115], v5 offset:6144
  v_fmac_f32 v156, v122, v122
  v_mfma_f32_32x32x16_bf16 v[32:47], v[100:103], a[88:91], v[32:47]
  ds_read_b128 v[116:119], v5 offset:7168
  buffer_load_dwordx4 v1, s[8:11], s32 offen offset:1024 sc1 lds
  v_fmac_f32 v156, v124, v124
  s_waitcnt lgkmcnt(2)
  v_mfma_f32_32x32x16_bf16 v[48:63], v[104:107], a[88:91], v[48:63]
  ds_read_b128 v[88:91], v5 offset:8192
  v_fmac_f32 v156, v126, v126
  s_waitcnt vmcnt(12)
  v_mfma_f32_32x32x16_bf16 v[16:31], v[108:111], a[92:95], v[16:31]
  ds_read_b128 v[92:95], v5 offset:9216
  v_fmac_f32 v156, v128, v128
  s_waitcnt lgkmcnt(2)
  v_mfma_f32_32x32x16_bf16 v[32:47], v[112:115], a[92:95], v[32:47]
  ds_read_b128 v[96:99], v5 offset:10240
  v_fmac_f32 v156, v130, v130
  v_mfma_f32_32x32x16_bf16 v[48:63], v[116:119], a[92:95], v[48:63]
  ds_read_b128 v[100:103], v5 offset:11264
  v_fmac_f32 v156, v132, v132
  s_waitcnt lgkmcnt(2)
  s_waitcnt vmcnt(11)
  v_mfma_f32_32x32x16_bf16 v[16:31], v[88:91], a[96:99], v[16:31]
  ds_read_b128 v[104:107], v5 offset:12288
  v_fmac_f32 v156, v134, v134
  v_mfma_f32_32x32x16_bf16 v[32:47], v[92:95], a[96:99], v[32:47]
  ds_read_b128 v[108:111], v5 offset:13312
  v_fmamk_f32 v137, v156, 0x42000000, v137
  s_waitcnt lgkmcnt(2)
  v_mfma_f32_32x32x16_bf16 v[48:63], v[96:99], a[96:99], v[48:63]
  ds_read_b128 v[112:115], v5 offset:14336
  v_mov_b32 v156, v137
  s_waitcnt vmcnt(9)
  v_mfma_f32_32x32x16_bf16 v[16:31], v[100:103], a[100:103], v[16:31]
  ds_read_b128 v[116:119], v5 offset:15360
  buffer_load_dwordx4 v1, s[8:11], s32 offen offset:2048 sc1 lds
  v_permlane32_swap_b32 v156, v137
  s_waitcnt lgkmcnt(2)
  v_mfma_f32_32x32x16_bf16 v[32:47], v[104:107], a[100:103], v[32:47]
  ds_read_b128 v[88:91], v5 offset:16384
  v_add_f32 v137, v156, v137
  v_mfma_f32_32x32x16_bf16 v[48:63], v[108:111], a[100:103], v[48:63]
  ds_read_b128 v[92:95], v5 offset:17408
  v_mov_b32 v156, 0x3727c5ac
  s_waitcnt lgkmcnt(2)
  s_waitcnt vmcnt(9)
  v_mfma_f32_32x32x16_bf16 v[16:31], v[112:115], a[104:107], v[16:31]
  ds_read_b128 v[96:99], v5 offset:18432
  v_fmamk_f32 v137, v137, 0x3b000000, v156
  v_mfma_f32_32x32x16_bf16 v[32:47], v[116:119], a[104:107], v[32:47]
  ds_read_b128 v[100:103], v5 offset:19456
  v_rsq_f32 v137, v137
  s_waitcnt lgkmcnt(2)
  v_mfma_f32_32x32x16_bf16 v[48:63], v[88:91], a[104:107], v[48:63]
  ds_read_b128 v[104:107], v5 offset:20480
  v_sub_f32 v156, 0, v136
  s_waitcnt vmcnt(8)
  v_mfma_f32_32x32x16_bf16 v[16:31], v[92:95], a[108:111], v[16:31]
  ds_read_b128 v[108:111], v5 offset:21504
  v_cvt_pk_bf16_f32 v141, v156, 0
  s_waitcnt lgkmcnt(2)
  v_mfma_f32_32x32x16_bf16 v[32:47], v[96:99], a[108:111], v[32:47]
  ds_read_b128 v[112:115], v5 offset:22528
  buffer_load_dwordx4 v1, s[8:11], s32 offen offset:3072 sc1 lds
  s_add_u32 s32, s32, 16384
  v_lshlrev_b32 v157, 16, v141
  v_mfma_f32_32x32x16_bf16 v[48:63], v[100:103], a[108:111], v[48:63]
  ds_read_b128 v[116:119], v5 offset:23552
  v_sub_f32 v157, v156, v157
  s_waitcnt lgkmcnt(2)
  s_waitcnt vmcnt(7)
  v_mfma_f32_32x32x16_bf16 v[16:31], v[104:107], a[112:115], v[16:31]
  ds_read_b128 v[88:91], v5 offset:24576
  v_cvt_pk_bf16_f32 v140, v156, v157
  v_mfma_f32_32x32x16_bf16 v[32:47], v[108:111], a[112:115], v[32:47]
  ds_read_b128 v[92:95], v5 offset:25600
  v_mov_b32 v143, 0
  s_waitcnt lgkmcnt(2)
  v_mfma_f32_32x32x16_bf16 v[48:63], v[112:115], a[112:115], v[48:63]
  ds_read_b128 v[96:99], v5 offset:26624
  v_mov_b32 v142, 0
  s_waitcnt vmcnt(6)
  v_mfma_f32_32x32x16_bf16 v[16:31], v[116:119], a[116:119], v[16:31]
  ds_read_b128 v[100:103], v5 offset:27648
  v_mul_f32 v136, 0xbfb8aa3b, v137
  v_rcp_f32 v137, v137
  s_waitcnt lgkmcnt(2)
  v_mfma_f32_32x32x16_bf16 v[32:47], v[88:91], a[116:119], v[32:47]
  ds_read_b128 v[104:107], v5 offset:28672
  v_mfma_f32_32x32x16_bf16 v[48:63], v[92:95], a[116:119], v[48:63]
  ds_read_b128 v[108:111], v5 offset:29696
  s_waitcnt lgkmcnt(2)
  s_waitcnt vmcnt(4)
  v_mfma_f32_32x32x16_bf16 v[16:31], v[96:99], a[120:123], v[16:31]
  ds_read_b128 v[112:115], v5 offset:30720
  v_mfma_f32_32x32x16_bf16 v[32:47], v[100:103], a[120:123], v[32:47]
  ds_read_b128 v[116:119], v5 offset:31744
  s_waitcnt lgkmcnt(2)
  v_mfma_f32_32x32x16_bf16 v[48:63], v[104:107], a[120:123], v[48:63]
  ds_read_b128 v[88:91], v6 offset:19456
  s_waitcnt vmcnt(3)
  v_mfma_f32_32x32x16_bf16 v[16:31], v[108:111], a[124:127], v[16:31]
  ds_read_b128 v[92:95], v6 offset:20480
  s_waitcnt lgkmcnt(2)
  v_mfma_f32_32x32x16_bf16 v[32:47], v[112:115], a[124:127], v[32:47]
  ds_read_b128 v[96:99], v6 offset:21504
  v_mfma_f32_32x32x16_bf16 v[48:63], v[116:119], a[124:127], v[48:63]
  s_barrier
  ds_read_b128 v[100:103], v5 offset:32768
  s_waitcnt lgkmcnt(2)
  v_mfma_f32_32x32x16_bf16 v[16:31], v[88:91], v[140:143], v[16:31]
  ds_read_b128 v[104:107], v5 offset:33792
  v_mfma_f32_32x32x16_bf16 v[32:47], v[92:95], v[140:143], v[32:47]
  ds_read_b128 v[108:111], v5 offset:34816
  s_waitcnt lgkmcnt(2)
  v_mfma_f32_32x32x16_bf16 v[48:63], v[96:99], v[140:143], v[48:63]
  ds_read_b128 v[112:115], v5 offset:35840
  s_nop 5
  v_cmp_u_f32 vcc, v16, v136
  s_nop 0
  s_cbranch_vccnz L_fast_k3redo
L_fast_k3ok:
  s_waitcnt lgkmcnt(3)
  v_mfma_f32_32x32x16_bf16 v[64:79], v[100:103], a[0:3], 0
  ds_read_b128 v[116:119], v5 offset:36864
  s_waitcnt lgkmcnt(2)
  v_mfma_f32_32x32x16_bf16 v[64:79], v[104:107], a[4:7], v[64:79]
  ds_read_b128 v[88:91], v5 offset:37888
  s_add_u32 m0, s31, 16384
  s_nop 0
  buffer_load_dwordx4 v1, s[8:11], s32 offen offset:0 sc1 lds
  v_mul_f32 v144, v136, v16
  v_mul_f32 v145, v136, v17
  v_mfma_f32_32x32x16_bf16 v[64:79], v[108:111], a[8:11], v[64:79]
  ds_read_b128 v[92:95], v5 offset:38912
  v_exp_f32 v144, v144
  v_mul_f32 v146, v136, v18
  s_waitcnt lgkmcnt(2)
  v_mfma_f32_32x32x16_bf16 v[64:79], v[112:115], a[12:15], v[64:79]
  ds_read_b128 v[96:99], v5 offset:39936
  buffer_load_dwordx4 v1, s[8:11], s32 offen offset:1024 sc1 lds
  v_exp_f32 v145, v145
  v_fma_f32 v144, v144, v137, v137
  v_mfma_f32_32x32x16_bf16 v[64:79], v[116:119], a[16:19], v[64:79]
  ds_read_b128 v[100:103], v5 offset:40960
  v_mul_f32 v147, v136, v19
  v_exp_f32 v146, v146
  s_waitcnt lgkmcnt(2)
  v_mfma_f32_32x32x16_bf16 v[64:79], v[88:91], a[20:23], v[64:79]
  ds_read_b128 v[104:107], v5 offset:41984
  v_fma_f32 v145, v145, v137, v137
  v_rcp_f32 v144, v144
  v_mfma_f32_32x32x16_bf16 v[64:79], v[92:95], a[24:27], v[64:79]
  ds_read_b128 v[108:111], v5 offset:43008
  buffer_load_dwordx4 v1, s[8:11], s32 offen offset:2048 sc1 lds
  v_mul_f32 v148, v136, v20
  v_exp_f32 v147, v147
  s_waitcnt lgkmcnt(2)
  v_mfma_f32_32x32x16_bf16 v[64:79], v[96:99], a[28:31], v[64:79]
  ds_read_b128 v[112:115], v5 offset:44032
  v_fma_f32 v146, v146, v137, v137
  v_rcp_f32 v145, v145
  v_mul_f32 v144, v144, v24
  v_mfma_f32_32x32x16_bf16 v[64:79], v[100:103], a[32:35], v[64:79]
  ds_read_b128 v[116:119], v5 offset:45056
  buffer_load_dwordx4 v1, s[8:11], s32 offen offset:3072 sc1 lds
  s_add_u32 s32, s32, 16384
  v_mul_f32 v149, v136, v21
  v_exp_f32 v148, v148
  s_waitcnt lgkmcnt(2)
  v_mfma_f32_32x32x16_bf16 v[64:79], v[104:107], a[36:39], v[64:79]
  ds_read_b128 v[88:91], v5 offset:46080
  v_fma_f32 v147, v147, v137, v137
  v_rcp_f32 v146, v146
  v_mfma_f32_32x32x16_bf16 v[64:79], v[108:111], a[40:43], v[64:79]
  ds_read_b128 v[92:95], v5 offset:47104
  v_mul_f32 v145, v145, v25
  v_cvt_pk_bf16_f32 v120, v144, v145
  s_waitcnt lgkmcnt(2)
  v_mfma_f32_32x32x16_bf16 v[64:79], v[112:115], a[44:47], v[64:79]
  ds_read_b128 v[96:99], v5 offset:48128
  s_add_u32 m0, s31, 32768
  s_nop 0
  buffer_load_dwordx4 v1, s[8:11], s32 offen offset:0 sc1 lds
  v_mul_f32 v150, v136, v22
  v_exp_f32 v149, v149
  v_mfma_f32_32x32x16_bf16 v[64:79], v[116:119], a[48:51], v[64:79]
  ds_read_b128 v[100:103], v5 offset:49152
  v_fma_f32 v148, v148, v137, v137
  v_rcp_f32 v147, v147
  s_waitcnt lgkmcnt(2)
  v_mfma_f32_32x32x16_bf16 v[64:79], v[88:91], a[52:55], v[64:79]
  ds_read_b128 v[104:107], v5 offset:50176
  buffer_load_dwordx4 v1, s[8:11], s32 offen offset:1024 sc1 lds
  v_mul_f32 v146, v146, v26
  v_mul_f32 v151, v136, v23
  v_exp_f32 v150, v150
  v_mfma_f32_32x32x16_bf16 v[64:79], v[92:95], a[56:59], v[64:79]
  ds_read_b128 v[108:111], v5 offset:51200
  v_fma_f32 v149, v149, v137, v137
  v_rcp_f32 v148, v148
  s_waitcnt lgkmcnt(2)
  v_mfma_f32_32x32x16_bf16 v[64:79], v[96:99], a[60:63], v[64:79]
  ds_read_b128 v[112:115], v5 offset:52224
  v_mul_f32 v147, v147, v27
  v_cvt_pk_bf16_f32 v121, v146, v147
  v_mfma_f32_32x32x16_bf16 v[64:79], v[100:103], a[64:67], v[64:79]
  ds_read_b128 v[116:119], v5 offset:53248
  buffer_load_dwordx4 v1, s[8:11], s32 offen offset:2048 sc1 lds
  v_exp_f32 v151, v151
  v_fma_f32 v150, v150, v137, v137
  s_waitcnt lgkmcnt(2)
  v_mfma_f32_32x32x16_bf16 v[64:79], v[104:107], a[68:71], v[64:79]
  ds_read_b128 v[88:91], v5 offset:54272
  v_rcp_f32 v149, v149
  v_mul_f32 v148, v148, v28
  v_mfma_f32_32x32x16_bf16 v[64:79], v[108:111], a[72:75], v[64:79]
  ds_read_b128 v[92:95], v5 offset:55296
  buffer_load_dwordx4 v1, s[8:11], s32 offen offset:3072 sc1 lds
  s_add_u32 s32, s32, 16384
  v_fma_f32 v151, v151, v137, v137
  v_rcp_f32 v150, v150
  s_waitcnt lgkmcnt(2)
  v_mfma_f32_32x32x16_bf16 v[64:79], v[112:115], a[76:79], v[64:79]
  ds_read_b128 v[96:99], v5 offset:56320
  v_mul_f32 v149, v149, v29
  v_cvt_pk_bf16_f32 v122, v148, v149
  v_rcp_f32 v151, v151
  v_mfma_f32_32x32x16_bf16 v[64:79], v[116:119], a[80:83], v[64:79]
  ds_read_b128 v[100:103], v5 offset:57344
  v_mul_f32 v150, v150, v30
  v_mul_f32 v151, v151, v31
  s_waitcnt lgkmcnt(2)
  v_mfma_f32_32x32x16_bf16 v[64:79], v[88:91], a[84:87], v[64:79]
  ds_read_b128 v[104:107], v5 offset:58368
  s_cmp_lg_u32 s26, 0
  s_cbranch_scc1 lay_19
  s_add_u32 s67, s36, 0
  buffer_load_dwordx4 a[128:131], v10, s[8:11], s67 offen offset:0 sc1
  buffer_load_dwordx4 a[132:135], v11, s[8:11], s67 offen offset:0 sc1
lay_19:
  v_cvt_pk_bf16_f32 v123, v150, v151
  buffer_store_dwordx4 v[120:123], v1, s[8:11], s52 offen sc1
  s_add_u32 s52, s52, 8192
  v_mfma_f32_32x32x16_bf16 v[64:79], v[92:95], a[88:91], v[64:79]
  ds_read_b128 v[108:111], v5 offset:59392
  v_mul_f32 v144, v136, v32
  v_mul_f32 v145, v136, v33
  s_waitcnt lgkmcnt(2)
  v_mfma_f32_32x32x16_bf16 v[64:79], v[96:99], a[92:95], v[64:79]
  ds_read_b128 v[112:115], v5 offset:60416
  s_cmp_lg_u32 s26, 0
  s_cbranch_scc1 lay_20
  s_add_u32 s67, s36, 0
  buffer_load_dwordx4 a[136:139], v10, s[8:11], s67 offen offset:2048 sc1
  buffer_load_dwordx4 a[140:143], v11, s[8:11], s67 offen offset:2048 sc1
lay_20:
  v_exp_f32 v144, v144
  v_mul_f32 v146, v136, v34
  v_mfma_f32_32x32x16_bf16 v[64:79], v[100:103], a[96:99], v[64:79]
  ds_read_b128 v[116:119], v5 offset:61440
  v_exp_f32 v145, v145
  v_fma_f32 v144, v144, v137, v137
  s_waitcnt lgkmcnt(2)
  v_mfma_f32_32x32x16_bf16 v[64:79], v[104:107], a[100:103], v[64:79]
  ds_read_b128 v[88:91], v5 offset:62464
  v_mul_f32 v147, v136, v35
  v_exp_f32 v146, v146
  v_fma_f32 v145, v145, v137, v137
  v_mfma_f32_32x32x16_bf16 v[64:79], v[108:111], a[104:107], v[64:79]
  ds_read_b128 v[92:95], v5 offset:63488
  s_cmp_lg_u32 s26, 0
  s_cbranch_scc1 lay_21
  s_add_u32 s67, s36, 4096
  buffer_load_dwordx4 a[144:147], v10, s[8:11], s67 offen offset:0 sc1
  buffer_load_dwordx4 a[148:151], v11, s[8:11], s67 offen offset:0 sc1
lay_21:
  v_rcp_f32 v144, v144
  v_mul_f32 v148, v136, v36
  s_waitcnt lgkmcnt(2)
  v_mfma_f32_32x32x16_bf16 v[64:79], v[112:115], a[108:111], v[64:79]
  ds_read_b128 v[96:99], v5 offset:64512
  v_exp_f32 v147, v147
  v_fma_f32 v146, v146, v137, v137
  v_mfma_f32_32x32x16_bf16 v[64:79], v[116:119], a[112:115], v[64:79]
  ds_read_b128 v[100:103], v6 offset:22528
  s_cmp_lg_u32 s26, 0
  s_cbranch_scc1 lay_22
  s_add_u32 s67, s36, 4096
  buffer_load_dwordx4 a[152:155], v10, s[8:11], s67 offen offset:2048 sc1
  buffer_load_dwordx4 a[156:159], v11, s[8:11], s67 offen offset:2048 sc1
lay_22:
  v_rcp_f32 v145, v145
  v_mul_f32 v144, v144, v40
  s_waitcnt lgkmcnt(2)
  v_mfma_f32_32x32x16_bf16 v[64:79], v[88:91], a[116:119], v[64:79]
  s_waitcnt vmcnt(9)
  s_barrier
  ds_read_b128 v[104:107], v6 offset:0
  v_mul_f32 v149, v136, v37
  v_exp_f32 v148, v148
  v_mfma_f32_32x32x16_bf16 v[64:79], v[92:95], a[120:123], v[64:79]
  ds_read_b128 v[108:111], v6 offset:1024
  v_fma_f32 v147, v147, v137, v137
  v_rcp_f32 v146, v146
  s_waitcnt lgkmcnt(2)
  v_mfma_f32_32x32x16_bf16 v[64:79], v[96:99], a[124:127], v[64:79]
  ds_read_b128 v[112:115], v6 offset:2048
  v_mul_f32 v145, v145, v41
  v_cvt_pk_bf16_f32 v124, v144, v145
  v_mul_f32 v150, v136, v38
  v_mfma_f32_32x32x16_bf16 v[64:79], v[100:103], v[140:143], v[64:79]
  ds_read_b128 v[116:119], v6 offset:3072
  s_waitcnt lgkmcnt(2)
  v_mfma_f32_32x32x16_bf16 v[16:31], v[104:107], a[0:3], 0
  ds_read_b128 v[88:91], v6 offset:4096
  v_mfma_f32_32x32x16_bf16 v[16:31], v[108:111], a[4:7], v[16:31]
  ds_read_b128 v[92:95], v6 offset:5120
  s_add_u32 m0, s31, 49152
  s_nop 0
  buffer_load_dwordx4 v1, s[8:11], s32 offen offset:0 sc1 lds
  v_exp_f32 v149, v149
  v_fma_f32 v148, v148, v137, v137
  s_waitcnt lgkmcnt(2)
  v_mfma_f32_32x32x16_bf16 v[16:31], v[112:115], a[8:11], v[16:31]
  ds_read_b128 v[96:99], v6 offset:6144
  v_rcp_f32 v147, v147
  v_mul_f32 v146, v146, v42
  v_mfma_f32_32x32x16_bf16 v[16:31], v[116:119], a[12:15], v[16:31]
  ds_read_b128 v[100:103], v6 offset:7168
  buffer_load_dwordx4 v1, s[8:11], s32 offen offset:1024 sc1 lds
  v_mul_f32 v151, v136, v39
  v_exp_f32 v150, v150
  s_waitcnt lgkmcnt(2)
  v_mfma_f32_32x32x16_bf16 v[16:31], v[88:91], a[16:19], v[16:31]
  ds_read_b128 v[104:107], v6 offset:8192
  v_fma_f32 v149, v149, v137, v137
  v_rcp_f32 v148, v148
  v_mfma_f32_32x32x16_bf16 v[16:31], v[92:95], a[20:23], v[16:31]
  ds_read_b128 v[108:111], v6 offset:9216
  v_mul_f32 v147, v147, v43
  v_cvt_pk_bf16_f32 v125, v146, v147
  s_waitcnt lgkmcnt(2)
  v_mfma_f32_32x32x16_bf16 v[16:31], v[96:99], a[24:27], v[16:31]
  ds_read_b128 v[112:115], v6 offset:10240
  buffer_load_dwordx4 v1, s[8:11], s32 offen offset:2048 sc1 lds
  v_exp_f32 v151, v151
  v_fma_f32 v150, v150, v137, v137
  v_rcp_f32 v149, v149
  v_mfma_f32_32x32x16_bf16 v[16:31], v[100:103], a[28:31], v[16:31]
  ds_read_b128 v[116:119], v6 offset:11264
  v_mul_f32 v148, v148, v44
  v_fma_f32 v151, v151, v137, v137
  s_waitcnt lgkmcnt(2)
  v_mfma_f32_32x32x16_bf16 v[16:31], v[104:107], a[32:35], v[16:31]
  ds_read_b128 v[88:91], v6 offset:12288
  buffer_load_dwordx4 v1, s[8:11], s32 offen offset:3072 sc1 lds
  s_add_u32 s32, s32, 16384
  v_rcp_f32 v150, v150
  v_mul_f32 v149, v149, v45
  v_mfma_f32_32x32x16_bf16 v[16:31], v[108:111], a[36:39], v[16:31]
  ds_read_b128 v[92:95], v6 offset:13312
  v_cvt_pk_bf16_f32 v126, v148, v149
  v_rcp_f32 v151, v151
  s_waitcnt lgkmcnt(2)
  v_mfma_f32_32x32x16_bf16 v[16:31], v[112:115], a[40:43], v[16:31]
  ds_read_b128 v[96:99], v6 offset:14336
  v_mul_f32 v150, v150, v46
  v_mul_f32 v151, v151, v47
  v_mfma_f32_32x32x16_bf16 v[16:31], v[116:119], a[44:47], v[16:31]
  ds_read_b128 v[100:103], v6 offset:15360
  s_add_u32 m0, s31, 65536
  s_nop 0
  buffer_load_dwordx4 v1, s[8:11], s32 offen offset:0 sc1 lds
  v_cvt_pk_bf16_f32 v127, v150, v151
  buffer_store_dwordx4 v[124:127], v1, s[8:11], s52 offen sc1
  s_add_u32 s52, s52, 8192
  v_mul_f32 v144, v136, v48
  s_waitcnt lgkmcnt(2)
  v_mfma_f32_32x32x16_bf16 v[16:31], v[88:91], a[48:51], v[16:31]
  ds_read_b128 v[104:107], v1 offset:0
  v_mul_f32 v145, v136, v49
  v_exp_f32 v144, v144
  v_mfma_f32_32x32x16_bf16 v[16:31], v[92:95], a[52:55], v[16:31]
  ds_read_b128 v[108:111], v1 offset:1024
  buffer_load_dwordx4 v1, s[8:11], s32 offen offset:1024 sc1 lds
  v_mul_f32 v146, v136, v50
  v_exp_f32 v145, v145
  s_waitcnt lgkmcnt(2)
  v_mfma_f32_32x32x16_bf16 v[16:31], v[96:99], a[56:59], v[16:31]
  ds_read_b128 v[112:115], v1 offset:2048
  v_fma_f32 v144, v144, v137, v137
  v_mul_f32 v147, v136, v51
  v_mfma_f32_32x32x16_bf16 v[16:31], v[100:103], a[60:63], v[16:31]
  ds_read_b128 v[116:119], v1 offset:3072
  v_exp_f32 v146, v146
  v_fma_f32 v145, v145, v137, v137
  s_waitcnt lgkmcnt(2)
  v_mfma_f32_32x32x16_bf16 v[16:31], v[104:107], a[64:67], v[16:31]
  ds_read_b128 v[88:91], v1 offset:4096
  buffer_load_dwordx4 v1, s[8:11], s32 offen offset:2048 sc1 lds
  v_rcp_f32 v144, v144
  v_mul_f32 v148, v136, v52
  v_exp_f32 v147, v147
  v_mfma_f32_32x32x16_bf16 v[16:31], v[108:111], a[68:71], v[16:31]
  ds_read_b128 v[92:95], v1 offset:5120
  v_fma_f32 v146, v146, v137, v137
  v_rcp_f32 v145, v145
  s_waitcnt lgkmcnt(2)
  v_mfma_f32_32x32x16_bf16 v[16:31], v[112:115], a[72:75], v[16:31]
  ds_read_b128 v[96:99], v1 offset:6144
  buffer_load_dwordx4 v1, s[8:11], s32 offen offset:3072 sc1 lds
  s_add_u32 s32, s32, 16384
  v_mul_f32 v144, v144, v56
  v_mul_f32 v149, v136, v53
  v_mfma_f32_32x32x16_bf16 v[16:31], v[116:119], a[76:79], v[16:31]
  ds_read_b128 v[100:103], v1 offset:7168
  v_exp_f32 v148, v148
  v_fma_f32 v147, v147, v137, v137
  s_waitcnt lgkmcnt(2)
  v_mfma_f32_32x32x16_bf16 v[16:31], v[88:91], a[80:83], v[16:31]
  ds_read_b128 v[104:107], v1 offset:8192
  v_rcp_f32 v146, v146
  v_mul_f32 v145, v145, v57
  v_mfma_f32_32x32x16_bf16 v[16:31], v[92:95], a[84:87], v[16:31]
  ds_read_b128 v[108:111], v1 offset:9216
  s_cmp_lg_u32 s26, 0
  s_cbranch_scc1 lay_23
  s_add_u32 s67, s36, 8192
  buffer_load_dwordx4 a[160:163], v10, s[8:11], s67 offen offset:0 sc1
  buffer_load_dwordx4 a[164:167], v11, s[8:11], s67 offen offset:0 sc1
lay_23:
  v_cvt_pk_bf16_f32 v120, v144, v145
  v_mul_f32 v150, v136, v54
  v_exp_f32 v149, v149
  s_waitcnt lgkmcnt(2)
  v_mfma_f32_32x32x16_bf16 v[16:31], v[96:99], a[88:91], v[16:31]
  ds_read_b128 v[112:115], v1 offset:10240
  v_fma_f32 v148, v148, v137, v137
  v_rcp_f32 v147, v147
  v_mfma_f32_32x32x16_bf16 v[16:31], v[100:103], a[92:95], v[16:31]
  ds_read_b128 v[116:119], v1 offset:11264
  s_cmp_lg_u32 s26, 0
  s_cbranch_scc1 lay_24
  s_add_u32 s67, s36, 8192
  buffer_load_dwordx4 a[168:171], v10, s[8:11], s67 offen offset:2048 sc1
  buffer_load_dwordx4 a[172:175], v11, s[8:11], s67 offen offset:2048 sc1
lay_24:
  v_mul_f32 v146, v146, v58
  v_mul_f32 v151, v136, v55
  s_waitcnt lgkmcnt(2)
  v_mfma_f32_32x32x16_bf16 v[16:31], v[104:107], a[96:99], v[16:31]
  ds_read_b128 v[88:91], v1 offset:12288
  v_exp_f32 v150, v150
  v_fma_f32 v149, v149, v137, v137
  v_mfma_f32_32x32x16_bf16 v[16:31], v[108:111], a[100:103], v[16:31]
  ds_read_b128 v[92:95], v1 offset:13312
  v_rcp_f32 v148, v148
  v_mul_f32 v147, v147, v59
  s_waitcnt lgkmcnt(2)
  v_mfma_f32_32x32x16_bf16 v[16:31], v[112:115], a[104:107], v[16:31]
  ds_read_b128 v[96:99], v1 offset:14336
  s_cmp_lg_u32 s26, 0
  s_cbranch_scc1 lay_25
  s_add_u32 s67, s36, 12288
  buffer_load_dwordx4 a[176:179], v10, s[8:11], s67 offen offset:0 sc1
  buffer_load_dwordx4 a[180:183], v11, s[8:11], s67 offen offset:0 sc1
lay_25:
  v_cvt_pk_bf16_f32 v121, v146, v147
  v_exp_f32 v151, v151
  v_fma_f32 v150, v150, v137, v137
  v_mfma_f32_32x32x16_bf16 v[16:31], v[116:119], a[108:111], v[16:31]
  ds_read_b128 v[100:103], v1 offset:15360
  v_rcp_f32 v149, v149
  v_mul_f32 v148, v148, v60
  s_waitcnt lgkmcnt(2)
  v_mfma_f32_32x32x16_bf16 v[16:31], v[88:91], a[112:115], v[16:31]
  ds_read_b128 v[104:107], v6 offset:23552
  s_cmp_lg_u32 s26, 0
  s_cbranch_scc1 lay_26
  s_add_u32 s67, s36, 12288
  buffer_load_dwordx4 a[184:187], v10, s[8:11], s67 offen offset:2048 sc1
  buffer_load_dwordx4 a[188:191], v11, s[8:11], s67 offen offset:2048 sc1
lay_26:
  v_fma_f32 v151, v151, v137, v137
  v_rcp_f32 v150, v150
  v_mfma_f32_32x32x16_bf16 v[16:31], v[92:95], a[116:119], v[16:31]
  s_waitcnt vmcnt(10)
  s_barrier
  ds_read_b128 v[108:111], v1 offset:16384
  v_mul_f32 v149, v149, v61
  v_cvt_pk_bf16_f32 v122, v148, v149
  s_waitcnt lgkmcnt(2)
  v_mfma_f32_32x32x16_bf16 v[16:31], v[96:99], a[120:123], v[16:31]
  ds_read_b128 v[112:115], v1 offset:17408
  v_rcp_f32 v151, v151
  v_mul_f32 v150, v150, v62
  v_mfma_f32_32x32x16_bf16 v[16:31], v[100:103], a[124:127], v[16:31]
  ds_read_b128 v[116:119], v1 offset:18432
  v_mul_f32 v151, v151, v63
  v_cvt_pk_bf16_f32 v123, v150, v151
  buffer_store_dwordx4 v[120:123], v1, s[8:11], s52 offen sc1
  s_add_u32 s52, s52, 8192
  s_waitcnt lgkmcnt(2)
  v_mfma_f32_32x32x16_bf16 v[16:31], v[104:107], v[140:143], v[16:31]
  ds_read_b128 v[88:91], v1 offset:19456
  v_mfma_f32_32x32x16_bf16 v[32:47], v[108:111], a[0:3], 0
  ds_read_b128 v[92:95], v1 offset:20480
  s_waitcnt lgkmcnt(2)
  v_mfma_f32_32x32x16_bf16 v[32:47], v[112:115], a[4:7], v[32:47]
  ds_read_b128 v[96:99], v1 offset:21504
  s_cmp_lg_u32 s26, 0
  s_cbranch_scc1 lay_27
  s_add_u32 s67, s36, 16384
  buffer_load_dwordx4 a[192:195], v10, s[8:11], s67 offen offset:0 sc1
  buffer_load_dwordx4 a[196:199], v11, s[8:11], s67 offen offset:0 sc1
lay_27:
  v_mul_f32 v144, v136, v64
  v_mul_f32 v145, v136, v65
  v_mfma_f32_32x32x16_bf16 v[32:47], v[116:119], a[8:11], v[32:47]
  ds_read_b128 v[100:103], v1 offset:22528
  v_exp_f32 v144, v144
  v_mul_f32 v146, v136, v66
  s_waitcnt lgkmcnt(2)
  v_mfma_f32_32x32x16_bf16 v[32:47], v[88:91], a[12:15], v[32:47]
  ds_read_b128 v[104:107], v1 offset:23552
  v_exp_f32 v145, v145
  v_fma_f32 v144, v144, v137, v137
  v_mfma_f32_32x32x16_bf16 v[32:47], v[92:95], a[16:19], v[32:47]
  ds_read_b128 v[108:111], v1 offset:24576
  s_cmp_lg_u32 s26, 0
  s_cbranch_scc1 lay_28
  s_add_u32 s67, s36, 16384
  buffer_load_dwordx4 a[200:203], v10, s[8:11], s67 offen offset:2048 sc1
  buffer_load_dwordx4 a[204:207], v11, s[8:11], s67 offen offset:2048 sc1
lay_28:
  v_mul_f32 v147, v136, v67
  v_exp_f32 v146, v146
  s_waitcnt lgkmcnt(2)
  v_mfma_f32_32x32x16_bf16 v[32:47], v[96:99], a[20:23], v[32:47]
  ds_read_b128 v[112:115], v1 offset:25600
  v_fma_f32 v145, v145, v137, v137
  v_rcp_f32 v144, v144
  v_mfma_f32_32x32x16_bf16 v[32:47], v[100:103], a[24:27], v[32:47]
  ds_read_b128 v[116:119], v1 offset:26624
  v_mul_f32 v148, v136, v68
  v_exp_f32 v147, v147
  s_waitcnt lgkmcnt(2)
  v_mfma_f32_32x32x16_bf16 v[32:47], v[104:107], a[28:31], v[32:47]
  ds_read_b128 v[88:91], v1 offset:27648
  v_fma_f32 v146, v146, v137, v137
  v_rcp_f32 v145, v145
  v_mfma_f32_32x32x16_bf16 v[32:47], v[108:111], a[32:35], v[32:47]
  ds_read_b128 v[92:95], v1 offset:28672
  s_cmp_lg_u32 s26, 0
  s_cbranch_scc1 lay_29
  s_add_u32 s67, s36, 20480
  buffer_load_dwordx4 a[208:211], v10, s[8:11], s67 offen offset:0 sc1
  buffer_load_dwordx4 a[212:215], v11, s[8:11], s67 offen offset:0 sc1
lay_29:
  v_mul_f32 v144, v144, v72
  v_mul_f32 v149, v136, v69
  s_waitcnt lgkmcnt(2)
  v_mfma_f32_32x32x16_bf16 v[32:47], v[112:115], a[36:39], v[32:47]
  ds_read_b128 v[96:99], v1 offset:29696
  v_exp_f32 v148, v148
  v_fma_f32 v147, v147, v137, v137
  v_mfma_f32_32x32x16_bf16 v[32:47], v[116:119], a[40:43], v[32:47]
  ds_read_b128 v[100:103], v1 offset:30720
  v_rcp_f32 v146, v146
  v_mul_f32 v145, v145, v73
  s_waitcnt lgkmcnt(2)
  v_mfma_f32_32x32x16_bf16 v[32:47], v[88:91], a[44:47], v[32:47]
  ds_read_b128 v[104:107], v1 offset:31744
  v_cvt_pk_bf16_f32 v124, v144, v145
  v_mul_f32 v150, v136, v70
  v_mfma_f32_32x32x16_bf16 v[32:47], v[92:95], a[48:51], v[32:47]
  ds_read_b128 v[108:111], v1 offset:32768
  s_cmp_lg_u32 s26, 0
  s_cbranch_scc1 lay_30
  s_add_u32 s67, s36, 20480
  buffer_load_dwordx4 a[216:219], v10, s[8:11], s67 offen offset:2048 sc1
  buffer_load_dwordx4 a[220:223], v11, s[8:11], s67 offen offset:2048 sc1
lay_30:
  v_exp_f32 v149, v149
  v_fma_f32 v148, v148, v137, v137
  s_waitcnt lgkmcnt(2)
  v_mfma_f32_32x32x16_bf16 v[32:47], v[96:99], a[52:55], v[32:47]
  ds_read_b128 v[112:115], v1 offset:33792
  s_cmp_lg_u32 s26, 1
  s_cbranch_scc1 lay_31
  s_waitcnt vmcnt(0)
  v_mov_b32 v14, s53
  s_mov_b64 exec, 1
  buffer_store_dword v14, v13, s[8:11], s47 offen
  s_mov_b64 exec, -1
lay_31:
  v_rcp_f32 v147, v147
  v_mul_f32 v146, v146, v74
  v_mfma_f32_32x32x16_bf16 v[32:47], v[100:103], a[56:59], v[32:47]
  ds_read_b128 v[116:119], v1 offset:34816
  v_mul_f32 v151, v136, v71
  v_exp_f32 v150, v150
  s_waitcnt lgkmcnt(2)
  v_mfma_f32_32x32x16_bf16 v[32:47], v[104:107], a[60:63], v[32:47]
  ds_read_b128 v[88:91], v1 offset:35840
  v_fma_f32 v149, v149, v137, v137
  v_rcp_f32 v148, v148
  v_mfma_f32_32x32x16_bf16 v[32:47], v[108:111], a[64:67], v[32:47]
  ds_read_b128 v[92:95], v1 offset:36864
  s_cmp_lg_u32 s26, 0
  s_cbranch_scc1 lay_32
  s_add_u32 s67, s36, 24576
  buffer_load_dwordx4 a[224:227], v10, s[8:11], s67 offen offset:0 sc1
  buffer_load_dwordx4 a[228:231], v11, s[8:11], s67 offen offset:0 sc1
lay_32:
  v_mul_f32 v147, v147, v75
  v_cvt_pk_bf16_f32 v125, v146, v147
  s_waitcnt lgkmcnt(2)
  v_mfma_f32_32x32x16_bf16 v[32:47], v[112:115], a[68:71], v[32:47]
  ds_read_b128 v[96:99], v1 offset:37888
  v_exp_f32 v151, v151
  v_fma_f32 v150, v150, v137, v137
  v_mfma_f32_32x32x16_bf16 v[32:47], v[116:119], a[72:75], v[32:47]
  ds_read_b128 v[100:103], v1 offset:38912
  v_rcp_f32 v149, v149
  v_mul_f32 v148, v148, v76
  s_waitcnt lgkmcnt(2)
  v_mfma_f32_32x32x16_bf16 v[32:47], v[88:91], a[76:79], v[32:47]
  ds_read_b128 v[104:107], v1 offset:39936
  s_cmp_lg_u32 s26, 0
  s_cbranch_scc1 lay_33
  s_add_u32 s67, s36, 24576
  buffer_load_dwordx4 a[232:235], v10, s[8:11], s67 offen offset:2048 sc1
  buffer_load_dwordx4 a[236:239], v11, s[8:11], s67 offen offset:2048 sc1
lay_33:
  s_cmp_lg_u32 s26, 0
  s_cbranch_scc1 lay_34
  s_waitcnt vmcnt(12)
  v_mov_b32 v14, s53
  s_mov_b64 exec, 1
  buffer_store_dword v14, v13, s[8:11], s47 offen
  s_mov_b64 exec, -1
lay_34:
  v_fma_f32 v151, v151, v137, v137
  v_rcp_f32 v150, v150
  v_mfma_f32_32x32x16_bf16 v[32:47], v[92:95], a[80:83], v[32:47]
  ds_read_b128 v[108:111], v1 offset:40960
  v_mul_f32 v149, v149, v77
  v_cvt_pk_bf16_f32 v126, v148, v149
  s_waitcnt lgkmcnt(2)
  v_mfma_f32_32x32x16_bf16 v[32:47], v[96:99], a[84:87], v[32:47]
  ds_read_b128 v[112:115], v1 offset:41984
  v_rcp_f32 v151, v151
  v_mul_f32 v150, v150, v78
  v_mfma_f32_32x32x16_bf16 v[32:47], v[100:103], a[88:91], v[32:47]
  ds_read_b128 v[116:119], v1 offset:43008
  v_mul_f32 v151, v151, v79
  v_cvt_pk_bf16_f32 v127, v150, v151
  s_waitcnt lgkmcnt(2)
  v_mfma_f32_32x32x16_bf16 v[32:47], v[104:107], a[92:95], v[32:47]
  ds_read_b128 v[88:91], v1 offset:44032
  s_cmp_lg_u32 s26, 0
  s_cbranch_scc1 lay_35
  s_add_u32 s67, s36, 28672
  buffer_load_dwordx4 a[240:243], v10, s[8:11], s67 offen offset:0 sc1
  buffer_load_dwordx4 a[244:247], v11, s[8:11], s67 offen offset:0 sc1
lay_35:
  buffer_store_dwordx4 v[124:127], v1, s[8:11], s52 offen sc1
  s_add_u32 s52, s52, 8192
  v_mul_f32 v144, v136, v16
  v_mfma_f32_32x32x16_bf16 v[32:47], v[108:111], a[96:99], v[32:47]
  ds_read_b128 v[92:95], v1 offset:45056
  v_mul_f32 v145, v136, v17
  v_exp_f32 v144, v144
  s_waitcnt lgkmcnt(2)
  v_mfma_f32_32x32x16_bf16 v[32:47], v[112:115], a[100:103], v[32:47]
  ds_read_b128 v[96:99], v1 offset:46080
  v_mul_f32 v146, v136, v18
  v_exp_f32 v145, v145
  v_mfma_f32_32x32x16_bf16 v[32:47], v[116:119], a[104:107], v[32:47]
  ds_read_b128 v[100:103], v1 offset:47104
  v_fma_f32 v144, v144, v137, v137
  v_mul_f32 v147, v136, v19
  s_waitcnt lgkmcnt(2)
  v_mfma_f32_32x32x16_bf16 v[32:47], v[88:91], a[108:111], v[32:47]
  ds_read_b128 v[104:107], v1 offset:48128
  s_cmp_lg_u32 s26, 0
  s_cbranch_scc1 lay_36
  s_add_u32 s67, s36, 28672
  buffer_load_dwordx4 a[248:251], v10, s[8:11], s67 offen offset:2048 sc1
  buffer_load_dwordx4 a[252:255], v11, s[8:11], s67 offen offset:2048 sc1
lay_36:
  v_exp_f32 v146, v146
  v_fma_f32 v145, v145, v137, v137
  v_mfma_f32_32x32x16_bf16 v[32:47], v[92:95], a[112:115], v[32:47]
  ds_read_b128 v[108:111], v6 offset:24576
  v_rcp_f32 v144, v144
  v_mul_f32 v148, v136, v20
  s_waitcnt lgkmcnt(2)
  v_mfma_f32_32x32x16_bf16 v[32:47], v[96:99], a[116:119], v[32:47]
  s_barrier
  ds_read_b128 v[112:115], v1 offset:49152
  v_exp_f32 v147, v147
  v_fma_f32 v146, v146, v137, v137
  v_mfma_f32_32x32x16_bf16 v[32:47], v[100:103], a[120:123], v[32:47]
  ds_read_b128 v[116:119], v1 offset:50176
  v_rcp_f32 v145, v145
  v_mul_f32 v144, v144, v24
  s_waitcnt lgkmcnt(2)
  v_mfma_f32_32x32x16_bf16 v[32:47], v[104:107], a[124:127], v[32:47]
  ds_read_b128 v[88:91], v1 offset:51200
  buffer_load_dword v158, v139, s[8:11], s51 offen sc1
  v_mul_f32 v149, v136, v21
  v_exp_f32 v148, v148
  v_mfma_f32_32x32x16_bf16 v[32:47], v[108:111], v[140:143], v[32:47]
  ds_read_b128 v[92:95], v1 offset:52224
  v_fma_f32 v147, v147, v137, v137
  v_rcp_f32 v146, v146
  s_waitcnt lgkmcnt(2)
  v_mfma_f32_32x32x16_bf16 v[48:63], v[112:115], a[0:3], 0
  ds_read_b128 v[96:99], v1 offset:53248
  v_mul_f32 v145, v145, v25
  v_cvt_pk_bf16_f32 v120, v144, v145
  v_mul_f32 v150, v136, v22
  v_mfma_f32_32x32x16_bf16 v[48:63], v[116:119], a[4:7], v[48:63]
  ds_read_b128 v[100:103], v1 offset:54272
  v_exp_f32 v149, v149
  v_fma_f32 v148, v148, v137, v137
  s_waitcnt lgkmcnt(2)
  v_mfma_f32_32x32x16_bf16 v[48:63], v[88:91], a[8:11], v[48:63]
  ds_read_b128 v[104:107], v1 offset:55296
  v_rcp_f32 v147, v147
  v_mul_f32 v146, v146, v26
  v_mfma_f32_32x32x16_bf16 v[48:63], v[92:95], a[12:15], v[48:63]
  ds_read_b128 v[108:111], v1 offset:56320
  v_mul_f32 v151, v136, v23
  v_exp_f32 v150, v150
  s_waitcnt lgkmcnt(2)
  v_mfma_f32_32x32x16_bf16 v[48:63], v[96:99], a[16:19], v[48:63]
  ds_read_b128 v[112:115], v1 offset:57344
  v_fma_f32 v149, v149, v137, v137
  v_rcp_f32 v148, v148
  v_mfma_f32_32x32x16_bf16 v[48:63], v[100:103], a[20:23], v[48:63]
  ds_read_b128 v[116:119], v1 offset:58368
  v_mul_f32 v147, v147, v27
  v_cvt_pk_bf16_f32 v121, v146, v147
  s_waitcnt lgkmcnt(2)
  v_mfma_f32_32x32x16_bf16 v[48:63], v[104:107], a[24:27], v[48:63]
  ds_read_b128 v[88:91], v1 offset:59392
  v_exp_f32 v151, v151
  v_fma_f32 v150, v150, v137, v137
  v_mfma_f32_32x32x16_bf16 v[48:63], v[108:111], a[28:31], v[48:63]
  ds_read_b128 v[92:95], v1 offset:60416
  v_rcp_f32 v149, v149
  v_mul_f32 v148, v148, v28
  s_waitcnt lgkmcnt(2)
  v_mfma_f32_32x32x16_bf16 v[48:63], v[112:115], a[32:35], v[48:63]
  ds_read_b128 v[96:99], v1 offset:61440
  v_fma_f32 v151, v151, v137, v137
  v_rcp_f32 v150, v150
  v_mul_f32 v149, v149, v29
  v_mfma_f32_32x32x16_bf16 v[48:63], v[116:119], a[36:39], v[48:63]
  ds_read_b128 v[100:103], v1 offset:62464
  v_cvt_pk_bf16_f32 v122, v148, v149
  v_rcp_f32 v151, v151
  s_waitcnt lgkmcnt(2)
  v_mfma_f32_32x32x16_bf16 v[48:63], v[88:91], a[40:43], v[48:63]
  ds_read_b128 v[104:107], v1 offset:63488
  v_mul_f32 v150, v150, v30
  v_mul_f32 v151, v151, v31
  v_mfma_f32_32x32x16_bf16 v[48:63], v[92:95], a[44:47], v[48:63]
  ds_read_b128 v[108:111], v1 offset:64512
  v_cvt_pk_bf16_f32 v123, v150, v151
  buffer_store_dwordx4 v[120:123], v1, s[8:11], s52 offen sc1
  s_add_u32 s52, s52, 8192
  s_waitcnt lgkmcnt(2)
  v_mfma_f32_32x32x16_bf16 v[48:63], v[96:99], a[48:51], v[48:63]
  ds_read_b128 v[112:115], v5 offset:0
  s_waitcnt vmcnt(1)
  v_cmp_gt_u32 vcc, s53, v158
  s_nop 0
  s_cbranch_vccz poll_37_x
  s_mov_b32 s58, 0
poll_37:
  buffer_load_dword v158, v139, s[8:11], s51 offen sc1
  s_waitcnt vmcnt(0)
  v_cmp_gt_u32 vcc, s53, v158
  s_add_u32 s58, s58, 1
  s_cmp_gt_u32 s58, 0x200000
  s_cbranch_scc1 poll_37_x
  s_cbranch_vccnz poll_37
poll_37_x:
  v_mul_f32 v144, v136, v32
  v_mul_f32 v145, v136, v33
  v_mfma_f32_32x32x16_bf16 v[48:63], v[100:103], a[52:55], v[48:63]
  ds_read_b128 v[116:119], v5 offset:1024
  buffer_load_dwordx4 a[0:3], v8, s[8:11], s37 offen offset:0 sc1
  buffer_load_dwordx4 a[4:7], v9, s[8:11], s37 offen offset:0 sc1
  v_exp_f32 v144, v144
  v_mul_f32 v146, v136, v34
  s_waitcnt lgkmcnt(2)
  v_mfma_f32_32x32x16_bf16 v[48:63], v[104:107], a[56:59], v[48:63]
  ds_read_b128 v[88:91], v5 offset:2048
  v_exp_f32 v145, v145
  v_fma_f32 v144, v144, v137, v137
  v_mfma_f32_32x32x16_bf16 v[48:63], v[108:111], a[60:63], v[48:63]
  ds_read_b128 v[92:95], v5 offset:3072
  v_mul_f32 v147, v136, v35
  v_exp_f32 v146, v146
  s_waitcnt lgkmcnt(2)
  v_mfma_f32_32x32x16_bf16 v[48:63], v[112:115], a[64:67], v[48:63]
  ds_read_b128 v[96:99], v5 offset:4096
  buffer_load_dwordx4 a[8:11], v8, s[8:11], s37 offen offset:2048 sc1
  buffer_load_dwordx4 a[12:15], v9, s[8:11], s37 offen offset:2048 sc1
  s_add_u32 s37, s37, 4096
  v_fma_f32 v145, v145, v137, v137
  v_rcp_f32 v144, v144
  v_mul_f32 v148, v136, v36
  v_mfma_f32_32x32x16_bf16 v[48:63], v[116:119], a[68:71], v[48:63]
  ds_read_b128 v[100:103], v5 offset:5120
  v_exp_f32 v147, v147
  v_fma_f32 v146, v146, v137, v137
  s_waitcnt lgkmcnt(2)
  v_mfma_f32_32x32x16_bf16 v[48:63], v[88:91], a[72:75], v[48:63]
  ds_read_b128 v[104:107], v5 offset:6144
  v_rcp_f32 v145, v145
  v_mul_f32 v144, v144, v40
  v_mfma_f32_32x32x16_bf16 v[48:63], v[92:95], a[76:79], v[48:63]
  ds_read_b128 v[108:111], v5 offset:7168
  buffer_load_dwordx4 a[16:19], v8, s[8:11], s37 offen offset:0 sc1
  buffer_load_dwordx4 a[20:23], v9, s[8:11], s37 offen offset:0 sc1
  v_mul_f32 v149, v136, v37
  v_exp_f32 v148, v148
  s_waitcnt lgkmcnt(2)
  v_mfma_f32_32x32x16_bf16 v[48:63], v[96:99], a[80:83], v[48:63]
  ds_read_b128 v[112:115], v5 offset:8192
  v_fma_f32 v147, v147, v137, v137
  v_rcp_f32 v146, v146
  v_mfma_f32_32x32x16_bf16 v[48:63], v[100:103], a[84:87], v[48:63]
  ds_read_b128 v[116:119], v5 offset:9216
  v_mul_f32 v145, v145, v41
  v_cvt_pk_bf16_f32 v124, v144, v145
  s_waitcnt lgkmcnt(2)
  v_mfma_f32_32x32x16_bf16 v[48:63], v[104:107], a[88:91], v[48:63]
  ds_read_b128 v[88:91], v5 offset:10240
  buffer_load_dwordx4 a[24:27], v8, s[8:11], s37 offen offset:2048 sc1
  buffer_load_dwordx4 a[28:31], v9, s[8:11], s37 offen offset:2048 sc1
  s_add_u32 s37, s37, 4096
  v_mul_f32 v150, v136, v38
  v_exp_f32 v149, v149
  v_mfma_f32_32x32x16_bf16 v[48:63], v[108:111], a[92:95], v[48:63]
  ds_read_b128 v[92:95], v5 offset:11264
  v_fma_f32 v148, v148, v137, v137
  v_rcp_f32 v147, v147
  s_waitcnt lgkmcnt(2)
  v_mfma_f32_32x32x16_bf16 v[48:63], v[112:115], a[96:99], v[48:63]
  ds_read_b128 v[96:99], v5 offset:12288
  v_mul_f32 v146, v146, v42
  v_mul_f32 v151, v136, v39
  v_exp_f32 v150, v150
  v_mfma_f32_32x32x16_bf16 v[48:63], v[116:119], a[100:103], v[48:63]
  ds_read_b128 v[100:103], v5 offset:13312
  buffer_load_dwordx4 a[32:35], v8, s[8:11], s37 offen offset:0 sc1
  buffer_load_dwordx4 a[36:39], v9, s[8:11], s37 offen offset:0 sc1
  v_fma_f32 v149, v149, v137, v137
  v_rcp_f32 v148, v148
  s_waitcnt lgkmcnt(2)
  v_mfma_f32_32x32x16_bf16 v[48:63], v[88:91], a[104:107], v[48:63]
  ds_read_b128 v[104:107], v5 offset:14336
  v_mul_f32 v147, v147, v43
  v_cvt_pk_bf16_f32 v125, v146, v147
  v_mfma_f32_32x32x16_bf16 v[48:63], v[92:95], a[108:111], v[48:63]
  ds_read_b128 v[108:111], v5 offset:15360
  v_exp_f32 v151, v151
  v_fma_f32 v150, v150, v137, v137
  s_waitcnt lgkmcnt(3)
  v_mfma_f32_32x32x16_bf16 v[48:63], v[96:99], a[112:115], v[48:63]
  ds_read_b128 v[112:115], v6 offset:25600
  buffer_load_dwordx4 a[40:43], v8, s[8:11], s37 offen offset:2048 sc1
  buffer_load_dwordx4 a[44:47], v9, s[8:11], s37 offen offset:2048 sc1
  s_add_u32 s37, s37, 4096
  v_rcp_f32 v149, v149
  v_mul_f32 v148, v148, v44
  s_waitcnt lgkmcnt(3)
  v_mfma_f32_32x32x16_bf16 v[48:63], v[100:103], a[116:119], v[48:63]
  v_fma_f32 v151, v151, v137, v137
  v_rcp_f32 v150, v150
  s_waitcnt lgkmcnt(2)
  v_mfma_f32_32x32x16_bf16 v[48:63], v[104:107], a[120:123], v[48:63]
  v_mul_f32 v149, v149, v45
  v_cvt_pk_bf16_f32 v126, v148, v149
  s_waitcnt lgkmcnt(1)
  v_mfma_f32_32x32x16_bf16 v[48:63], v[108:111], a[124:127], v[48:63]
  s_waitcnt vmcnt(12)
  v_mov_b32 v14, s54
  s_mov_b64 exec, 1
  buffer_store_dword v14, v13, s[8:11], s47 offen
  s_mov_b64 exec, -1
  v_rcp_f32 v151, v151
  v_mul_f32 v150, v150, v46
  s_waitcnt lgkmcnt(0)
  v_mfma_f32_32x32x16_bf16 v[48:63], v[112:115], v[140:143], v[48:63]
  v_mul_f32 v151, v151, v47
  v_cvt_pk_bf16_f32 v127, v150, v151
  buffer_store_dwordx4 v[124:127], v1, s[8:11], s52 offen sc1
  s_add_u32 s52, s52, 8192
  s_cmp_lg_u32 s26, 0
  s_cbranch_scc1 L_fast_k4b
  s_waitcnt vmcnt(12)
  v_mfma_f32_32x32x16_bf16 v[64:79], a[132:135], a[4:7], 0
  buffer_load_dwordx4 a[48:51], v8, s[8:11], s37 offen offset:0 sc1
  buffer_load_dwordx4 a[52:55], v9, s[8:11], s37 offen offset:0 sc1
  s_nop 1
  v_mul_f32 v144, v136, v48
  v_mul_f32 v145, v136, v49
  v_exp_f32 v144, v144
  v_mfma_f32_32x32x16_bf16 v[88:103], a[128:131], a[4:7], 0
  v_mul_f32 v146, v136, v50
  v_exp_f32 v145, v145
  v_fma_f32 v144, v144, v137, v137
  v_mul_f32 v147, v136, v51
  v_mfma_f32_32x32x16_bf16 v[32:47], a[132:135], a[0:3], 0
  v_exp_f32 v146, v146
  v_fma_f32 v145, v145, v137, v137
  v_rcp_f32 v144, v144
  v_mul_f32 v148, v136, v52
  v_mfma_f32_32x32x16_bf16 v[16:31], a[128:131], a[0:3], 0
  v_exp_f32 v147, v147
  v_fma_f32 v146, v146, v137, v137
  v_rcp_f32 v145, v145
  v_mul_f32 v144, v144, v56
  s_waitcnt vmcnt(12)
  v_mfma_f32_32x32x16_bf16 v[64:79], a[140:143], a[12:15], v[64:79]
  buffer_load_dwordx4 a[56:59], v8, s[8:11], s37 offen offset:2048 sc1
  buffer_load_dwordx4 a[60:63], v9, s[8:11], s37 offen offset:2048 sc1
  s_add_u32 s37, s37, 4096
  v_mul_f32 v149, v136, v53
  v_exp_f32 v148, v148
  v_fma_f32 v147, v147, v137, v137
  v_mfma_f32_32x32x16_bf16 v[88:103], a[136:139], a[12:15], v[88:103]
  v_rcp_f32 v146, v146
  v_mul_f32 v145, v145, v57
  v_cvt_pk_bf16_f32 v120, v144, v145
  v_mul_f32 v150, v136, v54
  v_mfma_f32_32x32x16_bf16 v[32:47], a[140:143], a[8:11], v[32:47]
  v_exp_f32 v149, v149
  v_fma_f32 v148, v148, v137, v137
  v_rcp_f32 v147, v147
  v_mul_f32 v146, v146, v58
  v_mfma_f32_32x32x16_bf16 v[16:31], a[136:139], a[8:11], v[16:31]
  s_barrier
  s_mul_i32 s32, s22, 98304
  s_add_u32 s32, s32, s31
  s_add_u32 s32, s32, 0
  v_mul_f32 v151, v136, v55
  v_exp_f32 v150, v150
  v_fma_f32 v149, v149, v137, v137
  v_rcp_f32 v148, v148
  s_waitcnt vmcnt(12)
  v_mfma_f32_32x32x16_bf16 v[64:79], a[148:151], a[20:23], v[64:79]
  buffer_load_dwordx4 a[64:67], v8, s[8:11], s37 offen offset:0 sc1
  buffer_load_dwordx4 a[68:71], v9, s[8:11], s37 offen offset:0 sc1
  v_mul_f32 v147, v147, v59
  v_cvt_pk_bf16_f32 v121, v146, v147
  v_exp_f32 v151, v151
  v_mfma_f32_32x32x16_bf16 v[88:103], a[144:147], a[20:23], v[88:103]
  v_fma_f32 v150, v150, v137, v137
  v_rcp_f32 v149, v149
  v_mul_f32 v148, v148, v60
  v_fma_f32 v151, v151, v137, v137
  v_mfma_f32_32x32x16_bf16 v[32:47], a[148:151], a[16:19], v[32:47]
  v_rcp_f32 v150, v150
  v_mul_f32 v149, v149, v61
  v_cvt_pk_bf16_f32 v122, v148, v149
  v_rcp_f32 v151, v151
  v_mfma_f32_32x32x16_bf16 v[16:31], a[144:147], a[16:19], v[16:31]
  buffer_load_dword v158, v139, s[8:11], s51 offen sc1
  s_add_u32 m0, s31, 0
  s_nop 0
  buffer_load_dwordx4 v1, s[8:11], s32 offen offset:0 sc1 lds
  buffer_load_dwordx4 v1, s[8:11], s32 offen offset:1024 sc1 lds
  v_mul_f32 v150, v150, v62
  v_mul_f32 v151, v151, v63
  v_cvt_pk_bf16_f32 v123, v150, v151
  buffer_store_dwordx4 v[120:123], v1, s[8:11], s52 offen sc1
  s_add_u32 s52, s52, 8192
  s_waitcnt vmcnt(16)
  v_mfma_f32_32x32x16_bf16 v[64:79], a[156:159], a[28:31], v[64:79]
  buffer_load_dwordx4 a[72:75], v8, s[8:11], s37 offen offset:2048 sc1
  buffer_load_dwordx4 a[76:79], v9, s[8:11], s37 offen offset:2048 sc1
  s_add_u32 s37, s37, 4096
  v_mfma_f32_32x32x16_bf16 v[88:103], a[152:155], a[28:31], v[88:103]
  v_mfma_f32_32x32x16_bf16 v[32:47], a[156:159], a[24:27], v[32:47]
  v_mfma_f32_32x32x16_bf16 v[16:31], a[152:155], a[24:27], v[16:31]
  s_waitcnt vmcnt(16)
  v_mfma_f32_32x32x16_bf16 v[64:79], a[164:167], a[36:39], v[64:79]
  buffer_load_dwordx4 a[80:83], v8, s[8:11], s37 offen offset:0 sc1
  buffer_load_dwordx4 a[84:87], v9, s[8:11], s37 offen offset:0 sc1
  v_mfma_f32_32x32x16_bf16 v[88:103], a[160:163], a[36:39], v[88:103]
  v_mfma_f32_32x32x16_bf16 v[32:47], a[164:167], a[32:35], v[32:47]
  v_mfma_f32_32x32x16_bf16 v[16:31], a[160:163], a[32:35], v[16:31]
  s_waitcnt vmcnt(16)
  v_mfma_f32_32x32x16_bf16 v[64:79], a[172:175], a[44:47], v[64:79]
  buffer_load_dwordx4 a[88:91], v8, s[8:11], s37 offen offset:2048 sc1
  buffer_load_dwordx4 a[92:95], v9, s[8:11], s37 offen offset:2048 sc1
  s_add_u32 s37, s37, 4096
  v_mfma_f32_32x32x16_bf16 v[88:103], a[168:171], a[44:47], v[88:103]
  v_mfma_f32_32x32x16_bf16 v[32:47], a[172:175], a[40:43], v[32:47]
  s_add_u32 s67, s36, 32768
  buffer_load_dwordx4 v[160:163], v10, s[8:11], s67 offen offset:0 sc1
  buffer_load_dwordx4 v[164:167], v11, s[8:11], s67 offen offset:0 sc1
  v_mfma_f32_32x32x16_bf16 v[16:31], a[168:171], a[40:43], v[16:31]
  s_waitcnt vmcnt(8)
  v_mov_b32 v14, s55
  s_mov_b64 exec, 1
  buffer_store_dword v14, v13, s[8:11], s47 offen
  s_mov_b64 exec, -1
  s_add_u32 m0, s31, 0
  s_nop 0
  buffer_load_dwordx4 v1, s[8:11], s32 offen offset:2048 sc1 lds
  buffer_load_dwordx4 v1, s[8:11], s32 offen offset:3072 sc1 lds
  s_add_u32 s32, s32, 16384
  v_mfma_f32_32x32x16_bf16 v[64:79], a[180:183], a[52:55], v[64:79]
  v_cmp_gt_u32 vcc, s54, v158
  s_nop 0
  s_cbranch_vccz poll_38_x
  s_mov_b32 s58, 0
poll_38:
  buffer_load_dword v158, v139, s[8:11], s51 offen sc1
  s_waitcnt vmcnt(0)
  v_cmp_gt_u32 vcc, s54, v158
  s_add_u32 s58, s58, 1
  s_cmp_gt_u32 s58, 0x200000
  s_cbranch_scc1 poll_38_x
  s_cbranch_vccnz poll_38
poll_38_x:
  buffer_load_dwordx4 a[96:99], v8, s[8:11], s37 offen offset:0 sc1
  buffer_load_dwordx4 a[100:103], v9, s[8:11], s37 offen offset:0 sc1
  v_mfma_f32_32x32x16_bf16 v[88:103], a[176:179], a[52:55], v[88:103]
  v_mfma_f32_32x32x16_bf16 v[32:47], a[180:183], a[48:51], v[32:47]
  v_mfma_f32_32x32x16_bf16 v[16:31], a[176:179], a[48:51], v[16:31]
  v_mfma_f32_32x32x16_bf16 v[64:79], a[188:191], a[60:63], v[64:79]
  buffer_load_dwordx4 a[104:107], v8, s[8:11], s37 offen offset:2048 sc1
  buffer_load_dwordx4 a[108:111], v9, s[8:11], s37 offen offset:2048 sc1
  s_add_u32 s37, s37, 4096
  v_mfma_f32_32x32x16_bf16 v[88:103], a[184:187], a[60:63], v[88:103]
  v_mfma_f32_32x32x16_bf16 v[32:47], a[188:191], a[56:59], v[32:47]
  v_mfma_f32_32x32x16_bf16 v[16:31], a[184:187], a[56:59], v[16:31]
  v_mfma_f32_32x32x16_bf16 v[64:79], a[196:199], a[68:71], v[64:79]
  buffer_load_dwordx4 a[112:115], v8, s[8:11], s37 offen offset:0 sc1
  buffer_load_dwordx4 a[116:119], v9, s[8:11], s37 offen offset:0 sc1
  v_mfma_f32_32x32x16_bf16 v[88:103], a[192:195], a[68:71], v[88:103]
  v_mfma_f32_32x32x16_bf16 v[32:47], a[196:199], a[64:67], v[32:47]
  v_mfma_f32_32x32x16_bf16 v[16:31], a[192:195], a[64:67], v[16:31]
  s_waitcnt vmcnt(15)
  v_mfma_f32_32x32x16_bf16 v[64:79], a[204:207], a[76:79], v[64:79]
  buffer_load_dwordx4 a[120:123], v8, s[8:11], s37 offen offset:2048 sc1
  buffer_load_dwordx4 a[124:127], v9, s[8:11], s37 offen offset:2048 sc1
  s_add_u32 s37, s37, 4096
  v_mfma_f32_32x32x16_bf16 v[88:103], a[200:203], a[76:79], v[88:103]
  v_mfma_f32_32x32x16_bf16 v[32:47], a[204:207], a[72:75], v[32:47]
  v_mfma_f32_32x32x16_bf16 v[16:31], a[200:203], a[72:75], v[16:31]
  s_mul_i32 s48, s26, 4194304
  s_add_u32 s48, s48, s28
  s_add_u32 s48, s48, 11796480
  s_mul_i32 s49, s26, 524288
  s_add_u32 s49, s49, s29
  s_add_u32 s49, s49, 16515072
  s_mul_i32 s50, s26, 48
  s_add_u32 s50, s50, 64
  s_lshl_b32 s42, s23, 7
  s_add_u32 s42, s42, 37388288
  v_and_b32 v138, 15, v0
  v_lshlrev_b32 v138, 2, v138
  v_mov_b32 v108, -1
  v_mov_b32 v109, -1
  v_mov_b32 v110, -1
  v_mov_b32 v111, -1
  buffer_store_dwordx4 v[108:111], v1, s[8:11], s48 offen sc1
  buffer_store_dwordx4 v[108:111], v1, s[8:11], s48 offen offset:1024 sc1
  buffer_store_dwordx2 v[108:109], v12, s[8:11], s49 offen sc1
  buffer_load_dword v159, v139, s[8:11], s51 offen sc1
  s_waitcnt vmcnt(19)
  v_mfma_f32_32x32x16_bf16 v[64:79], a[212:215], a[84:87], v[64:79]
  buffer_load_dwordx4 a[0:3], v8, s[8:11], s37 offen offset:0 sc1
  buffer_load_dwordx4 a[4:7], v9, s[8:11], s37 offen offset:0 sc1
  v_mfma_f32_32x32x16_bf16 v[88:103], a[208:211], a[84:87], v[88:103]
  v_mfma_f32_32x32x16_bf16 v[32:47], a[212:215], a[80:83], v[32:47]
  v_mfma_f32_32x32x16_bf16 v[16:31], a[208:211], a[80:83], v[16:31]
  s_waitcnt vmcnt(19)
  v_mfma_f32_32x32x16_bf16 v[64:79], a[220:223], a[92:95], v[64:79]
  s_add_u32 s67, s36, 32768
  buffer_load_dwordx4 v[168:171], v10, s[8:11], s67 offen offset:2048 sc1
  buffer_load_dwordx4 v[172:175], v11, s[8:11], s67 offen offset:2048 sc1
  buffer_load_dwordx4 a[8:11], v8, s[8:11], s37 offen offset:2048 sc1
  buffer_load_dwordx4 a[12:15], v9, s[8:11], s37 offen offset:2048 sc1
  s_add_u32 s37, s37, 4096
  v_mfma_f32_32x32x16_bf16 v[88:103], a[216:219], a[92:95], v[88:103]
  v_mfma_f32_32x32x16_bf16 v[32:47], a[220:223], a[88:91], v[32:47]
  v_mfma_f32_32x32x16_bf16 v[16:31], a[216:219], a[88:91], v[16:31]
  s_waitcnt vmcnt(16)
  v_mfma_f32_32x32x16_bf16 v[64:79], a[228:231], a[100:103], v[64:79]
  s_add_u32 s67, s36, 36864
  buffer_load_dwordx4 v[176:179], v10, s[8:11], s67 offen offset:0 sc1
  buffer_load_dwordx4 v[180:183], v11, s[8:11], s67 offen offset:0 sc1
  buffer_load_dwordx4 a[16:19], v8, s[8:11], s37 offen offset:0 sc1
  buffer_load_dwordx4 a[20:23], v9, s[8:11], s37 offen offset:0 sc1
  v_mfma_f32_32x32x16_bf16 v[88:103], a[224:227], a[100:103], v[88:103]
  v_mfma_f32_32x32x16_bf16 v[32:47], a[228:231], a[96:99], v[32:47]
  v_mfma_f32_32x32x16_bf16 v[16:31], a[224:227], a[96:99], v[16:31]
  s_waitcnt vmcnt(18)
  v_mfma_f32_32x32x16_bf16 v[64:79], a[236:239], a[108:111], v[64:79]
  s_add_u32 s67, s36, 36864
  buffer_load_dwordx4 v[184:187], v10, s[8:11], s67 offen offset:2048 sc1
  buffer_load_dwordx4 v[188:191], v11, s[8:11], s67 offen offset:2048 sc1
  buffer_load_dwordx4 a[24:27], v8, s[8:11], s37 offen offset:2048 sc1
  buffer_load_dwordx4 a[28:31], v9, s[8:11], s37 offen offset:2048 sc1
  s_add_u32 s37, s37, 4096
  v_mfma_f32_32x32x16_bf16 v[88:103], a[232:235], a[108:111], v[88:103]
  v_mfma_f32_32x32x16_bf16 v[32:47], a[236:239], a[104:107], v[32:47]
  s_add_u32 s67, s36, 40960
  buffer_load_dwordx4 v[192:195], v10, s[8:11], s67 offen offset:0 sc1
  buffer_load_dwordx4 v[196:199], v11, s[8:11], s67 offen offset:0 sc1
  v_mfma_f32_32x32x16_bf16 v[16:31], a[232:235], a[104:107], v[16:31]
  s_waitcnt vmcnt(22)
  v_mfma_f32_32x32x16_bf16 v[64:79], a[244:247], a[116:119], v[64:79]
  s_waitcnt vmcnt(16)
  v_cmp_gt_u32 vcc, s55, v159
  s_nop 0
  s_cbranch_vccz poll_39_x
  s_mov_b32 s58, 0
poll_39:
  buffer_load_dword v159, v139, s[8:11], s51 offen sc1
  s_waitcnt vmcnt(0)
  v_cmp_gt_u32 vcc, s55, v159
  s_add_u32 s58, s58, 1
  s_cmp_gt_u32 s58, 0x200000
  s_cbranch_scc1 poll_39_x
  s_cbranch_vccnz poll_39
poll_39_x:
  buffer_load_dwordx4 a[32:35], v8, s[8:11], s37 offen offset:0 sc1
  buffer_load_dwordx4 a[36:39], v9, s[8:11], s37 offen offset:0 sc1
  v_mfma_f32_32x32x16_bf16 v[88:103], a[240:243], a[116:119], v[88:103]
  v_mfma_f32_32x32x16_bf16 v[32:47], a[244:247], a[112:115], v[32:47]
  v_mfma_f32_32x32x16_bf16 v[16:31], a[240:243], a[112:115], v[16:31]
  v_mfma_f32_32x32x16_bf16 v[64:79], a[252:255], a[124:127], v[64:79]
  s_add_u32 s67, s36, 40960
  buffer_load_dwordx4 v[200:203], v10, s[8:11], s67 offen offset:2048 sc1
  buffer_load_dwordx4 v[204:207], v11, s[8:11], s67 offen offset:2048 sc1
  buffer_load_dwordx4 a[40:43], v8, s[8:11], s37 offen offset:2048 sc1
  buffer_load_dwordx4 a[44:47], v9, s[8:11], s37 offen offset:2048 sc1
  s_add_u32 s37, s37, 4096
  v_mfma_f32_32x32x16_bf16 v[88:103], a[248:251], a[124:127], v[88:103]
  v_mfma_f32_32x32x16_bf16 v[32:47], a[252:255], a[120:123], v[32:47]
  v_mfma_f32_32x32x16_bf16 v[16:31], a[248:251], a[120:123], v[16:31]
  s_waitcnt vmcnt(20)
  v_mfma_f32_32x32x16_bf16 v[64:79], v[164:167], a[4:7], v[64:79]
  s_add_u32 s67, s36, 45056
  buffer_load_dwordx4 v[208:211], v10, s[8:11], s67 offen offset:0 sc1
  buffer_load_dwordx4 v[212:215], v11, s[8:11], s67 offen offset:0 sc1
  buffer_load_dwordx4 a[48:51], v8, s[8:11], s37 offen offset:0 sc1
  buffer_load_dwordx4 a[52:55], v9, s[8:11], s37 offen offset:0 sc1
  s_xor_b32 s16, s20, 3
  v_mfma_f32_32x32x16_bf16 v[88:103], v[160:163], a[4:7], v[88:103]
  s_mul_i32 s16, s16, 12288
  v_mfma_f32_32x32x16_bf16 v[32:47], v[164:167], a[0:3], v[32:47]
  s_add_u32 s16, s16, 106496
  v_mfma_f32_32x32x16_bf16 v[16:31], v[160:163], a[0:3], v[16:31]
  v_add_u32 v107, s16, v1
  s_waitcnt vmcnt(20)
  v_mfma_f32_32x32x16_bf16 v[64:79], v[172:175], a[12:15], v[64:79]
  s_add_u32 s67, s36, 45056
  buffer_load_dwordx4 v[216:219], v10, s[8:11], s67 offen offset:2048 sc1
  buffer_load_dwordx4 v[220:223], v11, s[8:11], s67 offen offset:2048 sc1
  buffer_load_dwordx4 a[56:59], v8, s[8:11], s37 offen offset:2048 sc1
  buffer_load_dwordx4 a[60:63], v9, s[8:11], s37 offen offset:2048 sc1
  s_add_u32 s37, s37, 4096
  s_xor_b32 s16, s20, 2
  v_mfma_f32_32x32x16_bf16 v[88:103], v[168:171], a[12:15], v[88:103]
  s_mul_i32 s16, s16, 12288
  v_mfma_f32_32x32x16_bf16 v[32:47], v[172:175], a[8:11], v[32:47]
  s_add_u32 s16, s16, 102400
  v_mfma_f32_32x32x16_bf16 v[16:31], v[168:171], a[8:11], v[16:31]
  v_add_u32 v106, s16, v1
  s_waitcnt vmcnt(20)
  v_mfma_f32_32x32x16_bf16 v[64:79], v[180:183], a[20:23], v[64:79]
  s_add_u32 s67, s36, 49152
  buffer_load_dwordx4 v[224:227], v10, s[8:11], s67 offen offset:0 sc1
  buffer_load_dwordx4 v[228:231], v11, s[8:11], s67 offen offset:0 sc1
  buffer_load_dwordx4 a[64:67], v8, s[8:11], s37 offen offset:0 sc1
  buffer_load_dwordx4 a[68:71], v9, s[8:11], s37 offen offset:0 sc1
  s_xor_b32 s16, s20, 1
  v_mfma_f32_32x32x16_bf16 v[88:103], v[176:179], a[20:23], v[88:103]
  s_mul_i32 s16, s16, 12288
  v_mfma_f32_32x32x16_bf16 v[32:47], v[180:183], a[16:19], v[32:47]
  s_add_u32 s16, s16, 98304
  v_mfma_f32_32x32x16_bf16 v[16:31], v[176:179], a[16:19], v[16:31]
  v_add_u32 v105, s16, v1
  s_waitcnt vmcnt(20)
  v_mfma_f32_32x32x16_bf16 v[64:79], v[188:191], a[28:31], v[64:79]
  s_add_u32 s67, s36, 49152
  buffer_load_dwordx4 v[232:235], v10, s[8:11], s67 offen offset:2048 sc1
  buffer_load_dwordx4 v[236:239], v11, s[8:11], s67 offen offset:2048 sc1
  buffer_load_dwordx4 a[72:75], v8, s[8:11], s37 offen offset:2048 sc1
  buffer_load_dwordx4 a[76:79], v9, s[8:11], s37 offen offset:2048 sc1
  s_add_u32 s37, s37, 4096
  s_mul_i32 s16, s20, 12288
  v_mfma_f32_32x32x16_bf16 v[88:103], v[184:187], a[28:31], v[88:103]
  s_add_u32 s16, s16, 98304
  v_mfma_f32_32x32x16_bf16 v[32:47], v[188:191], a[24:27], v[32:47]
  v_add_u32 v104, s16, v1
  v_mfma_f32_32x32x16_bf16 v[16:31], v[184:187], a[24:27], v[16:31]
  s_mov_b32 s17, 0xffff0000
  s_waitcnt vmcnt(20)
  v_mfma_f32_32x32x16_bf16 v[64:79], v[196:199], a[36:39], v[64:79]
  s_add_u32 s67, s36, 53248
  buffer_load_dwordx4 v[240:243], v10, s[8:11], s67 offen offset:0 sc1
  buffer_load_dwordx4 v[244:247], v11, s[8:11], s67 offen offset:0 sc1
  buffer_load_dwordx4 a[80:83], v8, s[8:11], s37 offen offset:0 sc1
  buffer_load_dwordx4 a[84:87], v9, s[8:11], s37 offen offset:0 sc1
  v_lshlrev_b32 v48, 16, v80
  v_mfma_f32_32x32x16_bf16 v[88:103], v[192:195], a[36:39], v[88:103]
  v_and_b32 v49, s17, v80
  v_mfma_f32_32x32x16_bf16 v[32:47], v[196:199], a[32:35], v[32:47]
  v_lshlrev_b32 v50, 16, v81
  v_mfma_f32_32x32x16_bf16 v[16:31], v[192:195], a[32:35], v[16:31]
  v_and_b32 v51, s17, v81
  s_waitcnt vmcnt(20)
  v_mfma_f32_32x32x16_bf16 v[64:79], v[204:207], a[44:47], v[64:79]
  s_add_u32 s67, s36, 53248
  buffer_load_dwordx4 v[248:251], v10, s[8:11], s67 offen offset:2048 sc1
  buffer_load_dwordx4 v[252:255], v11, s[8:11], s67 offen offset:2048 sc1
  buffer_load_dwordx4 a[88:91], v8, s[8:11], s37 offen offset:2048 sc1
  buffer_load_dwordx4 a[92:95], v9, s[8:11], s37 offen offset:2048 sc1
  s_add_u32 s37, s37, 4096
  v_lshlrev_b32 v52, 16, v82
  v_mfma_f32_32x32x16_bf16 v[88:103], v[200:203], a[44:47], v[88:103]
  v_and_b32 v53, s17, v82
  v_mfma_f32_32x32x16_bf16 v[32:47], v[204:207], a[40:43], v[32:47]
  s_add_u32 m0, s31, 16384
  s_nop 0
  buffer_load_dwordx4 v1, s[8:11], s32 offen offset:0 sc1 lds
  v_lshlrev_b32 v54, 16, v83
  v_mfma_f32_32x32x16_bf16 v[16:31], v[200:203], a[40:43], v[16:31]
  v_and_b32 v55, s17, v83
  s_waitcnt vmcnt(21)
  v_mfma_f32_32x32x16_bf16 v[64:79], v[212:215], a[52:55], v[64:79]
  s_add_u32 m0, s31, 16384
  s_nop 0
  buffer_load_dwordx4 v1, s[8:11], s32 offen offset:1024 sc1 lds
  v_lshlrev_b32 v56, 16, v84
  v_mfma_f32_32x32x16_bf16 v[88:103], v[208:211], a[52:55], v[88:103]
  v_and_b32 v57, s17, v84
  v_mfma_f32_32x32x16_bf16 v[32:47], v[212:215], a[48:51], v[32:47]
  s_add_u32 m0, s31, 16384
  s_nop 0
  buffer_load_dwordx4 v1, s[8:11], s32 offen offset:2048 sc1 lds
  v_lshlrev_b32 v58, 16, v85
  v_mfma_f32_32x32x16_bf16 v[16:31], v[208:211], a[48:51], v[16:31]
  v_and_b32 v59, s17, v85
  s_waitcnt vmcnt(19)
  v_mfma_f32_32x32x16_bf16 v[64:79], v[220:223], a[60:63], v[64:79]
  s_add_u32 m0, s31, 16384
  s_nop 0
  buffer_load_dwordx4 v1, s[8:11], s32 offen offset:3072 sc1 lds
  s_add_u32 s32, s32, 16384
  v_lshlrev_b32 v60, 16, v86
  v_mfma_f32_32x32x16_bf16 v[88:103], v[216:219], a[60:63], v[88:103]
  v_and_b32 v61, s17, v86
  v_mfma_f32_32x32x16_bf16 v[32:47], v[220:223], a[56:59], v[32:47]
  s_add_u32 m0, s31, 32768
  s_nop 0
  buffer_load_dwordx4 v1, s[8:11], s32 offen offset:0 sc1 lds
  v_lshlrev_b32 v62, 16, v87
  v_mfma_f32_32x32x16_bf16 v[16:31], v[216:219], a[56:59], v[16:31]
  v_and_b32 v63, s17, v87
  s_waitcnt vmcnt(17)
  v_mfma_f32_32x32x16_bf16 v[64:79], v[228:231], a[68:71], v[64:79]
  s_add_u32 m0, s31, 32768
  s_nop 0
  buffer_load_dwordx4 v1, s[8:11], s32 offen offset:1024 sc1 lds
  s_waitcnt vmcnt(14)
  v_mfma_f32_32x32x16_bf16 v[64:79], v[236:239], a[76:79], v[64:79]
  s_add_u32 m0, s31, 32768
  s_nop 0
  buffer_load_dwordx4 v1, s[8:11], s32 offen offset:2048 sc1 lds
  s_waitcnt vmcnt(11)
  v_mfma_f32_32x32x16_bf16 v[64:79], v[244:247], a[84:87], v[64:79]
  s_add_u32 m0, s31, 32768
  s_nop 0
  buffer_load_dwordx4 v1, s[8:11], s32 offen offset:3072 sc1 lds
  s_add_u32 s32, s32, 16384
  s_waitcnt vmcnt(8)
  v_mfma_f32_32x32x16_bf16 v[64:79], v[252:255], a[92:95], v[64:79]
  s_add_u32 m0, s31, 49152
  s_nop 0
  buffer_load_dwordx4 v1, s[8:11], s32 offen offset:0 sc1 lds
  v_mfma_f32_32x32x16_bf16 v[88:103], v[224:227], a[68:71], v[88:103]
  v_mfma_f32_32x32x16_bf16 v[88:103], v[232:235], a[76:79], v[88:103]
  s_nop 6
  ds_write_b128 v107, v[64:67] offset:0
  ds_write_b128 v107, v[68:71] offset:1024
  v_mfma_f32_32x32x16_bf16 v[88:103], v[240:243], a[84:87], v[88:103]
  ds_write_b128 v107, v[72:75] offset:2048
  v_mfma_f32_32x32x16_bf16 v[88:103], v[248:251], a[92:95], v[88:103]
  ds_write_b128 v107, v[76:79] offset:3072
  v_mfma_f32_32x32x16_bf16 v[32:47], v[228:231], a[64:67], v[32:47]
  s_add_u32 m0, s31, 49152
  s_nop 0
  buffer_load_dwordx4 v1, s[8:11], s32 offen offset:1024 sc1 lds
  v_mfma_f32_32x32x16_bf16 v[32:47], v[236:239], a[72:75], v[32:47]
  s_add_u32 m0, s31, 49152
  s_nop 0
  buffer_load_dwordx4 v1, s[8:11], s32 offen offset:2048 sc1 lds
  s_nop 2
  ds_write_b128 v106, v[88:91] offset:0
  ds_write_b128 v106, v[92:95] offset:1024
  v_mfma_f32_32x32x16_bf16 v[32:47], v[244:247], a[80:83], v[32:47]
  s_add_u32 m0, s31, 49152
  s_nop 0
  buffer_load_dwordx4 v1, s[8:11], s32 offen offset:3072 sc1 lds
  s_add_u32 s32, s32, 16384
  ds_write_b128 v106, v[96:99] offset:2048
  v_mfma_f32_32x32x16_bf16 v[32:47], v[252:255], a[88:91], v[32:47]
  ds_write_b128 v106, v[100:103] offset:3072
  v_mfma_f32_32x32x16_bf16 v[16:31], v[224:227], a[64:67], v[16:31]
  v_mfma_f32_32x32x16_bf16 v[16:31], v[232:235], a[72:75], v[16:31]
  s_nop 8
  ds_write_b128 v105, v[32:35] offset:0
  ds_write_b128 v105, v[36:39] offset:1024
  v_mfma_f32_32x32x16_bf16 v[16:31], v[240:243], a[80:83], v[16:31]
  ds_write_b128 v105, v[40:43] offset:2048
  v_mfma_f32_32x32x16_bf16 v[16:31], v[248:251], a[88:91], v[16:31]
  ds_write_b128 v105, v[44:47] offset:3072
  s_waitcnt lgkmcnt(0)
  s_barrier
  ds_read_b128 v[32:35], v104 offset:0
  ds_read_b128 v[88:91], v104 offset:4096
  ds_read_b128 v[64:67], v104 offset:8192
  ds_read_b128 v[36:39], v104 offset:1024
  ds_read_b128 v[92:95], v104 offset:5120
  ds_read_b128 v[68:71], v104 offset:9216
  ds_read_b128 v[40:43], v104 offset:2048
  ds_read_b128 v[96:99], v104 offset:6144
  ds_read_b128 v[72:75], v104 offset:10240
  ds_read_b128 v[44:47], v104 offset:3072
  ds_read_b128 v[100:103], v104 offset:7168
  ds_read_b128 v[76:79], v104 offset:11264
  v_pk_add_f32 v[16:17], v[16:17], v[48:49]
  v_pk_add_f32 v[18:19], v[18:19], v[50:51]
  v_pk_add_f32 v[20:21], v[20:21], v[52:53]
  v_pk_add_f32 v[22:23], v[22:23], v[54:55]
  v_pk_add_f32 v[24:25], v[24:25], v[56:57]
  v_pk_add_f32 v[26:27], v[26:27], v[58:59]
  v_pk_add_f32 v[28:29], v[28:29], v[60:61]
  v_pk_add_f32 v[30:31], v[30:31], v[62:63]
  s_waitcnt lgkmcnt(11)
  v_pk_add_f32 v[16:17], v[16:17], v[32:33]
  v_pk_add_f32 v[18:19], v[18:19], v[34:35]
  s_waitcnt lgkmcnt(10)
  v_pk_add_f32 v[16:17], v[16:17], v[88:89]
  v_pk_add_f32 v[18:19], v[18:19], v[90:91]
  s_waitcnt lgkmcnt(9)
  v_pk_add_f32 v[16:17], v[16:17], v[64:65]
  v_pk_add_f32 v[18:19], v[18:19], v[66:67]
  v_cvt_pk_bf16_f32 v80, v16, v17
  v_cvt_pk_bf16_f32 v81, v18, v19
  s_waitcnt lgkmcnt(8)
  v_pk_add_f32 v[20:21], v[20:21], v[36:37]
  v_pk_add_f32 v[22:23], v[22:23], v[38:39]
  s_waitcnt lgkmcnt(7)
  v_pk_add_f32 v[20:21], v[20:21], v[92:93]
  v_pk_add_f32 v[22:23], v[22:23], v[94:95]
  s_waitcnt lgkmcnt(6)
  v_pk_add_f32 v[20:21], v[20:21], v[68:69]
  v_pk_add_f32 v[22:23], v[22:23], v[70:71]
  v_cvt_pk_bf16_f32 v82, v20, v21
  v_cvt_pk_bf16_f32 v83, v22, v23
  buffer_store_dwordx4 v[80:83], v1, s[8:11], s48 offen offset:0 sc1
  s_waitcnt lgkmcnt(5)
  v_pk_add_f32 v[24:25], v[24:25], v[40:41]
  v_pk_add_f32 v[26:27], v[26:27], v[42:43]
  s_waitcnt lgkmcnt(4)
  v_pk_add_f32 v[24:25], v[24:25], v[96:97]
  v_pk_add_f32 v[26:27], v[26:27], v[98:99]
  s_waitcnt lgkmcnt(3)
  v_pk_add_f32 v[24:25], v[24:25], v[72:73]
  v_pk_add_f32 v[26:27], v[26:27], v[74:75]
  v_cvt_pk_bf16_f32 v84, v24, v25
  v_cvt_pk_bf16_f32 v85, v26, v27
  s_waitcnt lgkmcnt(2)
  v_pk_add_f32 v[28:29], v[28:29], v[44:45]
  v_pk_add_f32 v[30:31], v[30:31], v[46:47]
  s_waitcnt lgkmcnt(1)
  v_pk_add_f32 v[28:29], v[28:29], v[100:101]
  v_pk_add_f32 v[30:31], v[30:31], v[102:103]
  s_waitcnt lgkmcnt(0)
  v_pk_add_f32 v[28:29], v[28:29], v[76:77]
  v_pk_add_f32 v[30:31], v[30:31], v[78:79]
  v_cvt_pk_bf16_f32 v86, v28, v29
  v_cvt_pk_bf16_f32 v87, v30, v31
  buffer_store_dwordx4 v[84:87], v1, s[8:11], s48 offen offset:1024 sc1
  v_pk_add_f32 v[112:113], v[16:17], v[18:19]
  v_pk_add_f32 v[114:115], v[20:21], v[22:23]
  v_pk_add_f32 v[112:113], v[112:113], v[24:25]
  v_pk_add_f32 v[114:115], v[114:115], v[26:27]
  v_pk_add_f32 v[112:113], v[112:113], v[28:29]
  v_pk_add_f32 v[114:115], v[114:115], v[30:31]
  v_pk_add_f32 v[112:113], v[112:113], v[114:115]
  v_add_f32 v112, v112, v113
  v_mov_b32 v114, v112
  s_nop 1
  v_permlane32_swap_b32 v114, v112
  v_add_f32 v112, v114, v112
  v_mul_f32 v112, 0x3d000000, v112
  v_pk_add_f32 v[16:17], v[16:17], v[112:113] op_sel_hi:[1,0] neg_lo:[0,1] neg_hi:[0,1]
  v_pk_add_f32 v[18:19], v[18:19], v[112:113] op_sel_hi:[1,0] neg_lo:[0,1] neg_hi:[0,1]
  v_pk_add_f32 v[20:21], v[20:21], v[112:113] op_sel_hi:[1,0] neg_lo:[0,1] neg_hi:[0,1]
  v_pk_add_f32 v[22:23], v[22:23], v[112:113] op_sel_hi:[1,0] neg_lo:[0,1] neg_hi:[0,1]
  v_pk_add_f32 v[24:25], v[24:25], v[112:113] op_sel_hi:[1,0] neg_lo:[0,1] neg_hi:[0,1]
  v_pk_add_f32 v[26:27], v[26:27], v[112:113] op_sel_hi:[1,0] neg_lo:[0,1] neg_hi:[0,1]
  v_pk_add_f32 v[28:29], v[28:29], v[112:113] op_sel_hi:[1,0] neg_lo:[0,1] neg_hi:[0,1]
  v_pk_add_f32 v[30:31], v[30:31], v[112:113] op_sel_hi:[1,0] neg_lo:[0,1] neg_hi:[0,1]
  v_pk_mul_f32 v[114:115], v[16:17], v[16:17]
  v_pk_mul_f32 v[16:17], v[18:19], v[18:19]
  v_pk_fma_f32 v[114:115], v[20:21], v[20:21], v[114:115]
  v_pk_fma_f32 v[16:17], v[22:23], v[22:23], v[16:17]
  v_pk_fma_f32 v[114:115], v[24:25], v[24:25], v[114:115]
  v_pk_fma_f32 v[16:17], v[26:27], v[26:27], v[16:17]
  v_pk_fma_f32 v[114:115], v[28:29], v[28:29], v[114:115]
  v_pk_fma_f32 v[16:17], v[30:31], v[30:31], v[16:17]
  v_pk_add_f32 v[114:115], v[114:115], v[16:17]
  v_add_f32 v113, v114, v115
  v_min_u32 v112, -2, v112
  v_mov_b32 v114, v113
  s_nop 1
  v_permlane32_swap_b32 v114, v113
  v_add_f32 v113, v114, v113
  buffer_store_dwordx2 v[112:113], v12, s[8:11], s49 offen sc1
  v_mov_b32 v14, s50
  s_mov_b64 exec, 1
  buffer_store_dword v14, v13, s[8:11], s30 offen
  s_mov_b64 exec, -1
  s_waitcnt vmcnt(4)
  s_barrier
  ds_read_b128 v[88:91], v1 offset:0
  ds_read_b128 v[92:95], v1 offset:1024
  ds_read_b128 v[96:99], v1 offset:2048
  s_lshl_b32 s34, s23, 15
  s_add_u32 s34, s34, 11796480
  s_lshl_b32 s35, s23, 12
  s_add_u32 s35, s35, 16515072
  s_mov_b32 s58, 0
poll_40:
  buffer_load_dword v14, v138, s[8:11], s42 offen sc1
  s_waitcnt vmcnt(0)
  v_cmp_gt_u32 vcc, s50, v14
  s_add_u32 s58, s58, 1
  s_cmp_gt_u32 s58, 0x200000
  s_cbranch_scc1 poll_40_x
  s_cbranch_vccnz poll_40
poll_40_x:
  buffer_load_dwordx4 a[0:3], v1, s[8:11], s34 offen offset:0 sc1
  buffer_load_dwordx4 a[4:7], v1, s[8:11], s34 offen offset:1024 sc1
  buffer_load_dwordx4 a[8:11], v1, s[8:11], s34 offen offset:2048 sc1
  buffer_load_dwordx4 a[12:15], v1, s[8:11], s34 offen offset:3072 sc1
  s_add_u32 s34, s34, 4096
  buffer_load_dwordx4 a[16:19], v1, s[8:11], s34 offen offset:0 sc1
  buffer_load_dwordx4 a[20:23], v1, s[8:11], s34 offen offset:1024 sc1
  buffer_load_dwordx4 a[24:27], v1, s[8:11], s34 offen offset:2048 sc1
  buffer_load_dwordx4 a[28:31], v1, s[8:11], s34 offen offset:3072 sc1
  s_add_u32 s34, s34, 4096
  buffer_load_dwordx4 a[32:35], v1, s[8:11], s34 offen offset:0 sc1
  buffer_load_dwordx4 a[36:39], v1, s[8:11], s34 offen offset:1024 sc1
  s_add_u32 s16, s50, 8
  v_mov_b32 v14, s16
  s_mov_b64 exec, 1
  buffer_store_dword v14, v13, s[8:11], s30 offen
  s_mov_b64 exec, -1
  s_mov_b32 s26, 1
  s_branch L_fast
L_fast_k4b:
  s_waitcnt vmcnt(12)
  v_mfma_f32_32x32x16_bf16 v[64:79], a[132:135], a[4:7], 0
  buffer_load_dwordx4 a[48:51], v8, s[8:11], s37 offen offset:0 sc1
  buffer_load_dwordx4 a[52:55], v9, s[8:11], s37 offen offset:0 sc1
  s_nop 1
  v_mul_f32 v144, v136, v48
  v_mul_f32 v145, v136, v49
  v_exp_f32 v144, v144
  v_mfma_f32_32x32x16_bf16 v[88:103], a[128:131], a[4:7], 0
  v_mul_f32 v146, v136, v50
  v_exp_f32 v145, v145
  v_fma_f32 v144, v144, v137, v137
  v_mul_f32 v147, v136, v51
  v_mfma_f32_32x32x16_bf16 v[32:47], a[132:135], a[0:3], 0
  buffer_load_dwordx4 a[56:59], v8, s[8:11], s37 offen offset:2048 sc1
  buffer_load_dwordx4 a[60:63], v9, s[8:11], s37 offen offset:2048 sc1
  s_add_u32 s37, s37, 4096
  v_exp_f32 v146, v146
  v_fma_f32 v145, v145, v137, v137
  v_rcp_f32 v144, v144
  v_mul_f32 v148, v136, v52
  v_mfma_f32_32x32x16_bf16 v[16:31], a[128:131], a[0:3], 0
  v_exp_f32 v147, v147
  v_fma_f32 v146, v146, v137, v137
  v_rcp_f32 v145, v145
  v_mul_f32 v144, v144, v56
  s_waitcnt vmcnt(14)
  v_mfma_f32_32x32x16_bf16 v[64:79], a[140:143], a[12:15], v[64:79]
  buffer_load_dwordx4 a[64:67], v8, s[8:11], s37 offen offset:0 sc1
  buffer_load_dwordx4 a[68:71], v9, s[8:11], s37 offen offset:0 sc1
  v_mul_f32 v149, v136, v53
  v_exp_f32 v148, v148
  v_fma_f32 v147, v147, v137, v137
  v_mfma_f32_32x32x16_bf16 v[88:103], a[136:139], a[12:15], v[88:103]
  v_rcp_f32 v146, v146
  v_mul_f32 v145, v145, v57
  v_cvt_pk_bf16_f32 v120, v144, v145
  v_mul_f32 v150, v136, v54
  v_mfma_f32_32x32x16_bf16 v[32:47], a[140:143], a[8:11], v[32:47]
  v_exp_f32 v149, v149
  v_fma_f32 v148, v148, v137, v137
  v_rcp_f32 v147, v147
  v_mul_f32 v146, v146, v58
  v_mfma_f32_32x32x16_bf16 v[16:31], a[136:139], a[8:11], v[16:31]
  s_barrier
  v_mul_f32 v151, v136, v55
  v_exp_f32 v150, v150
  v_fma_f32 v149, v149, v137, v137
  v_rcp_f32 v148, v148
  s_waitcnt vmcnt(14)
  v_mfma_f32_32x32x16_bf16 v[64:79], a[148:151], a[20:23], v[64:79]
  buffer_load_dwordx4 a[72:75], v8, s[8:11], s37 offen offset:2048 sc1
  buffer_load_dwordx4 a[76:79], v9, s[8:11], s37 offen offset:2048 sc1
  s_add_u32 s37, s37, 4096
  v_mul_f32 v147, v147, v59
  v_cvt_pk_bf16_f32 v121, v146, v147
  v_exp_f32 v151, v151
  v_mfma_f32_32x32x16_bf16 v[88:103], a[144:147], a[20:23], v[88:103]
  v_fma_f32 v150, v150, v137, v137
  v_rcp_f32 v149, v149
  v_mul_f32 v148, v148, v60
  v_fma_f32 v151, v151, v137, v137
  v_mfma_f32_32x32x16_bf16 v[32:47], a[148:151], a[16:19], v[32:47]
  v_rcp_f32 v150, v150
  v_mul_f32 v149, v149, v61
  v_cvt_pk_bf16_f32 v122, v148, v149
  v_rcp_f32 v151, v151
  v_mfma_f32_32x32x16_bf16 v[16:31], a[144:147], a[16:19], v[16:31]
  buffer_load_dword v158, v139, s[8:11], s51 offen sc1
  v_mul_f32 v150, v150, v62
  v_mul_f32 v151, v151, v63
  v_cvt_pk_bf16_f32 v123, v150, v151
  buffer_store_dwordx4 v[120:123], v1, s[8:11], s52 offen sc1
  s_add_u32 s52, s52, 8192
  s_waitcnt vmcnt(16)
  v_mfma_f32_32x32x16_bf16 v[64:79], a[156:159], a[28:31], v[64:79]
  buffer_load_dwordx4 a[80:83], v8, s[8:11], s37 offen offset:0 sc1
  buffer_load_dwordx4 a[84:87], v9, s[8:11], s37 offen offset:0 sc1
  v_mfma_f32_32x32x16_bf16 v[88:103], a[152:155], a[28:31], v[88:103]
  v_mfma_f32_32x32x16_bf16 v[32:47], a[156:159], a[24:27], v[32:47]
  v_mfma_f32_32x32x16_bf16 v[16:31], a[152:155], a[24:27], v[16:31]
  s_waitcnt vmcnt(16)
  v_mfma_f32_32x32x16_bf16 v[64:79], a[164:167], a[36:39], v[64:79]
  buffer_load_dwordx4 a[88:91], v8, s[8:11], s37 offen offset:2048 sc1
  buffer_load_dwordx4 a[92:95], v9, s[8:11], s37 offen offset:2048 sc1
  s_add_u32 s37, s37, 4096
  v_mfma_f32_32x32x16_bf16 v[88:103], a[160:163], a[36:39], v[88:103]
  v_mfma_f32_32x32x16_bf16 v[32:47], a[164:167], a[32:35], v[32:47]
  v_mfma_f32_32x32x16_bf16 v[16:31], a[160:163], a[32:35], v[16:31]
  s_waitcnt vmcnt(16)
  v_mfma_f32_32x32x16_bf16 v[64:79], a[172:175], a[44:47], v[64:79]
  v_mfma_f32_32x32x16_bf16 v[88:103], a[168:171], a[44:47], v[88:103]
  v_mfma_f32_32x32x16_bf16 v[32:47], a[172:175], a[40:43], v[32:47]
  v_mfma_f32_32x32x16_bf16 v[16:31], a[168:171], a[40:43], v[16:31]
  s_waitcnt vmcnt(4)
  v_mov_b32 v14, s55
  s_mov_b64 exec, 1
  buffer_store_dword v14, v13, s[8:11], s47 offen
  s_mov_b64 exec, -1
  v_mfma_f32_32x32x16_bf16 v[64:79], a[180:183], a[52:55], v[64:79]
  v_cmp_gt_u32 vcc, s54, v158
  s_nop 0
  s_cbranch_vccz poll_41_x
  s_mov_b32 s58, 0
poll_41:
  buffer_load_dword v158, v139, s[8:11], s51 offen sc1
  s_waitcnt vmcnt(0)
  v_cmp_gt_u32 vcc, s54, v158
  s_add_u32 s58, s58, 1
  s_cmp_gt_u32 s58, 0x200000
  s_cbranch_scc1 poll_41_x
  s_cbranch_vccnz poll_41
poll_41_x:
  buffer_load_dwordx4 a[96:99], v8, s[8:11], s37 offen offset:0 sc1
  buffer_load_dwordx4 a[100:103], v9, s[8:11], s37 offen offset:0 sc1
  v_mfma_f32_32x32x16_bf16 v[88:103], a[176:179], a[52:55], v[88:103]
  v_mfma_f32_32x32x16_bf16 v[32:47], a[180:183], a[48:51], v[32:47]
  buffer_load_dwordx4 a[104:107], v8, s[8:11], s37 offen offset:2048 sc1
  buffer_load_dwordx4 a[108:111], v9, s[8:11], s37 offen offset:2048 sc1
  s_add_u32 s37, s37, 4096
  v_mfma_f32_32x32x16_bf16 v[16:31], a[176:179], a[48:51], v[16:31]
  v_mfma_f32_32x32x16_bf16 v[64:79], a[188:191], a[60:63], v[64:79]
  buffer_load_dwordx4 a[112:115], v8, s[8:11], s37 offen offset:0 sc1
  buffer_load_dwordx4 a[116:119], v9, s[8:11], s37 offen offset:0 sc1
  v_mfma_f32_32x32x16_bf16 v[88:103], a[184:187], a[60:63], v[88:103]
  v_mfma_f32_32x32x16_bf16 v[32:47], a[188:191], a[56:59], v[32:47]
  v_mfma_f32_32x32x16_bf16 v[16:31], a[184:187], a[56:59], v[16:31]
  v_mfma_f32_32x32x16_bf16 v[64:79], a[196:199], a[68:71], v[64:79]
  buffer_load_dwordx4 a[120:123], v8, s[8:11], s37 offen offset:2048 sc1
  buffer_load_dwordx4 a[124:127], v9, s[8:11], s37 offen offset:2048 sc1
  s_add_u32 s37, s37, 4096
  v_mfma_f32_32x32x16_bf16 v[88:103], a[192:195], a[68:71], v[88:103]
  v_mfma_f32_32x32x16_bf16 v[32:47], a[196:199], a[64:67], v[32:47]
  v_mfma_f32_32x32x16_bf16 v[16:31], a[192:195], a[64:67], v[16:31]
  v_mfma_f32_32x32x16_bf16 v[64:79], a[204:207], a[76:79], v[64:79]
  buffer_load_dwordx4 a[0:3], v8, s[8:11], s37 offen offset:0 sc1
  buffer_load_dwordx4 a[4:7], v9, s[8:11], s37 offen offset:0 sc1
  v_mfma_f32_32x32x16_bf16 v[88:103], a[200:203], a[76:79], v[88:103]
  v_mfma_f32_32x32x16_bf16 v[32:47], a[204:207], a[72:75], v[32:47]
  v_mfma_f32_32x32x16_bf16 v[16:31], a[200:203], a[72:75], v[16:31]
  buffer_load_dword v159, v139, s[8:11], s51 offen sc1
  s_waitcnt vmcnt(14)
  v_mfma_f32_32x32x16_bf16 v[64:79], a[212:215], a[84:87], v[64:79]
  buffer_load_dwordx4 a[8:11], v8, s[8:11], s37 offen offset:2048 sc1
  buffer_load_dwordx4 a[12:15], v9, s[8:11], s37 offen offset:2048 sc1
  s_add_u32 s37, s37, 4096
  v_mfma_f32_32x32x16_bf16 v[88:103], a[208:211], a[84:87], v[88:103]
  v_mfma_f32_32x32x16_bf16 v[32:47], a[212:215], a[80:83], v[32:47]
  v_mfma_f32_32x32x16_bf16 v[16:31], a[208:211], a[80:83], v[16:31]
  s_waitcnt vmcnt(14)
  v_mfma_f32_32x32x16_bf16 v[64:79], a[220:223], a[92:95], v[64:79]
  buffer_load_dwordx4 a[16:19], v8, s[8:11], s37 offen offset:0 sc1
  buffer_load_dwordx4 a[20:23], v9, s[8:11], s37 offen offset:0 sc1
  v_mfma_f32_32x32x16_bf16 v[88:103], a[216:219], a[92:95], v[88:103]
  v_mfma_f32_32x32x16_bf16 v[32:47], a[220:223], a[88:91], v[32:47]
  v_mfma_f32_32x32x16_bf16 v[16:31], a[216:219], a[88:91], v[16:31]
  s_waitcnt vmcnt(13)
  v_mfma_f32_32x32x16_bf16 v[64:79], a[228:231], a[100:103], v[64:79]
  buffer_load_dwordx4 a[24:27], v8, s[8:11], s37 offen offset:2048 sc1
  buffer_load_dwordx4 a[28:31], v9, s[8:11], s37 offen offset:2048 sc1
  s_add_u32 s37, s37, 4096
  v_mfma_f32_32x32x16_bf16 v[88:103], a[224:227], a[100:103], v[88:103]
  v_mfma_f32_32x32x16_bf16 v[32:47], a[228:231], a[96:99], v[32:47]
  v_mfma_f32_32x32x16_bf16 v[16:31], a[224:227], a[96:99], v[16:31]
  s_waitcnt vmcnt(13)
  v_mfma_f32_32x32x16_bf16 v[64:79], a[236:239], a[108:111], v[64:79]
  v_mfma_f32_32x32x16_bf16 v[88:103], a[232:235], a[108:111], v[88:103]
  v_mfma_f32_32x32x16_bf16 v[32:47], a[236:239], a[104:107], v[32:47]
  v_mfma_f32_32x32x16_bf16 v[16:31], a[232:235], a[104:107], v[16:31]
  s_waitcnt vmcnt(11)
  v_mfma_f32_32x32x16_bf16 v[64:79], a[244:247], a[116:119], v[64:79]
  s_waitcnt vmcnt(6)
  v_cmp_gt_u32 vcc, s55, v159
  s_nop 0
  s_cbranch_vccz poll_42_x
  s_mov_b32 s58, 0
poll_42:
  buffer_load_dword v159, v139, s[8:11], s51 offen sc1
  s_waitcnt vmcnt(0)
  v_cmp_gt_u32 vcc, s55, v159
  s_add_u32 s58, s58, 1
  s_cmp_gt_u32 s58, 0x200000
  s_cbranch_scc1 poll_42_x
  s_cbranch_vccnz poll_42
poll_42_x:
  buffer_load_dwordx4 a[32:35], v8, s[8:11], s37 offen offset:0 sc1
  buffer_load_dwordx4 a[36:39], v9, s[8:11], s37 offen offset:0 sc1
  v_mfma_f32_32x32x16_bf16 v[88:103], a[240:243], a[116:119], v[88:103]
  v_mfma_f32_32x32x16_bf16 v[32:47], a[244:247], a[112:115], v[32:47]
  buffer_load_dwordx4 a[40:43], v8, s[8:11], s37 offen offset:2048 sc1
  buffer_load_dwordx4 a[44:47], v9, s[8:11], s37 offen offset:2048 sc1
  s_add_u32 s37, s37, 4096
  v_mfma_f32_32x32x16_bf16 v[16:31], a[240:243], a[112:115], v[16:31]
  v_mfma_f32_32x32x16_bf16 v[64:79], a[252:255], a[124:127], v[64:79]
  buffer_load_dwordx4 a[48:51], v8, s[8:11], s37 offen offset:0 sc1
  buffer_load_dwordx4 a[52:55], v9, s[8:11], s37 offen offset:0 sc1
  v_mfma_f32_32x32x16_bf16 v[88:103], a[248:251], a[124:127], v[88:103]
  v_mfma_f32_32x32x16_bf16 v[32:47], a[252:255], a[120:123], v[32:47]
  v_mfma_f32_32x32x16_bf16 v[16:31], a[248:251], a[120:123], v[16:31]
  v_mfma_f32_32x32x16_bf16 v[64:79], v[164:167], a[4:7], v[64:79]
  buffer_load_dwordx4 a[56:59], v8, s[8:11], s37 offen offset:2048 sc1
  buffer_load_dwordx4 a[60:63], v9, s[8:11], s37 offen offset:2048 sc1
  s_add_u32 s37, s37, 4096
  s_xor_b32 s16, s20, 3
  v_mfma_f32_32x32x16_bf16 v[88:103], v[160:163], a[4:7], v[88:103]
  s_mul_i32 s16, s16, 12288
  v_mfma_f32_32x32x16_bf16 v[32:47], v[164:167], a[0:3], v[32:47]
  s_add_u32 s16, s16, 106496
  v_mfma_f32_32x32x16_bf16 v[16:31], v[160:163], a[0:3], v[16:31]
  v_add_u32 v107, s16, v1
  s_waitcnt vmcnt(12)
  v_mfma_f32_32x32x16_bf16 v[64:79], v[172:175], a[12:15], v[64:79]
  buffer_load_dwordx4 a[64:67], v8, s[8:11], s37 offen offset:0 sc1
  buffer_load_dwordx4 a[68:71], v9, s[8:11], s37 offen offset:0 sc1
  s_xor_b32 s16, s20, 2
  v_mfma_f32_32x32x16_bf16 v[88:103], v[168:171], a[12:15], v[88:103]
  s_mul_i32 s16, s16, 12288
  v_mfma_f32_32x32x16_bf16 v[32:47], v[172:175], a[8:11], v[32:47]
  s_add_u32 s16, s16, 102400
  v_mfma_f32_32x32x16_bf16 v[16:31], v[168:171], a[8:11], v[16:31]
  v_add_u32 v106, s16, v1
  s_waitcnt vmcnt(12)
  v_mfma_f32_32x32x16_bf16 v[64:79], v[180:183], a[20:23], v[64:79]
  buffer_load_dwordx4 a[72:75], v8, s[8:11], s37 offen offset:2048 sc1
  buffer_load_dwordx4 a[76:79], v9, s[8:11], s37 offen offset:2048 sc1
  s_add_u32 s37, s37, 4096
  s_xor_b32 s16, s20, 1
  v_mfma_f32_32x32x16_bf16 v[88:103], v[176:179], a[20:23], v[88:103]
  s_mul_i32 s16, s16, 12288
  v_mfma_f32_32x32x16_bf16 v[32:47], v[180:183], a[16:19], v[32:47]
  s_add_u32 s16, s16, 98304
  v_mfma_f32_32x32x16_bf16 v[16:31], v[176:179], a[16:19], v[16:31]
  v_add_u32 v105, s16, v1
  s_waitcnt vmcnt(12)
  v_mfma_f32_32x32x16_bf16 v[64:79], v[188:191], a[28:31], v[64:79]
  buffer_load_dwordx4 a[80:83], v8, s[8:11], s37 offen offset:0 sc1
  buffer_load_dwordx4 a[84:87], v9, s[8:11], s37 offen offset:0 sc1
  s_mul_i32 s16, s20, 12288
  v_mfma_f32_32x32x16_bf16 v[88:103], v[184:187], a[28:31], v[88:103]
  s_add_u32 s16, s16, 98304
  v_mfma_f32_32x32x16_bf16 v[32:47], v[188:191], a[24:27], v[32:47]
  v_add_u32 v104, s16, v1
  v_mfma_f32_32x32x16_bf16 v[16:31], v[184:187], a[24:27], v[16:31]
  s_mov_b32 s17, 0xffff0000
  s_waitcnt vmcnt(12)
  v_mfma_f32_32x32x16_bf16 v[64:79], v[196:199], a[36:39], v[64:79]
  buffer_load_dwordx4 a[88:91], v8, s[8:11], s37 offen offset:2048 sc1
  buffer_load_dwordx4 a[92:95], v9, s[8:11], s37 offen offset:2048 sc1
  s_add_u32 s37, s37, 4096
  v_lshlrev_b32 v48, 16, v80
  v_mfma_f32_32x32x16_bf16 v[88:103], v[192:195], a[36:39], v[88:103]
  v_and_b32 v49, s17, v80
  v_mfma_f32_32x32x16_bf16 v[32:47], v[196:199], a[32:35], v[32:47]
  v_lshlrev_b32 v50, 16, v81
  v_mfma_f32_32x32x16_bf16 v[16:31], v[192:195], a[32:35], v[16:31]
  v_and_b32 v51, s17, v81
  s_waitcnt vmcnt(12)
  v_mfma_f32_32x32x16_bf16 v[64:79], v[204:207], a[44:47], v[64:79]
  v_lshlrev_b32 v52, 16, v82
  v_mfma_f32_32x32x16_bf16 v[88:103], v[200:203], a[44:47], v[88:103]
  v_and_b32 v53, s17, v82
  v_mfma_f32_32x32x16_bf16 v[32:47], v[204:207], a[40:43], v[32:47]
  v_lshlrev_b32 v54, 16, v83
  v_mfma_f32_32x32x16_bf16 v[16:31], v[200:203], a[40:43], v[16:31]
  v_and_b32 v55, s17, v83
  s_waitcnt vmcnt(10)
  v_mfma_f32_32x32x16_bf16 v[64:79], v[212:215], a[52:55], v[64:79]
  v_lshlrev_b32 v56, 16, v84
  v_mfma_f32_32x32x16_bf16 v[88:103], v[208:211], a[52:55], v[88:103]
  v_and_b32 v57, s17, v84
  v_mfma_f32_32x32x16_bf16 v[32:47], v[212:215], a[48:51], v[32:47]
  v_lshlrev_b32 v58, 16, v85
  v_mfma_f32_32x32x16_bf16 v[16:31], v[208:211], a[48:51], v[16:31]
  v_and_b32 v59, s17, v85
  s_waitcnt vmcnt(8)
  v_mfma_f32_32x32x16_bf16 v[64:79], v[220:223], a[60:63], v[64:79]
  v_lshlrev_b32 v60, 16, v86
  v_mfma_f32_32x32x16_bf16 v[88:103], v[216:219], a[60:63], v[88:103]
  v_and_b32 v61, s17, v86
  v_mfma_f32_32x32x16_bf16 v[32:47], v[220:223], a[56:59], v[32:47]
  v_lshlrev_b32 v62, 16, v87
  v_mfma_f32_32x32x16_bf16 v[16:31], v[216:219], a[56:59], v[16:31]
  v_and_b32 v63, s17, v87
  s_waitcnt vmcnt(6)
  v_mfma_f32_32x32x16_bf16 v[64:79], v[228:231], a[68:71], v[64:79]
  s_waitcnt vmcnt(4)
  v_mfma_f32_32x32x16_bf16 v[64:79], v[236:239], a[76:79], v[64:79]
  s_waitcnt vmcnt(2)
  v_mfma_f32_32x32x16_bf16 v[64:79], v[244:247], a[84:87], v[64:79]
  s_waitcnt vmcnt(0)
  v_mfma_f32_32x32x16_bf16 v[64:79], v[252:255], a[92:95], v[64:79]
  v_mfma_f32_32x32x16_bf16 v[88:103], v[224:227], a[68:71], v[88:103]
  v_mfma_f32_32x32x16_bf16 v[88:103], v[232:235], a[76:79], v[88:103]
  s_nop 9
  ds_write_b128 v107, v[64:67] offset:0
  ds_write_b128 v107, v[68:71] offset:1024
  v_mfma_f32_32x32x16_bf16 v[88:103], v[240:243], a[84:87], v[88:103]
  ds_write_b128 v107, v[72:75] offset:2048
  v_mfma_f32_32x32x16_bf16 v[88:103], v[248:251], a[92:95], v[88:103]
  ds_write_b128 v107, v[76:79] offset:3072
  v_mfma_f32_32x32x16_bf16 v[32:47], v[228:231], a[64:67], v[32:47]
  v_mfma_f32_32x32x16_bf16 v[32:47], v[236:239], a[72:75], v[32:47]
  s_nop 8
  ds_write_b128 v106, v[88:91] offset:0
  ds_write_b128 v106, v[92:95] offset:1024
  v_mfma_f32_32x32x16_bf16 v[32:47], v[244:247], a[80:83], v[32:47]
  ds_write_b128 v106, v[96:99] offset:2048
  v_mfma_f32_32x32x16_bf16 v[32:47], v[252:255], a[88:91], v[32:47]
  ds_write_b128 v106, v[100:103] offset:3072
  v_mfma_f32_32x32x16_bf16 v[16:31], v[224:227], a[64:67], v[16:31]
  v_mfma_f32_32x32x16_bf16 v[16:31], v[232:235], a[72:75], v[16:31]
  s_nop 8
  ds_write_b128 v105, v[32:35] offset:0
  ds_write_b128 v105, v[36:39] offset:1024
  v_mfma_f32_32x32x16_bf16 v[16:31], v[240:243], a[80:83], v[16:31]
  ds_write_b128 v105, v[40:43] offset:2048
  v_mfma_f32_32x32x16_bf16 v[16:31], v[248:251], a[88:91], v[16:31]
  ds_write_b128 v105, v[44:47] offset:3072
  s_waitcnt lgkmcnt(0)
  s_barrier
  ds_read_b128 v[32:35], v104 offset:0
  ds_read_b128 v[88:91], v104 offset:4096
  ds_read_b128 v[64:67], v104 offset:8192
  ds_read_b128 v[36:39], v104 offset:1024
  ds_read_b128 v[92:95], v104 offset:5120
  ds_read_b128 v[68:71], v104 offset:9216
  ds_read_b128 v[40:43], v104 offset:2048
  ds_read_b128 v[96:99], v104 offset:6144
  ds_read_b128 v[72:75], v104 offset:10240
  ds_read_b128 v[44:47], v104 offset:3072
  ds_read_b128 v[100:103], v104 offset:7168
  ds_read_b128 v[76:79], v104 offset:11264
  s_mov_b64 s[12:13], s[60:61]
  s_mov_b32 s14, 2097152
  s_mov_b32 s15, 0x20000
  v_lshlrev_b32 v7, 10, v2
  v_lshl_add_u32 v7, v3, 4, v7
  v_pk_add_f32 v[16:17], v[16:17], v[48:49]
  v_pk_add_f32 v[18:19], v[18:19], v[50:51]
  v_pk_add_f32 v[20:21], v[20:21], v[52:53]
  v_pk_add_f32 v[22:23], v[22:23], v[54:55]
  v_pk_add_f32 v[24:25], v[24:25], v[56:57]
  v_pk_add_f32 v[26:27], v[26:27], v[58:59]
  v_pk_add_f32 v[28:29], v[28:29], v[60:61]
  v_pk_add_f32 v[30:31], v[30:31], v[62:63]
  s_waitcnt lgkmcnt(11)
  v_pk_add_f32 v[16:17], v[16:17], v[32:33]
  v_pk_add_f32 v[18:19], v[18:19], v[34:35]
  s_waitcnt lgkmcnt(10)
  v_pk_add_f32 v[16:17], v[16:17], v[88:89]
  v_pk_add_f32 v[18:19], v[18:19], v[90:91]
  s_waitcnt lgkmcnt(9)
  v_pk_add_f32 v[16:17], v[16:17], v[64:65]
  v_pk_add_f32 v[18:19], v[18:19], v[66:67]
  v_cvt_pk_bf16_f32 v80, v16, v17
  v_cvt_pk_bf16_f32 v81, v18, v19
  s_waitcnt lgkmcnt(8)
  v_pk_add_f32 v[20:21], v[20:21], v[36:37]
  v_pk_add_f32 v[22:23], v[22:23], v[38:39]
  s_waitcnt lgkmcnt(7)
  v_pk_add_f32 v[20:21], v[20:21], v[92:93]
  v_pk_add_f32 v[22:23], v[22:23], v[94:95]
  s_waitcnt lgkmcnt(6)
  v_pk_add_f32 v[20:21], v[20:21], v[68:69]
  v_pk_add_f32 v[22:23], v[22:23], v[70:71]
  v_cvt_pk_bf16_f32 v82, v20, v21
  v_cvt_pk_bf16_f32 v83, v22, v23
  s_nop 0
  v_permlane32_swap_b32 v80, v82
  v_permlane32_swap_b32 v81, v83
  buffer_store_dwordx4 v[80:83], v7, s[12:15], s57 offen offset:0
  s_waitcnt lgkmcnt(5)
  v_pk_add_f32 v[24:25], v[24:25], v[40:41]
  v_pk_add_f32 v[26:27], v[26:27], v[42:43]
  s_waitcnt lgkmcnt(4)
  v_pk_add_f32 v[24:25], v[24:25], v[96:97]
  v_pk_add_f32 v[26:27], v[26:27], v[98:99]
  s_waitcnt lgkmcnt(3)
  v_pk_add_f32 v[24:25], v[24:25], v[72:73]
  v_pk_add_f32 v[26:27], v[26:27], v[74:75]
  v_cvt_pk_bf16_f32 v84, v24, v25
  v_cvt_pk_bf16_f32 v85, v26, v27
  s_waitcnt lgkmcnt(2)
  v_pk_add_f32 v[28:29], v[28:29], v[44:45]
  v_pk_add_f32 v[30:31], v[30:31], v[46:47]
  s_waitcnt lgkmcnt(1)
  v_pk_add_f32 v[28:29], v[28:29], v[100:101]
  v_pk_add_f32 v[30:31], v[30:31], v[102:103]
  s_waitcnt lgkmcnt(0)
  v_pk_add_f32 v[28:29], v[28:29], v[76:77]
  v_pk_add_f32 v[30:31], v[30:31], v[78:79]
  v_cvt_pk_bf16_f32 v86, v28, v29
  v_cvt_pk_bf16_f32 v87, v30, v31
  s_nop 0
  v_permlane32_swap_b32 v84, v86
  v_permlane32_swap_b32 v85, v87
  buffer_store_dwordx4 v[84:87], v7, s[12:15], s57 offen offset:32
  s_endpgm
L_fast_k1redo:
  s_mov_b32 s97, 1
  s_add_u32 s16, s50, 8
  v_and_b32 v7, 15, v0
  v_lshlrev_b32 v7, 2, v7
  s_mov_b32 s58, 0
poll_43:
  buffer_load_dword v14, v7, s[8:11], s42 offen sc1
  s_waitcnt vmcnt(0)
  v_cmp_gt_u32 vcc, s16, v14
  s_add_u32 s58, s58, 1
  s_cmp_gt_u32 s58, 0x200000
  s_cbranch_scc1 poll_43_x
  s_cbranch_vccnz poll_43
poll_43_x:
  s_lshl_b32 s34, s23, 15
  s_add_u32 s34, s34, 11796480
  s_lshl_b32 s35, s23, 12
  s_add_u32 s35, s35, 16515072
  buffer_load_dwordx4 a[0:3], v1, s[8:11], s34 offen offset:0 sc1
  buffer_load_dwordx4 a[4:7], v1, s[8:11], s34 offen offset:1024 sc1
  buffer_load_dwordx4 a[8:11], v1, s[8:11], s34 offen offset:2048 sc1
  buffer_load_dwordx4 a[12:15], v1, s[8:11], s34 offen offset:3072 sc1
  s_add_u32 s34, s34, 4096
  buffer_load_dwordx2 v[112:113], v4, s[8:11], s35 offen offset:0 sc1
  buffer_load_dwordx2 v[114:115], v4, s[8:11], s35 offen offset:256 sc1
  buffer_load_dwordx2 v[116:117], v4, s[8:11], s35 offen offset:512 sc1
  buffer_load_dwordx2 v[118:119], v4, s[8:11], s35 offen offset:768 sc1
  buffer_load_dwordx2 v[120:121], v4, s[8:11], s35 offen offset:1024 sc1
  buffer_load_dwordx2 v[122:123], v4, s[8:11], s35 offen offset:1280 sc1
  buffer_load_dwordx2 v[124:125], v4, s[8:11], s35 offen offset:1536 sc1
  buffer_load_dwordx2 v[126:127], v4, s[8:11], s35 offen offset:1792 sc1
  buffer_load_dwordx4 a[16:19], v1, s[8:11], s34 offen offset:0 sc1
  buffer_load_dwordx4 a[20:23], v1, s[8:11], s34 offen offset:1024 sc1
  buffer_load_dwordx4 a[24:27], v1, s[8:11], s34 offen offset:2048 sc1
  buffer_load_dwordx4 a[28:31], v1, s[8:11], s34 offen offset:3072 sc1
  s_add_u32 s34, s34, 4096
  buffer_load_dwordx4 a[32:35], v1, s[8:11], s34 offen offset:0 sc1
  buffer_load_dwordx4 a[36:39], v1, s[8:11], s34 offen offset:1024 sc1
  buffer_load_dwordx4 a[40:43], v1, s[8:11], s34 offen offset:2048 sc1
  buffer_load_dwordx4 a[44:47], v1, s[8:11], s34 offen offset:3072 sc1
  s_add_u32 s34, s34, 4096
  buffer_load_dwordx4 a[48:51], v1, s[8:11], s34 offen offset:0 sc1
  buffer_load_dwordx4 a[52:55], v1, s[8:11], s34 offen offset:1024 sc1
  buffer_load_dwordx4 a[56:59], v1, s[8:11], s34 offen offset:2048 sc1
  buffer_load_dwordx4 a[60:63], v1, s[8:11], s34 offen offset:3072 sc1
  s_add_u32 s34, s34, 4096
  buffer_load_dwordx4 a[64:67], v1, s[8:11], s34 offen offset:0 sc1
  buffer_load_dwordx4 a[68:71], v1, s[8:11], s34 offen offset:1024 sc1
  buffer_load_dwordx4 a[72:75], v1, s[8:11], s34 offen offset:2048 sc1
  buffer_load_dwordx4 a[76:79], v1, s[8:11], s34 offen offset:3072 sc1
  s_add_u32 s34, s34, 4096
  buffer_load_dwordx4 a[80:83], v1, s[8:11], s34 offen offset:0 sc1
  buffer_load_dwordx4 a[84:87], v1, s[8:11], s34 offen offset:1024 sc1
  buffer_load_dwordx4 a[88:91], v1, s[8:11], s34 offen offset:2048 sc1
  buffer_load_dwordx4 a[92:95], v1, s[8:11], s34 offen offset:3072 sc1
  s_add_u32 s34, s34, 4096
  buffer_load_dwordx4 a[96:99], v1, s[8:11], s34 offen offset:0 sc1
  buffer_load_dwordx4 a[100:103], v1, s[8:11], s34 offen offset:1024 sc1
  buffer_load_dwordx4 a[104:107], v1, s[8:11], s34 offen offset:2048 sc1
  buffer_load_dwordx4 a[108:111], v1, s[8:11], s34 offen offset:3072 sc1
  s_add_u32 s34, s34, 4096
  buffer_load_dwordx4 a[112:115], v1, s[8:11], s34 offen offset:0 sc1
  buffer_load_dwordx4 a[116:119], v1, s[8:11], s34 offen offset:1024 sc1
  buffer_load_dwordx4 a[120:123], v1, s[8:11], s34 offen offset:2048 sc1
  buffer_load_dwordx4 a[124:127], v1, s[8:11], s34 offen offset:3072 sc1
  s_add_u32 s34, s34, 4096
  s_waitcnt vmcnt(34)
  v_add_f32 v128, v112, v114
  v_add_f32 v129, v113, v115
  s_waitcnt vmcnt(33)
  v_add_f32 v128, v128, v116
  v_add_f32 v129, v129, v117
  s_waitcnt vmcnt(32)
  v_add_f32 v128, v128, v118
  v_add_f32 v129, v129, v119
  s_waitcnt vmcnt(31)
  v_add_f32 v128, v128, v120
  v_add_f32 v129, v129, v121
  s_waitcnt vmcnt(30)
  v_add_f32 v128, v128, v122
  v_add_f32 v129, v129, v123
  s_waitcnt vmcnt(29)
  v_add_f32 v128, v128, v124
  v_add_f32 v129, v129, v125
  s_waitcnt vmcnt(28)
  v_add_f32 v128, v128, v126
  v_add_f32 v129, v129, v127
  v_mov_b32 v130, v128
  s_nop 1
  v_permlane32_swap_b32 v130, v128
  v_add_f32 v128, v130, v128
  v_mul_f32 v128, 0x3d800000, v128
  v_sub_f32 v112, v112, v128
  v_sub_f32 v114, v114, v128
  v_sub_f32 v116, v116, v128
  v_sub_f32 v118, v118, v128
  v_sub_f32 v120, v120, v128
  v_sub_f32 v122, v122, v128
  v_sub_f32 v124, v124, v128
  v_sub_f32 v126, v126, v128
  v_mul_f32 v130, v112, v112
  v_fmac_f32 v130, v114, v114
  v_fmac_f32 v130, v116, v116
  v_fmac_f32 v130, v118, v118
  v_fmac_f32 v130, v120, v120
  v_fmac_f32 v130, v122, v122
  v_fmac_f32 v130, v124, v124
  v_fmac_f32 v130, v126, v126
  v_fmamk_f32 v129, v130, 0x42000000, v129
  v_mov_b32 v130, v129
  s_nop 1
  v_permlane32_swap_b32 v130, v129
  v_add_f32 v129, v130, v129
  v_mov_b32 v130, 0x3727c5ac
  v_fmamk_f32 v129, v129, 0x3b000000, v130
  v_rsq_f32 v129, v129
  v_sub_f32 v130, 0, v128
  v_cvt_pk_bf16_f32 v133, v130, 0
  v_lshlrev_b32 v131, 16, v133
  v_sub_f32 v131, v130, v131
  v_cvt_pk_bf16_f32 v132, v130, v131
  v_mov_b32 v135, 0
  v_mov_b32 v134, 0
  s_lshl_b32 s16, s20, 7
  s_add_u32 s16, s16, 161792
  v_lshl_add_u32 v7, v2, 2, s16
  ds_write_b32 v7, v129
  v_lshl_add_u32 v7, v3, 4, s16
  ds_read_b128 v[112:115], v7 offset:0
  ds_read_b128 v[116:119], v7 offset:32
  ds_read_b128 v[120:123], v7 offset:64
  ds_read_b128 v[124:127], v7 offset:96
  s_mov_b32 s38, 0x3fb8aa3b
  v_mul_f32 v128, s38, v129
  s_mov_b32 s40, 0x358637bd
  s_mov_b32 s41, 0x358637bd
  s_waitcnt lgkmcnt(3)
  v_mul_f32 v144, s38, v112
  v_mul_f32 v145, s38, v113
  v_mul_f32 v146, s38, v114
  v_mul_f32 v147, s38, v115
  s_waitcnt lgkmcnt(2)
  v_mul_f32 v148, s38, v116
  v_mul_f32 v149, s38, v117
  v_mul_f32 v150, s38, v118
  v_mul_f32 v151, s38, v119
  s_waitcnt lgkmcnt(1)
  v_mul_f32 v152, s38, v120
  v_mul_f32 v153, s38, v121
  v_mul_f32 v154, s38, v122
  v_mul_f32 v155, s38, v123
  s_waitcnt lgkmcnt(0)
  v_mul_f32 v156, s38, v124
  v_mul_f32 v157, s38, v125
  v_mul_f32 v158, s38, v126
  v_mul_f32 v159, s38, v127
  ds_read_b128 v[88:91], v1 offset:0
  s_waitcnt lgkmcnt(0)
  v_mfma_f32_32x32x16_bf16 v[16:31], a[0:3], v[88:91], 0
  ds_read_b128 v[92:95], v1 offset:1024
  s_waitcnt lgkmcnt(0)
  v_mfma_f32_32x32x16_bf16 v[32:47], a[0:3], v[92:95], 0
  ds_read_b128 v[96:99], v1 offset:2048
  s_waitcnt lgkmcnt(0)
  v_mfma_f32_32x32x16_bf16 v[16:31], a[4:7], v[96:99], v[16:31]
  ds_read_b128 v[100:103], v1 offset:3072
  s_waitcnt lgkmcnt(0)
  v_mfma_f32_32x32x16_bf16 v[32:47], a[4:7], v[100:103], v[32:47]
  ds_read_b128 v[104:107], v1 offset:4096
  s_waitcnt lgkmcnt(0)
  v_mfma_f32_32x32x16_bf16 v[16:31], a[8:11], v[104:107], v[16:31]
  ds_read_b128 v[108:111], v1 offset:5120
  s_waitcnt lgkmcnt(0)
  v_mfma_f32_32x32x16_bf16 v[32:47], a[8:11], v[108:111], v[32:47]
  ds_read_b128 v[88:91], v1 offset:6144
  s_waitcnt lgkmcnt(0)
  v_mfma_f32_32x32x16_bf16 v[16:31], a[12:15], v[88:91], v[16:31]
  ds_read_b128 v[92:95], v1 offset:7168
  s_waitcnt lgkmcnt(0)
  v_mfma_f32_32x32x16_bf16 v[32:47], a[12:15], v[92:95], v[32:47]
  ds_read_b128 v[96:99], v1 offset:8192
  s_waitcnt vmcnt(27) lgkmcnt(0)
  v_mfma_f32_32x32x16_bf16 v[16:31], a[16:19], v[96:99], v[16:31]
  ds_read_b128 v[100:103], v1 offset:9216
  s_waitcnt lgkmcnt(0)
  v_mfma_f32_32x32x16_bf16 v[32:47], a[16:19], v[100:103], v[32:47]
  ds_read_b128 v[104:107], v1 offset:10240
  s_waitcnt vmcnt(26) lgkmcnt(0)
  v_mfma_f32_32x32x16_bf16 v[16:31], a[20:23], v[104:107], v[16:31]
  ds_read_b128 v[108:111], v1 offset:11264
  s_waitcnt lgkmcnt(0)
  v_mfma_f32_32x32x16_bf16 v[32:47], a[20:23], v[108:111], v[32:47]
  ds_read_b128 v[88:91], v1 offset:12288
  s_waitcnt vmcnt(25) lgkmcnt(0)
  v_mfma_f32_32x32x16_bf16 v[16:31], a[24:27], v[88:91], v[16:31]
  ds_read_b128 v[92:95], v1 offset:13312
  s_waitcnt lgkmcnt(0)
  v_mfma_f32_32x32x16_bf16 v[32:47], a[24:27], v[92:95], v[32:47]
  ds_read_b128 v[96:99], v1 offset:14336
  s_waitcnt vmcnt(24) lgkmcnt(0)
  v_mfma_f32_32x32x16_bf16 v[16:31], a[28:31], v[96:99], v[16:31]
  ds_read_b128 v[100:103], v1 offset:15360
  s_waitcnt lgkmcnt(0)
  v_mfma_f32_32x32x16_bf16 v[32:47], a[28:31], v[100:103], v[32:47]
  ds_read_b128 v[104:107], v1 offset:16384
  s_waitcnt vmcnt(23) lgkmcnt(0)
  v_mfma_f32_32x32x16_bf16 v[16:31], a[32:35], v[104:107], v[16:31]
  ds_read_b128 v[108:111], v1 offset:17408
  s_waitcnt lgkmcnt(0)
  v_mfma_f32_32x32x16_bf16 v[32:47], a[32:35], v[108:111], v[32:47]
  ds_read_b128 v[88:91], v1 offset:18432
  s_waitcnt vmcnt(22) lgkmcnt(0)
  v_mfma_f32_32x32x16_bf16 v[16:31], a[36:39], v[88:91], v[16:31]
  ds_read_b128 v[92:95], v1 offset:19456
  s_waitcnt lgkmcnt(0)
  v_mfma_f32_32x32x16_bf16 v[32:47], a[36:39], v[92:95], v[32:47]
  ds_read_b128 v[96:99], v1 offset:20480
  s_waitcnt vmcnt(21) lgkmcnt(0)
  v_mfma_f32_32x32x16_bf16 v[16:31], a[40:43], v[96:99], v[16:31]
  ds_read_b128 v[100:103], v1 offset:21504
  s_waitcnt lgkmcnt(0)
  v_mfma_f32_32x32x16_bf16 v[32:47], a[40:43], v[100:103], v[32:47]
  ds_read_b128 v[104:107], v1 offset:22528
  s_waitcnt vmcnt(20) lgkmcnt(0)
  v_mfma_f32_32x32x16_bf16 v[16:31], a[44:47], v[104:107], v[16:31]
  ds_read_b128 v[108:111], v1 offset:23552
  s_waitcnt lgkmcnt(0)
  v_mfma_f32_32x32x16_bf16 v[32:47], a[44:47], v[108:111], v[32:47]
  ds_read_b128 v[88:91], v1 offset:24576
  s_waitcnt vmcnt(19) lgkmcnt(0)
  v_mfma_f32_32x32x16_bf16 v[16:31], a[48:51], v[88:91], v[16:31]
  ds_read_b128 v[92:95], v1 offset:25600
  s_waitcnt lgkmcnt(0)
  v_mfma_f32_32x32x16_bf16 v[32:47], a[48:51], v[92:95], v[32:47]
  ds_read_b128 v[96:99], v1 offset:26624
  s_waitcnt vmcnt(18) lgkmcnt(0)
  v_mfma_f32_32x32x16_bf16 v[16:31], a[52:55], v[96:99], v[16:31]
  ds_read_b128 v[100:103], v1 offset:27648
  s_waitcnt lgkmcnt(0)
  v_mfma_f32_32x32x16_bf16 v[32:47], a[52:55], v[100:103], v[32:47]
  ds_read_b128 v[104:107], v1 offset:28672
  s_waitcnt vmcnt(17) lgkmcnt(0)
  v_mfma_f32_32x32x16_bf16 v[16:31], a[56:59], v[104:107], v[16:31]
  ds_read_b128 v[108:111], v1 offset:29696
  s_waitcnt lgkmcnt(0)
  v_mfma_f32_32x32x16_bf16 v[32:47], a[56:59], v[108:111], v[32:47]
  ds_read_b128 v[88:91], v1 offset:30720
  s_waitcnt vmcnt(16) lgkmcnt(0)
  v_mfma_f32_32x32x16_bf16 v[16:31], a[60:63], v[88:91], v[16:31]
  ds_read_b128 v[92:95], v1 offset:31744
  s_waitcnt lgkmcnt(0)
  v_mfma_f32_32x32x16_bf16 v[32:47], a[60:63], v[92:95], v[32:47]
  ds_read_b128 v[96:99], v1 offset:32768
  s_waitcnt vmcnt(15) lgkmcnt(0)
  v_mfma_f32_32x32x16_bf16 v[16:31], a[64:67], v[96:99], v[16:31]
  ds_read_b128 v[100:103], v1 offset:33792
  s_waitcnt lgkmcnt(0)
  v_mfma_f32_32x32x16_bf16 v[32:47], a[64:67], v[100:103], v[32:47]
  ds_read_b128 v[104:107], v1 offset:34816
  s_waitcnt vmcnt(14) lgkmcnt(0)
  v_mfma_f32_32x32x16_bf16 v[16:31], a[68:71], v[104:107], v[16:31]
  ds_read_b128 v[108:111], v1 offset:35840
  s_waitcnt lgkmcnt(0)
  v_mfma_f32_32x32x16_bf16 v[32:47], a[68:71], v[108:111], v[32:47]
  ds_read_b128 v[88:91], v1 offset:36864
  s_waitcnt vmcnt(13) lgkmcnt(0)
  v_mfma_f32_32x32x16_bf16 v[16:31], a[72:75], v[88:91], v[16:31]
  ds_read_b128 v[92:95], v1 offset:37888
  s_waitcnt lgkmcnt(0)
  v_mfma_f32_32x32x16_bf16 v[32:47], a[72:75], v[92:95], v[32:47]
  ds_read_b128 v[96:99], v1 offset:38912
  s_waitcnt vmcnt(12) lgkmcnt(0)
  v_mfma_f32_32x32x16_bf16 v[16:31], a[76:79], v[96:99], v[16:31]
  ds_read_b128 v[100:103], v1 offset:39936
  s_waitcnt lgkmcnt(0)
  v_mfma_f32_32x32x16_bf16 v[32:47], a[76:79], v[100:103], v[32:47]
  ds_read_b128 v[104:107], v1 offset:40960
  s_waitcnt vmcnt(11) lgkmcnt(0)
  v_mfma_f32_32x32x16_bf16 v[16:31], a[80:83], v[104:107], v[16:31]
  ds_read_b128 v[108:111], v1 offset:41984
  s_waitcnt lgkmcnt(0)
  v_mfma_f32_32x32x16_bf16 v[32:47], a[80:83], v[108:111], v[32:47]
  ds_read_b128 v[88:91], v1 offset:43008
  s_waitcnt vmcnt(10) lgkmcnt(0)
  v_mfma_f32_32x32x16_bf16 v[16:31], a[84:87], v[88:91], v[16:31]
  ds_read_b128 v[92:95], v1 offset:44032
  s_waitcnt lgkmcnt(0)
  v_mfma_f32_32x32x16_bf16 v[32:47], a[84:87], v[92:95], v[32:47]
  ds_read_b128 v[96:99], v1 offset:45056
  s_waitcnt vmcnt(9) lgkmcnt(0)
  v_mfma_f32_32x32x16_bf16 v[16:31], a[88:91], v[96:99], v[16:31]
  ds_read_b128 v[100:103], v1 offset:46080
  s_waitcnt lgkmcnt(0)
  v_mfma_f32_32x32x16_bf16 v[32:47], a[88:91], v[100:103], v[32:47]
  ds_read_b128 v[104:107], v1 offset:47104
  s_waitcnt vmcnt(8) lgkmcnt(0)
  v_mfma_f32_32x32x16_bf16 v[16:31], a[92:95], v[104:107], v[16:31]
  ds_read_b128 v[108:111], v1 offset:48128
  s_waitcnt lgkmcnt(0)
  v_mfma_f32_32x32x16_bf16 v[32:47], a[92:95], v[108:111], v[32:47]
  ds_read_b128 v[88:91], v1 offset:49152
  s_waitcnt vmcnt(7) lgkmcnt(0)
  v_mfma_f32_32x32x16_bf16 v[16:31], a[96:99], v[88:91], v[16:31]
  ds_read_b128 v[92:95], v1 offset:50176
  s_waitcnt lgkmcnt(0)
  v_mfma_f32_32x32x16_bf16 v[32:47], a[96:99], v[92:95], v[32:47]
  ds_read_b128 v[96:99], v1 offset:51200
  s_waitcnt vmcnt(6) lgkmcnt(0)
  v_mfma_f32_32x32x16_bf16 v[16:31], a[100:103], v[96:99], v[16:31]
  ds_read_b128 v[100:103], v1 offset:52224
  s_waitcnt lgkmcnt(0)
  v_mfma_f32_32x32x16_bf16 v[32:47], a[100:103], v[100:103], v[32:47]
  ds_read_b128 v[104:107], v1 offset:53248
  s_waitcnt vmcnt(5) lgkmcnt(0)
  v_mfma_f32_32x32x16_bf16 v[16:31], a[104:107], v[104:107], v[16:31]
  ds_read_b128 v[108:111], v1 offset:54272
  s_waitcnt lgkmcnt(0)
  v_mfma_f32_32x32x16_bf16 v[32:47], a[104:107], v[108:111], v[32:47]
  ds_read_b128 v[88:91], v1 offset:55296
  s_waitcnt vmcnt(4) lgkmcnt(0)
  v_mfma_f32_32x32x16_bf16 v[16:31], a[108:111], v[88:91], v[16:31]
  ds_read_b128 v[92:95], v1 offset:56320
  s_waitcnt lgkmcnt(0)
  v_mfma_f32_32x32x16_bf16 v[32:47], a[108:111], v[92:95], v[32:47]
  ds_read_b128 v[96:99], v1 offset:57344
  s_waitcnt vmcnt(3) lgkmcnt(0)
  v_mfma_f32_32x32x16_bf16 v[16:31], a[112:115], v[96:99], v[16:31]
  ds_read_b128 v[100:103], v1 offset:58368
  s_waitcnt lgkmcnt(0)
  v_mfma_f32_32x32x16_bf16 v[32:47], a[112:115], v[100:103], v[32:47]
  ds_read_b128 v[104:107], v1 offset:59392
  s_waitcnt vmcnt(2) lgkmcnt(0)
  v_mfma_f32_32x32x16_bf16 v[16:31], a[116:119], v[104:107], v[16:31]
  ds_read_b128 v[108:111], v1 offset:60416
  s_waitcnt lgkmcnt(0)
  v_mfma_f32_32x32x16_bf16 v[32:47], a[116:119], v[108:111], v[32:47]
  ds_read_b128 v[88:91], v1 offset:61440
  s_waitcnt vmcnt(1) lgkmcnt(0)
  v_mfma_f32_32x32x16_bf16 v[16:31], a[120:123], v[88:91], v[16:31]
  ds_read_b128 v[92:95], v1 offset:62464
  s_waitcnt lgkmcnt(0)
  v_mfma_f32_32x32x16_bf16 v[32:47], a[120:123], v[92:95], v[32:47]
  ds_read_b128 v[96:99], v1 offset:63488
  s_waitcnt vmcnt(0) lgkmcnt(0)
  v_mfma_f32_32x32x16_bf16 v[16:31], a[124:127], v[96:99], v[16:31]
  ds_read_b128 v[100:103], v1 offset:64512
  s_waitcnt lgkmcnt(0)
  v_mfma_f32_32x32x16_bf16 v[32:47], a[124:127], v[100:103], v[32:47]
  ds_read_b128 v[104:107], v6 offset:16384
  s_waitcnt lgkmcnt(0)
  v_mfma_f32_32x32x16_bf16 v[16:31], v[132:135], v[104:107], v[16:31]
  ds_read_b128 v[108:111], v6 offset:17408
  s_waitcnt lgkmcnt(0)
  v_mfma_f32_32x32x16_bf16 v[32:47], v[132:135], v[108:111], v[32:47]
  s_branch L_fast_epi
L_fast_k3redo:
  s_add_u32 s16, s50, 8
  s_mov_b32 s58, 0
poll_44:
  buffer_load_dword v14, v138, s[8:11], s42 offen sc1
  s_waitcnt vmcnt(0)
  v_cmp_gt_u32 vcc, s16, v14
  s_add_u32 s58, s58, 1
  s_cmp_gt_u32 s58, 0x200000
  s_cbranch_scc1 poll_44_x
  s_cbranch_vccnz poll_44
poll_44_x:
  s_sub_u32 s34, s34, 32768
  s_mul_i32 s16, s22, 229376
  s_add_u32 s16, s16, 2097152
  buffer_load_dwordx4 a[0:3], v1, s[8:11], s34 offen offset:0 sc1
  buffer_load_dwordx4 a[4:7], v1, s[8:11], s34 offen offset:1024 sc1
  buffer_load_dwordx4 a[8:11], v1, s[8:11], s34 offen offset:2048 sc1
  buffer_load_dwordx4 a[12:15], v1, s[8:11], s34 offen offset:3072 sc1
  s_add_u32 s34, s34, 4096
  buffer_load_dwordx4 a[16:19], v1, s[8:11], s34 offen offset:0 sc1
  buffer_load_dwordx4 a[20:23], v1, s[8:11], s34 offen offset:1024 sc1
  buffer_load_dwordx4 a[24:27], v1, s[8:11], s34 offen offset:2048 sc1
  buffer_load_dwordx4 a[28:31], v1, s[8:11], s34 offen offset:3072 sc1
  s_add_u32 s34, s34, 4096
  buffer_load_dwordx4 a[32:35], v1, s[8:11], s34 offen offset:0 sc1
  buffer_load_dwordx4 a[36:39], v1, s[8:11], s34 offen offset:1024 sc1
  buffer_load_dwordx4 a[40:43], v1, s[8:11], s34 offen offset:2048 sc1
  buffer_load_dwordx4 a[44:47], v1, s[8:11], s34 offen offset:3072 sc1
  s_add_u32 s34, s34, 4096
  buffer_load_dwordx4 a[48:51], v1, s[8:11], s34 offen offset:0 sc1
  buffer_load_dwordx4 a[52:55], v1, s[8:11], s34 offen offset:1024 sc1
  buffer_load_dwordx4 a[56:59], v1, s[8:11], s34 offen offset:2048 sc1
  buffer_load_dwordx4 a[60:63], v1, s[8:11], s34 offen offset:3072 sc1
  s_add_u32 s34, s34, 4096
  buffer_load_dwordx4 a[64:67], v1, s[8:11], s34 offen offset:0 sc1
  buffer_load_dwordx4 a[68:71], v1, s[8:11], s34 offen offset:1024 sc1
  buffer_load_dwordx4 a[72:75], v1, s[8:11], s34 offen offset:2048 sc1
  buffer_load_dwordx4 a[76:79], v1, s[8:11], s34 offen offset:3072 sc1
  s_add_u32 s34, s34, 4096
  buffer_load_dwordx4 a[80:83], v1, s[8:11], s34 offen offset:0 sc1
  buffer_load_dwordx4 a[84:87], v1, s[8:11], s34 offen offset:1024 sc1
  buffer_load_dwordx4 a[88:91], v1, s[8:11], s34 offen offset:2048 sc1
  buffer_load_dwordx4 a[92:95], v1, s[8:11], s34 offen offset:3072 sc1
  s_add_u32 s34, s34, 4096
  buffer_load_dwordx4 a[96:99], v1, s[8:11], s34 offen offset:0 sc1
  buffer_load_dwordx4 a[100:103], v1, s[8:11], s34 offen offset:1024 sc1
  buffer_load_dwordx4 a[104:107], v1, s[8:11], s34 offen offset:2048 sc1
  buffer_load_dwordx4 a[108:111], v1, s[8:11], s34 offen offset:3072 sc1
  s_add_u32 s34, s34, 4096
  buffer_load_dwordx4 a[112:115], v1, s[8:11], s34 offen offset:0 sc1
  buffer_load_dwordx4 a[116:119], v1, s[8:11], s34 offen offset:1024 sc1
  buffer_load_dwordx4 a[120:123], v1, s[8:11], s34 offen offset:2048 sc1
  buffer_load_dwordx4 a[124:127], v1, s[8:11], s34 offen offset:3072 sc1
  s_add_u32 s34, s34, 4096
  buffer_load_dwordx2 v[120:121], v4, s[8:11], s35 offen offset:0 sc1
  buffer_load_dwordx2 v[122:123], v4, s[8:11], s35 offen offset:256 sc1
  buffer_load_dwordx2 v[124:125], v4, s[8:11], s35 offen offset:512 sc1
  buffer_load_dwordx2 v[126:127], v4, s[8:11], s35 offen offset:768 sc1
  buffer_load_dwordx2 v[128:129], v4, s[8:11], s35 offen offset:1024 sc1
  buffer_load_dwordx2 v[130:131], v4, s[8:11], s35 offen offset:1280 sc1
  buffer_load_dwordx2 v[132:133], v4, s[8:11], s35 offen offset:1536 sc1
  buffer_load_dwordx2 v[134:135], v4, s[8:11], s35 offen offset:1792 sc1
  s_waitcnt vmcnt(6)
  v_add_f32 v136, v120, v122
  v_add_f32 v137, v121, v123
  s_waitcnt vmcnt(5)
  v_add_f32 v136, v136, v124
  v_add_f32 v137, v137, v125
  s_waitcnt vmcnt(4)
  v_add_f32 v136, v136, v126
  v_add_f32 v137, v137, v127
  s_waitcnt vmcnt(3)
  v_add_f32 v136, v136, v128
  v_add_f32 v137, v137, v129
  s_waitcnt vmcnt(2)
  v_add_f32 v136, v136, v130
  v_add_f32 v137, v137, v131
  s_waitcnt vmcnt(1)
  v_add_f32 v136, v136, v132
  v_add_f32 v137, v137, v133
  s_waitcnt vmcnt(0)
  v_add_f32 v136, v136, v134
  v_add_f32 v137, v137, v135
  v_mov_b32 v156, v136
  s_nop 1
  v_permlane32_swap_b32 v156, v136
  v_add_f32 v136, v156, v136
  v_mul_f32 v136, 0x3d800000, v136
  v_sub_f32 v120, v120, v136
  v_sub_f32 v122, v122, v136
  v_sub_f32 v124, v124, v136
  v_sub_f32 v126, v126, v136
  v_sub_f32 v128, v128, v136
  v_sub_f32 v130, v130, v136
  v_sub_f32 v132, v132, v136
  v_sub_f32 v134, v134, v136
  v_mul_f32 v156, v120, v120
  v_fmac_f32 v156, v122, v122
  v_fmac_f32 v156, v124, v124
  v_fmac_f32 v156, v126, v126
  v_fmac_f32 v156, v128, v128
  v_fmac_f32 v156, v130, v130
  v_fmac_f32 v156, v132, v132
  v_fmac_f32 v156, v134, v134
  v_fmamk_f32 v137, v156, 0x42000000, v137
  v_mov_b32 v156, v137
  s_nop 1
  v_permlane32_swap_b32 v156, v137
  v_add_f32 v137, v156, v137
  v_mov_b32 v156, 0x3727c5ac
  v_fmamk_f32 v137, v137, 0x3b000000, v156
  v_rsq_f32 v137, v137
  v_sub_f32 v156, 0, v136
  v_cvt_pk_bf16_f32 v141, v156, 0
  v_lshlrev_b32 v157, 16, v141
  v_sub_f32 v157, v156, v157
  v_cvt_pk_bf16_f32 v140, v156, v157
  v_mov_b32 v143, 0
  v_mov_b32 v142, 0
  v_mul_f32 v136, 0xbfb8aa3b, v137
  v_rcp_f32 v137, v137
  buffer_load_dwordx4 v[88:91], v1, s[8:11], s16 offen offset:0 sc1
  s_waitcnt vmcnt(0)
  v_mfma_f32_32x32x16_bf16 v[16:31], v[88:91], a[0:3], 0
  buffer_load_dwordx4 v[92:95], v1, s[8:11], s16 offen offset:1024 sc1
  s_waitcnt vmcnt(0)
  v_mfma_f32_32x32x16_bf16 v[32:47], v[92:95], a[0:3], 0
  buffer_load_dwordx4 v[96:99], v1, s[8:11], s16 offen offset:2048 sc1
  s_waitcnt vmcnt(0)
  v_mfma_f32_32x32x16_bf16 v[48:63], v[96:99], a[0:3], 0
  buffer_load_dwordx4 v[100:103], v1, s[8:11], s16 offen offset:3072 sc1
  s_add_u32 s16, s16, 4096
  s_waitcnt vmcnt(0)
  v_mfma_f32_32x32x16_bf16 v[16:31], v[100:103], a[4:7], v[16:31]
  s_waitcnt lgkmcnt(2)
  buffer_load_dwordx4 v[104:107], v1, s[8:11], s16 offen offset:0 sc1
  s_waitcnt vmcnt(0)
  v_mfma_f32_32x32x16_bf16 v[32:47], v[104:107], a[4:7], v[32:47]
  s_waitcnt lgkmcnt(1)
  buffer_load_dwordx4 v[108:111], v1, s[8:11], s16 offen offset:1024 sc1
  s_waitcnt vmcnt(0)
  v_mfma_f32_32x32x16_bf16 v[48:63], v[108:111], a[4:7], v[48:63]
  s_waitcnt lgkmcnt(0)
  buffer_load_dwordx4 v[112:115], v1, s[8:11], s16 offen offset:2048 sc1
  s_waitcnt vmcnt(0)
  v_mfma_f32_32x32x16_bf16 v[16:31], v[112:115], a[8:11], v[16:31]
  buffer_load_dwordx4 v[116:119], v1, s[8:11], s16 offen offset:3072 sc1
  s_add_u32 s16, s16, 4096
  s_waitcnt vmcnt(0)
  v_mfma_f32_32x32x16_bf16 v[32:47], v[116:119], a[8:11], v[32:47]
  buffer_load_dwordx4 v[88:91], v1, s[8:11], s16 offen offset:0 sc1
  s_waitcnt vmcnt(0)
  v_mfma_f32_32x32x16_bf16 v[48:63], v[88:91], a[8:11], v[48:63]
  buffer_load_dwordx4 v[92:95], v1, s[8:11], s16 offen offset:1024 sc1
  s_waitcnt vmcnt(0)
  v_mfma_f32_32x32x16_bf16 v[16:31], v[92:95], a[12:15], v[16:31]
  buffer_load_dwordx4 v[96:99], v1, s[8:11], s16 offen offset:2048 sc1
  s_waitcnt vmcnt(0)
  v_mfma_f32_32x32x16_bf16 v[32:47], v[96:99], a[12:15], v[32:47]
  buffer_load_dwordx4 v[100:103], v1, s[8:11], s16 offen offset:3072 sc1
  s_add_u32 s16, s16, 4096
  s_waitcnt vmcnt(0)
  v_mfma_f32_32x32x16_bf16 v[48:63], v[100:103], a[12:15], v[48:63]
  buffer_load_dwordx4 v[104:107], v1, s[8:11], s16 offen offset:0 sc1
  s_waitcnt vmcnt(0)
  v_mfma_f32_32x32x16_bf16 v[16:31], v[104:107], a[16:19], v[16:31]
  buffer_load_dwordx4 v[108:111], v1, s[8:11], s16 offen offset:1024 sc1
  s_waitcnt vmcnt(0)
  v_mfma_f32_32x32x16_bf16 v[32:47], v[108:111], a[16:19], v[32:47]
  buffer_load_dwordx4 v[112:115], v1, s[8:11], s16 offen offset:2048 sc1
  s_waitcnt vmcnt(0)
  v_mfma_f32_32x32x16_bf16 v[48:63], v[112:115], a[16:19], v[48:63]
  buffer_load_dwordx4 v[116:119], v1, s[8:11], s16 offen offset:3072 sc1
  s_add_u32 s16, s16, 4096
  s_waitcnt vmcnt(0)
  v_mfma_f32_32x32x16_bf16 v[16:31], v[116:119], a[20:23], v[16:31]
  buffer_load_dwordx4 v[88:91], v1, s[8:11], s16 offen offset:0 sc1
  s_waitcnt vmcnt(0)
  v_mfma_f32_32x32x16_bf16 v[32:47], v[88:91], a[20:23], v[32:47]
  buffer_load_dwordx4 v[92:95], v1, s[8:11], s16 offen offset:1024 sc1
  s_waitcnt vmcnt(0)
  v_mfma_f32_32x32x16_bf16 v[48:63], v[92:95], a[20:23], v[48:63]
  buffer_load_dwordx4 v[96:99], v1, s[8:11], s16 offen offset:2048 sc1
  s_waitcnt vmcnt(0)
  v_mfma_f32_32x32x16_bf16 v[16:31], v[96:99], a[24:27], v[16:31]
  buffer_load_dwordx4 v[100:103], v1, s[8:11], s16 offen offset:3072 sc1
  s_add_u32 s16, s16, 4096
  s_waitcnt vmcnt(0)
  v_mfma_f32_32x32x16_bf16 v[32:47], v[100:103], a[24:27], v[32:47]
  buffer_load_dwordx4 v[104:107], v1, s[8:11], s16 offen offset:0 sc1
  s_waitcnt vmcnt(0)
  v_mfma_f32_32x32x16_bf16 v[48:63], v[104:107], a[24:27], v[48:63]
  buffer_load_dwordx4 v[108:111], v1, s[8:11], s16 offen offset:1024 sc1
  s_waitcnt vmcnt(0)
  v_mfma_f32_32x32x16_bf16 v[16:31], v[108:111], a[28:31], v[16:31]
  buffer_load_dwordx4 v[112:115], v1, s[8:11], s16 offen offset:2048 sc1
  s_waitcnt vmcnt(0)
  v_mfma_f32_32x32x16_bf16 v[32:47], v[112:115], a[28:31], v[32:47]
  buffer_load_dwordx4 v[116:119], v1, s[8:11], s16 offen offset:3072 sc1
  s_add_u32 s16, s16, 4096
  s_waitcnt vmcnt(0)
  v_mfma_f32_32x32x16_bf16 v[48:63], v[116:119], a[28:31], v[48:63]
  buffer_load_dwordx4 v[88:91], v1, s[8:11], s16 offen offset:0 sc1
  s_waitcnt vmcnt(0)
  v_mfma_f32_32x32x16_bf16 v[16:31], v[88:91], a[32:35], v[16:31]
  buffer_load_dwordx4 v[92:95], v1, s[8:11], s16 offen offset:1024 sc1
  s_waitcnt vmcnt(0)
  v_mfma_f32_32x32x16_bf16 v[32:47], v[92:95], a[32:35], v[32:47]
  buffer_load_dwordx4 v[96:99], v1, s[8:11], s16 offen offset:2048 sc1
  s_waitcnt vmcnt(0)
  v_mfma_f32_32x32x16_bf16 v[48:63], v[96:99], a[32:35], v[48:63]
  buffer_load_dwordx4 v[100:103], v1, s[8:11], s16 offen offset:3072 sc1
  s_add_u32 s16, s16, 4096
  s_waitcnt vmcnt(0)
  v_mfma_f32_32x32x16_bf16 v[16:31], v[100:103], a[36:39], v[16:31]
  buffer_load_dwordx4 v[104:107], v1, s[8:11], s16 offen offset:0 sc1
  s_waitcnt vmcnt(0)
  v_mfma_f32_32x32x16_bf16 v[32:47], v[104:107], a[36:39], v[32:47]
  buffer_load_dwordx4 v[108:111], v1, s[8:11], s16 offen offset:1024 sc1
  s_waitcnt vmcnt(0)
  v_mfma_f32_32x32x16_bf16 v[48:63], v[108:111], a[36:39], v[48:63]
  buffer_load_dwordx4 v[112:115], v1, s[8:11], s16 offen offset:2048 sc1
  s_waitcnt vmcnt(0)
  v_mfma_f32_32x32x16_bf16 v[16:31], v[112:115], a[40:43], v[16:31]
  buffer_load_dwordx4 v[116:119], v1, s[8:11], s16 offen offset:3072 sc1
  s_add_u32 s16, s16, 4096
  s_waitcnt vmcnt(0)
  v_mfma_f32_32x32x16_bf16 v[32:47], v[116:119], a[40:43], v[32:47]
  buffer_load_dwordx4 v[88:91], v1, s[8:11], s16 offen offset:0 sc1
  s_waitcnt vmcnt(0)
  v_mfma_f32_32x32x16_bf16 v[48:63], v[88:91], a[40:43], v[48:63]
  buffer_load_dwordx4 v[92:95], v1, s[8:11], s16 offen offset:1024 sc1
  s_waitcnt vmcnt(0)
  v_mfma_f32_32x32x16_bf16 v[16:31], v[92:95], a[44:47], v[16:31]
  buffer_load_dwordx4 v[96:99], v1, s[8:11], s16 offen offset:2048 sc1
  s_waitcnt vmcnt(0)
  v_mfma_f32_32x32x16_bf16 v[32:47], v[96:99], a[44:47], v[32:47]
  buffer_load_dwordx4 v[100:103], v1, s[8:11], s16 offen offset:3072 sc1
  s_add_u32 s16, s16, 4096
  s_waitcnt vmcnt(0)
  v_mfma_f32_32x32x16_bf16 v[48:63], v[100:103], a[44:47], v[48:63]
  buffer_load_dwordx4 v[104:107], v1, s[8:11], s16 offen offset:0 sc1
  s_waitcnt vmcnt(0)
  v_mfma_f32_32x32x16_bf16 v[16:31], v[104:107], a[48:51], v[16:31]
  buffer_load_dwordx4 v[108:111], v1, s[8:11], s16 offen offset:1024 sc1
  s_waitcnt vmcnt(0)
  v_mfma_f32_32x32x16_bf16 v[32:47], v[108:111], a[48:51], v[32:47]
  buffer_load_dwordx4 v[112:115], v1, s[8:11], s16 offen offset:2048 sc1
  s_waitcnt vmcnt(0)
  v_mfma_f32_32x32x16_bf16 v[48:63], v[112:115], a[48:51], v[48:63]
  buffer_load_dwordx4 v[116:119], v1, s[8:11], s16 offen offset:3072 sc1
  s_add_u32 s16, s16, 4096
  s_waitcnt vmcnt(0)
  v_mfma_f32_32x32x16_bf16 v[16:31], v[116:119], a[52:55], v[16:31]
  buffer_load_dwordx4 v[88:91], v1, s[8:11], s16 offen offset:0 sc1
  s_waitcnt vmcnt(0)
  v_mfma_f32_32x32x16_bf16 v[32:47], v[88:91], a[52:55], v[32:47]
  buffer_load_dwordx4 v[92:95], v1, s[8:11], s16 offen offset:1024 sc1
  s_waitcnt vmcnt(0)
  v_mfma_f32_32x32x16_bf16 v[48:63], v[92:95], a[52:55], v[48:63]
  buffer_load_dwordx4 v[96:99], v1, s[8:11], s16 offen offset:2048 sc1
  s_waitcnt vmcnt(0)
  v_mfma_f32_32x32x16_bf16 v[16:31], v[96:99], a[56:59], v[16:31]
  buffer_load_dwordx4 v[100:103], v1, s[8:11], s16 offen offset:3072 sc1
  s_add_u32 s16, s16, 4096
  s_waitcnt vmcnt(0)
  v_mfma_f32_32x32x16_bf16 v[32:47], v[100:103], a[56:59], v[32:47]
  buffer_load_dwordx4 v[104:107], v1, s[8:11], s16 offen offset:0 sc1
  s_waitcnt vmcnt(0)
  v_mfma_f32_32x32x16_bf16 v[48:63], v[104:107], a[56:59], v[48:63]
  buffer_load_dwordx4 v[108:111], v1, s[8:11], s16 offen offset:1024 sc1
  s_waitcnt vmcnt(0)
  v_mfma_f32_32x32x16_bf16 v[16:31], v[108:111], a[60:63], v[16:31]
  buffer_load_dwordx4 v[112:115], v1, s[8:11], s16 offen offset:2048 sc1
  s_waitcnt vmcnt(0)
  v_mfma_f32_32x32x16_bf16 v[32:47], v[112:115], a[60:63], v[32:47]
  buffer_load_dwordx4 v[116:119], v1, s[8:11], s16 offen offset:3072 sc1
  s_add_u32 s16, s16, 4096
  s_waitcnt vmcnt(0)
  v_mfma_f32_32x32x16_bf16 v[48:63], v[116:119], a[60:63], v[48:63]
  buffer_load_dwordx4 v[88:91], v1, s[8:11], s16 offen offset:0 sc1
  s_waitcnt vmcnt(0)
  v_mfma_f32_32x32x16_bf16 v[16:31], v[88:91], a[64:67], v[16:31]
  buffer_load_dwordx4 v[92:95], v1, s[8:11], s16 offen offset:1024 sc1
  s_waitcnt vmcnt(0)
  v_mfma_f32_32x32x16_bf16 v[32:47], v[92:95], a[64:67], v[32:47]
  buffer_load_dwordx4 v[96:99], v1, s[8:11], s16 offen offset:2048 sc1
  s_waitcnt vmcnt(0)
  v_mfma_f32_32x32x16_bf16 v[48:63], v[96:99], a[64:67], v[48:63]
  buffer_load_dwordx4 v[100:103], v1, s[8:11], s16 offen offset:3072 sc1
  s_add_u32 s16, s16, 4096
  s_waitcnt vmcnt(0)
  v_mfma_f32_32x32x16_bf16 v[16:31], v[100:103], a[68:71], v[16:31]
  buffer_load_dwordx4 v[104:107], v1, s[8:11], s16 offen offset:0 sc1
  s_waitcnt vmcnt(0)
  v_mfma_f32_32x32x16_bf16 v[32:47], v[104:107], a[68:71], v[32:47]
  buffer_load_dwordx4 v[108:111], v1, s[8:11], s16 offen offset:1024 sc1
  s_waitcnt vmcnt(0)
  v_mfma_f32_32x32x16_bf16 v[48:63], v[108:111], a[68:71], v[48:63]
  buffer_load_dwordx4 v[112:115], v1, s[8:11], s16 offen offset:2048 sc1
  s_waitcnt vmcnt(0)
  v_mfma_f32_32x32x16_bf16 v[16:31], v[112:115], a[72:75], v[16:31]
  buffer_load_dwordx4 v[116:119], v1, s[8:11], s16 offen offset:3072 sc1
  s_add_u32 s16, s16, 4096
  s_waitcnt vmcnt(0)
  v_mfma_f32_32x32x16_bf16 v[32:47], v[116:119], a[72:75], v[32:47]
  buffer_load_dwordx4 v[88:91], v1, s[8:11], s16 offen offset:0 sc1
  s_waitcnt vmcnt(0)
  v_mfma_f32_32x32x16_bf16 v[48:63], v[88:91], a[72:75], v[48:63]
  buffer_load_dwordx4 v[92:95], v1, s[8:11], s16 offen offset:1024 sc1
  s_waitcnt vmcnt(0)
  v_mfma_f32_32x32x16_bf16 v[16:31], v[92:95], a[76:79], v[16:31]
  buffer_load_dwordx4 v[96:99], v1, s[8:11], s16 offen offset:2048 sc1
  s_waitcnt vmcnt(0)
  v_mfma_f32_32x32x16_bf16 v[32:47], v[96:99], a[76:79], v[32:47]
  buffer_load_dwordx4 v[100:103], v1, s[8:11], s16 offen offset:3072 sc1
  s_add_u32 s16, s16, 4096
  s_waitcnt vmcnt(0)
  v_mfma_f32_32x32x16_bf16 v[48:63], v[100:103], a[76:79], v[48:63]
  buffer_load_dwordx4 v[104:107], v1, s[8:11], s16 offen offset:0 sc1
  s_waitcnt vmcnt(0)
  v_mfma_f32_32x32x16_bf16 v[16:31], v[104:107], a[80:83], v[16:31]
  buffer_load_dwordx4 v[108:111], v1, s[8:11], s16 offen offset:1024 sc1
  s_waitcnt vmcnt(0)
  v_mfma_f32_32x32x16_bf16 v[32:47], v[108:111], a[80:83], v[32:47]
  buffer_load_dwordx4 v[112:115], v1, s[8:11], s16 offen offset:2048 sc1
  s_waitcnt vmcnt(0)
  v_mfma_f32_32x32x16_bf16 v[48:63], v[112:115], a[80:83], v[48:63]
  buffer_load_dwordx4 v[116:119], v1, s[8:11], s16 offen offset:3072 sc1
  s_add_u32 s16, s16, 4096
  s_waitcnt vmcnt(0)
  v_mfma_f32_32x32x16_bf16 v[16:31], v[116:119], a[84:87], v[16:31]
  buffer_load_dwordx4 v[88:91], v1, s[8:11], s16 offen offset:0 sc1
  s_waitcnt vmcnt(0)
  v_mfma_f32_32x32x16_bf16 v[32:47], v[88:91], a[84:87], v[32:47]
  buffer_load_dwordx4 v[92:95], v1, s[8:11], s16 offen offset:1024 sc1
  s_waitcnt vmcnt(0)
  v_mfma_f32_32x32x16_bf16 v[48:63], v[92:95], a[84:87], v[48:63]
  buffer_load_dwordx4 v[96:99], v1, s[8:11], s16 offen offset:2048 sc1
  s_waitcnt vmcnt(0)
  v_mfma_f32_32x32x16_bf16 v[16:31], v[96:99], a[88:91], v[16:31]
  buffer_load_dwordx4 v[100:103], v1, s[8:11], s16 offen offset:3072 sc1
  s_add_u32 s16, s16, 4096
  s_waitcnt vmcnt(0)
  v_mfma_f32_32x32x16_bf16 v[32:47], v[100:103], a[88:91], v[32:47]
  buffer_load_dwordx4 v[104:107], v1, s[8:11], s16 offen offset:0 sc1
  s_waitcnt vmcnt(0)
  v_mfma_f32_32x32x16_bf16 v[48:63], v[104:107], a[88:91], v[48:63]
  buffer_load_dwordx4 v[108:111], v1, s[8:11], s16 offen offset:1024 sc1
  s_waitcnt vmcnt(0)
  v_mfma_f32_32x32x16_bf16 v[16:31], v[108:111], a[92:95], v[16:31]
  buffer_load_dwordx4 v[112:115], v1, s[8:11], s16 offen offset:2048 sc1
  s_waitcnt vmcnt(0)
  v_mfma_f32_32x32x16_bf16 v[32:47], v[112:115], a[92:95], v[32:47]
  buffer_load_dwordx4 v[116:119], v1, s[8:11], s16 offen offset:3072 sc1
  s_add_u32 s16, s16, 4096
  s_waitcnt vmcnt(0)
  v_mfma_f32_32x32x16_bf16 v[48:63], v[116:119], a[92:95], v[48:63]
  buffer_load_dwordx4 v[88:91], v1, s[8:11], s16 offen offset:0 sc1
  s_waitcnt vmcnt(0)
  v_mfma_f32_32x32x16_bf16 v[16:31], v[88:91], a[96:99], v[16:31]
  buffer_load_dwordx4 v[92:95], v1, s[8:11], s16 offen offset:1024 sc1
  s_waitcnt vmcnt(0)
  v_mfma_f32_32x32x16_bf16 v[32:47], v[92:95], a[96:99], v[32:47]
  buffer_load_dwordx4 v[96:99], v1, s[8:11], s16 offen offset:2048 sc1
  s_waitcnt vmcnt(0)
  v_mfma_f32_32x32x16_bf16 v[48:63], v[96:99], a[96:99], v[48:63]
  buffer_load_dwordx4 v[100:103], v1, s[8:11], s16 offen offset:3072 sc1
  s_add_u32 s16, s16, 4096
  s_waitcnt vmcnt(0)
  v_mfma_f32_32x32x16_bf16 v[16:31], v[100:103], a[100:103], v[16:31]
  buffer_load_dwordx4 v[104:107], v1, s[8:11], s16 offen offset:0 sc1
  s_waitcnt vmcnt(0)
  v_mfma_f32_32x32x16_bf16 v[32:47], v[104:107], a[100:103], v[32:47]
  buffer_load_dwordx4 v[108:111], v1, s[8:11], s16 offen offset:1024 sc1
  s_waitcnt vmcnt(0)
  v_mfma_f32_32x32x16_bf16 v[48:63], v[108:111], a[100:103], v[48:63]
  buffer_load_dwordx4 v[112:115], v1, s[8:11], s16 offen offset:2048 sc1
  s_waitcnt vmcnt(0)
  v_mfma_f32_32x32x16_bf16 v[16:31], v[112:115], a[104:107], v[16:31]
  buffer_load_dwordx4 v[116:119], v1, s[8:11], s16 offen offset:3072 sc1
  s_add_u32 s16, s16, 4096
  s_waitcnt vmcnt(0)
  v_mfma_f32_32x32x16_bf16 v[32:47], v[116:119], a[104:107], v[32:47]
  buffer_load_dwordx4 v[88:91], v1, s[8:11], s16 offen offset:0 sc1
  s_waitcnt vmcnt(0)
  v_mfma_f32_32x32x16_bf16 v[48:63], v[88:91], a[104:107], v[48:63]
  buffer_load_dwordx4 v[92:95], v1, s[8:11], s16 offen offset:1024 sc1
  s_waitcnt vmcnt(0)
  v_mfma_f32_32x32x16_bf16 v[16:31], v[92:95], a[108:111], v[16:31]
  buffer_load_dwordx4 v[96:99], v1, s[8:11], s16 offen offset:2048 sc1
  s_waitcnt vmcnt(0)
  v_mfma_f32_32x32x16_bf16 v[32:47], v[96:99], a[108:111], v[32:47]
  buffer_load_dwordx4 v[100:103], v1, s[8:11], s16 offen offset:3072 sc1
  s_add_u32 s16, s16, 4096
  s_waitcnt vmcnt(0)
  v_mfma_f32_32x32x16_bf16 v[48:63], v[100:103], a[108:111], v[48:63]
  buffer_load_dwordx4 v[104:107], v1, s[8:11], s16 offen offset:0 sc1
  s_waitcnt vmcnt(0)
  v_mfma_f32_32x32x16_bf16 v[16:31], v[104:107], a[112:115], v[16:31]
  buffer_load_dwordx4 v[108:111], v1, s[8:11], s16 offen offset:1024 sc1
  s_waitcnt vmcnt(0)
  v_mfma_f32_32x32x16_bf16 v[32:47], v[108:111], a[112:115], v[32:47]
  buffer_load_dwordx4 v[112:115], v1, s[8:11], s16 offen offset:2048 sc1
  s_waitcnt vmcnt(0)
  v_mfma_f32_32x32x16_bf16 v[48:63], v[112:115], a[112:115], v[48:63]
  buffer_load_dwordx4 v[116:119], v1, s[8:11], s16 offen offset:3072 sc1
  s_add_u32 s16, s16, 4096
  s_waitcnt vmcnt(0)
  v_mfma_f32_32x32x16_bf16 v[16:31], v[116:119], a[116:119], v[16:31]
  buffer_load_dwordx4 v[88:91], v1, s[8:11], s16 offen offset:0 sc1
  s_waitcnt vmcnt(0)
  v_mfma_f32_32x32x16_bf16 v[32:47], v[88:91], a[116:119], v[32:47]
  buffer_load_dwordx4 v[92:95], v1, s[8:11], s16 offen offset:1024 sc1
  s_waitcnt vmcnt(0)
  v_mfma_f32_32x32x16_bf16 v[48:63], v[92:95], a[116:119], v[48:63]
  buffer_load_dwordx4 v[96:99], v1, s[8:11], s16 offen offset:2048 sc1
  s_waitcnt vmcnt(0)
  v_mfma_f32_32x32x16_bf16 v[16:31], v[96:99], a[120:123], v[16:31]
  buffer_load_dwordx4 v[100:103], v1, s[8:11], s16 offen offset:3072 sc1
  s_add_u32 s16, s16, 4096
  s_waitcnt vmcnt(0)
  v_mfma_f32_32x32x16_bf16 v[32:47], v[100:103], a[120:123], v[32:47]
  buffer_load_dwordx4 v[104:107], v1, s[8:11], s16 offen offset:0 sc1
  s_waitcnt vmcnt(0)
  v_mfma_f32_32x32x16_bf16 v[48:63], v[104:107], a[120:123], v[48:63]
  buffer_load_dwordx4 v[108:111], v1, s[8:11], s16 offen offset:1024 sc1
  s_waitcnt vmcnt(0)
  v_mfma_f32_32x32x16_bf16 v[16:31], v[108:111], a[124:127], v[16:31]
  buffer_load_dwordx4 v[112:115], v1, s[8:11], s16 offen offset:2048 sc1
  s_waitcnt vmcnt(0)
  v_mfma_f32_32x32x16_bf16 v[32:47], v[112:115], a[124:127], v[32:47]
  buffer_load_dwordx4 v[116:119], v1, s[8:11], s16 offen offset:3072 sc1
  s_add_u32 s16, s16, 4096
  s_waitcnt vmcnt(0)
  v_mfma_f32_32x32x16_bf16 v[48:63], v[116:119], a[124:127], v[48:63]
  ds_read_b128 v[88:91], v6 offset:19456
  s_waitcnt lgkmcnt(0)
  v_mfma_f32_32x32x16_bf16 v[16:31], v[88:91], v[140:143], v[16:31]
  ds_read_b128 v[92:95], v6 offset:20480
  s_waitcnt lgkmcnt(0)
  v_mfma_f32_32x32x16_bf16 v[32:47], v[92:95], v[140:143], v[32:47]
  ds_read_b128 v[96:99], v6 offset:21504
  s_waitcnt lgkmcnt(0)
  v_mfma_f32_32x32x16_bf16 v[48:63], v[96:99], v[140:143], v[48:63]
  ds_read_b128 v[100:103], v5 offset:32768
  ds_read_b128 v[104:107], v5 offset:33792
  ds_read_b128 v[108:111], v5 offset:34816
  ds_read_b128 v[112:115], v5 offset:35840
  s_branch L_fast_k3ok
L_safe:
  s_mov_b32 s97, 0
  s_waitcnt vmcnt(9) lgkmcnt(2)
  v_mfma_f32_32x32x16_bf16 v[16:31], a[0:3], v[88:91], 0
  ds_read_b128 v[100:103], v1 offset:3072
  buffer_load_dwordx2 v[112:113], v4, s[8:11], s35 offen offset:0 sc1
  s_waitcnt lgkmcnt(2)
  v_mfma_f32_32x32x16_bf16 v[32:47], a[0:3], v[92:95], 0
  ds_read_b128 v[104:107], v1 offset:4096
  buffer_load_dwordx4 a[40:43], v1, s[8:11], s34 offen offset:2048 sc1
  buffer_load_dwordx2 v[114:115], v4, s[8:11], s35 offen offset:256 sc1
  s_waitcnt vmcnt(11) lgkmcnt(2)
  v_mfma_f32_32x32x16_bf16 v[16:31], a[4:7], v[96:99], v[16:31]
  ds_read_b128 v[108:111], v1 offset:5120
  buffer_load_dwordx2 v[116:117], v4, s[8:11], s35 offen offset:512 sc1
  v_bfe_u32 v7, v0, 4, 1
  s_waitcnt lgkmcnt(2)
  v_mfma_f32_32x32x16_bf16 v[32:47], a[4:7], v[100:103], v[32:47]
  ds_read_b128 v[88:91], v1 offset:6144
  buffer_load_dwordx4 a[44:47], v1, s[8:11], s34 offen offset:3072 sc1
  s_add_u32 s34, s34, 4096
  buffer_load_dwordx2 v[118:119], v4, s[8:11], s35 offen offset:768 sc1
  v_lshlrev_b32 v137, 4, v7
  s_waitcnt vmcnt(13) lgkmcnt(2)
  v_mfma_f32_32x32x16_bf16 v[16:31], a[8:11], v[104:107], v[16:31]
  ds_read_b128 v[92:95], v1 offset:7168
  buffer_load_dwordx2 v[120:121], v4, s[8:11], s35 offen offset:1024 sc1
  v_bfe_u32 v7, v0, 2, 1
  s_waitcnt lgkmcnt(2)
  v_mfma_f32_32x32x16_bf16 v[32:47], a[8:11], v[108:111], v[32:47]
  ds_read_b128 v[96:99], v1 offset:8192
  buffer_load_dwordx4 a[48:51], v1, s[8:11], s34 offen offset:0 sc1
  buffer_load_dwordx2 v[122:123], v4, s[8:11], s35 offen offset:1280 sc1
  v_lshl_add_u32 v137, v7, 3, v137
  s_waitcnt vmcnt(15) lgkmcnt(2)
  v_mfma_f32_32x32x16_bf16 v[16:31], a[12:15], v[88:91], v[16:31]
  ds_read_b128 v[100:103], v1 offset:9216
  buffer_load_dwordx2 v[124:125], v4, s[8:11], s35 offen offset:1536 sc1
  v_bfe_u32 v7, v0, 3, 1
  s_waitcnt lgkmcnt(2)
  v_mfma_f32_32x32x16_bf16 v[32:47], a[12:15], v[92:95], v[32:47]
  ds_read_b128 v[104:107], v1 offset:10240
  buffer_load_dwordx4 a[52:55], v1, s[8:11], s34 offen offset:1024 sc1
  buffer_load_dwordx2 v[126:127], v4, s[8:11], s35 offen offset:1792 sc1
  v_lshl_add_u32 v137, v7, 2, v137
  s_waitcnt vmcnt(17) lgkmcnt(2)
  v_mfma_f32_32x32x16_bf16 v[16:31], a[16:19], v[96:99], v[16:31]
  ds_read_b128 v[108:111], v1 offset:11264
  v_and_b32 v7, 3, v0
  v_add_u32 v137, v137, v7
  s_waitcnt lgkmcnt(2)
  v_mfma_f32_32x32x16_bf16 v[32:47], a[16:19], v[100:103], v[32:47]
  ds_read_b128 v[88:91], v1 offset:12288
  buffer_load_dwordx4 a[56:59], v1, s[8:11], s34 offen offset:2048 sc1
  s_mul_i32 s16, s20, 2176
  s_waitcnt vmcnt(17) lgkmcnt(2)
  v_mfma_f32_32x32x16_bf16 v[16:31], a[20:23], v[104:107], v[16:31]
  ds_read_b128 v[92:95], v1 offset:13312
  s_add_u32 s16, s16, 98304
  s_waitcnt lgkmcnt(2)
  v_mfma_f32_32x32x16_bf16 v[32:47], a[20:23], v[108:111], v[32:47]
  ds_read_b128 v[96:99], v1 offset:14336
  buffer_load_dwordx4 a[60:63], v1, s[8:11], s34 offen offset:3072 sc1
  s_add_u32 s34, s34, 4096
  v_lshl_add_u32 v137, v137, 2, s16
  s_waitcnt vmcnt(17) lgkmcnt(2)
  v_mfma_f32_32x32x16_bf16 v[16:31], a[24:27], v[88:91], v[16:31]
  ds_read_b128 v[100:103], v1 offset:15360
  v_lshl_add_u32 v136, v2, 6, s16
  s_waitcnt lgkmcnt(2)
  v_mfma_f32_32x32x16_bf16 v[32:47], a[24:27], v[92:95], v[32:47]
  ds_read_b128 v[104:107], v1 offset:16384
  buffer_load_dwordx4 a[64:67], v1, s[8:11], s34 offen offset:0 sc1
  v_lshl_add_u32 v136, v3, 5, v136
  s_waitcnt vmcnt(17) lgkmcnt(2)
  v_mfma_f32_32x32x16_bf16 v[16:31], a[28:31], v[96:99], v[16:31]
  ds_read_b128 v[108:111], v1 offset:17408
  s_lshl_b32 s16, s20, 9
  v_lshl_add_u32 v138, v0, 3, s16
  s_waitcnt lgkmcnt(2)
  v_mfma_f32_32x32x16_bf16 v[32:47], a[28:31], v[100:103], v[32:47]
  ds_read_b128 v[88:91], v1 offset:18432
  buffer_load_dwordx4 a[68:71], v1, s[8:11], s34 offen offset:1024 sc1
  v_add_u32 v139, 98304, v138
  s_waitcnt vmcnt(17) lgkmcnt(2)
  v_mfma_f32_32x32x16_bf16 v[16:31], a[32:35], v[104:107], v[16:31]
  ds_read_b128 v[92:95], v1 offset:19456
  s_lshl_b32 s16, s20, 5
  s_waitcnt lgkmcnt(2)
  v_mfma_f32_32x32x16_bf16 v[32:47], a[32:35], v[108:111], v[32:47]
  ds_read_b128 v[96:99], v1 offset:20480
  buffer_load_dwordx4 a[72:75], v1, s[8:11], s34 offen offset:2048 sc1
  s_add_u32 s16, s16, 2048
  s_waitcnt vmcnt(17) lgkmcnt(2)
  v_mfma_f32_32x32x16_bf16 v[16:31], a[36:39], v[88:91], v[16:31]
  ds_read_b128 v[100:103], v1 offset:21504
  v_and_b32 v7, 7, v0
  s_waitcnt lgkmcnt(2)
  v_mfma_f32_32x32x16_bf16 v[32:47], a[36:39], v[92:95], v[32:47]
  ds_read_b128 v[104:107], v1 offset:22528
  buffer_load_dwordx4 a[76:79], v1, s[8:11], s34 offen offset:3072 sc1
  s_add_u32 s34, s34, 4096
  v_lshl_add_u32 v142, v7, 2, s16
  s_waitcnt vmcnt(16) lgkmcnt(2)
  v_mfma_f32_32x32x16_bf16 v[16:31], a[40:43], v[96:99], v[16:31]
  ds_read_b128 v[108:111], v1 offset:23552
  v_add_u32 v143, 98304, v142
  s_mul_i32 s39, s26, 557056
  s_waitcnt lgkmcnt(2)
  v_mfma_f32_32x32x16_bf16 v[32:47], a[40:43], v[100:103], v[32:47]
  ds_read_b128 v[88:91], v1 offset:24576
  buffer_load_dwordx4 a[80:83], v1, s[8:11], s34 offen offset:0 sc1
  s_mul_i32 s16, s22, 34816
  s_waitcnt vmcnt(14) lgkmcnt(2)
  v_mfma_f32_32x32x16_bf16 v[16:31], a[44:47], v[104:107], v[16:31]
  ds_read_b128 v[92:95], v1 offset:25600
  s_add_u32 s39, s39, s16
  s_waitcnt lgkmcnt(2)
  v_mfma_f32_32x32x16_bf16 v[32:47], a[44:47], v[108:111], v[32:47]
  ds_read_b128 v[96:99], v1 offset:26624
  buffer_load_dwordx4 a[84:87], v1, s[8:11], s34 offen offset:1024 sc1
  s_add_u32 s39, s39, 35913728
  s_waitcnt vmcnt(12) lgkmcnt(2)
  v_mfma_f32_32x32x16_bf16 v[16:31], a[48:51], v[88:91], v[16:31]
  ds_read_b128 v[100:103], v1 offset:27648
  s_mul_i32 s16, s21, 2176
  s_waitcnt lgkmcnt(2)
  v_mfma_f32_32x32x16_bf16 v[32:47], a[48:51], v[92:95], v[32:47]
  ds_read_b128 v[104:107], v1 offset:28672
  buffer_load_dwordx4 a[88:91], v1, s[8:11], s34 offen offset:2048 sc1
  s_add_u32 s37, s39, s16
  s_waitcnt vmcnt(10) lgkmcnt(2)
  v_mfma_f32_32x32x16_bf16 v[16:31], a[52:55], v[96:99], v[16:31]
  ds_read_b128 v[108:111], v1 offset:29696
  v_and_b32 v7, 16, v0
  v_cmp_eq_u32 s[64:65], 0, v7
  s_waitcnt lgkmcnt(2)
  v_mfma_f32_32x32x16_bf16 v[32:47], a[52:55], v[100:103], v[32:47]
  ds_read_b128 v[88:91], v1 offset:30720
  buffer_load_dwordx4 a[92:95], v1, s[8:11], s34 offen offset:3072 sc1
  s_add_u32 s34, s34, 4096
  v_add_f32 v128, v112, v114
  v_add_f32 v129, v113, v115
  s_waitcnt vmcnt(9) lgkmcnt(2)
  v_mfma_f32_32x32x16_bf16 v[16:31], a[56:59], v[104:107], v[16:31]
  ds_read_b128 v[92:95], v1 offset:31744
  v_add_f32 v128, v128, v116
  v_add_f32 v129, v129, v117
  s_waitcnt lgkmcnt(2)
  v_mfma_f32_32x32x16_bf16 v[32:47], a[56:59], v[108:111], v[32:47]
  ds_read_b128 v[96:99], v1 offset:32768
  buffer_load_dwordx4 a[96:99], v1, s[8:11], s34 offen offset:0 sc1
  v_add_f32 v128, v128, v118
  v_add_f32 v129, v129, v119
  s_waitcnt vmcnt(9) lgkmcnt(2)
  v_mfma_f32_32x32x16_bf16 v[16:31], a[60:63], v[88:91], v[16:31]
  ds_read_b128 v[100:103], v1 offset:33792
  v_add_f32 v128, v128, v120
  v_add_f32 v129, v129, v121
  v_add_f32 v128, v128, v122
  s_waitcnt lgkmcnt(2)
  v_mfma_f32_32x32x16_bf16 v[32:47], a[60:63], v[92:95], v[32:47]
  ds_read_b128 v[104:107], v1 offset:34816
  buffer_load_dwordx4 a[100:103], v1, s[8:11], s34 offen offset:1024 sc1
  v_add_f32 v129, v129, v123
  v_add_f32 v128, v128, v124
  s_waitcnt vmcnt(9) lgkmcnt(2)
  v_mfma_f32_32x32x16_bf16 v[16:31], a[64:67], v[96:99], v[16:31]
  ds_read_b128 v[108:111], v1 offset:35840
  v_add_f32 v129, v129, v125
  v_add_f32 v128, v128, v126
  s_waitcnt lgkmcnt(2)
  v_mfma_f32_32x32x16_bf16 v[32:47], a[64:67], v[100:103], v[32:47]
  ds_read_b128 v[88:91], v1 offset:36864
  buffer_load_dwordx4 a[104:107], v1, s[8:11], s34 offen offset:2048 sc1
  v_add_f32 v129, v129, v127
  v_mov_b32 v130, v128
  s_waitcnt vmcnt(9) lgkmcnt(2)
  v_mfma_f32_32x32x16_bf16 v[16:31], a[68:71], v[104:107], v[16:31]
  ds_read_b128 v[92:95], v1 offset:37888
  v_permlane32_swap_b32 v130, v128
  v_add_f32 v128, v130, v128
  v_mul_f32 v128, 0x3d800000, v128
  s_waitcnt lgkmcnt(2)
  v_mfma_f32_32x32x16_bf16 v[32:47], a[68:71], v[108:111], v[32:47]
  ds_read_b128 v[96:99], v1 offset:38912
  buffer_load_dwordx4 a[108:111], v1, s[8:11], s34 offen offset:3072 sc1
  s_add_u32 s34, s34, 4096
  v_sub_f32 v112, v112, v128
  v_sub_f32 v114, v114, v128
  s_waitcnt vmcnt(9) lgkmcnt(2)
  v_mfma_f32_32x32x16_bf16 v[16:31], a[72:75], v[88:91], v[16:31]
  ds_read_b128 v[100:103], v1 offset:39936
  v_sub_f32 v116, v116, v128
  v_sub_f32 v118, v118, v128
  s_waitcnt lgkmcnt(2)
  v_mfma_f32_32x32x16_bf16 v[32:47], a[72:75], v[92:95], v[32:47]
  ds_read_b128 v[104:107], v1 offset:40960
  buffer_load_dwordx4 a[112:115], v1, s[8:11], s34 offen offset:0 sc1
  v_sub_f32 v120, v120, v128
  v_sub_f32 v122, v122, v128
  s_waitcnt vmcnt(9) lgkmcnt(2)
  v_mfma_f32_32x32x16_bf16 v[16:31], a[76:79], v[96:99], v[16:31]
  ds_read_b128 v[108:111], v1 offset:41984
  v_sub_f32 v124, v124, v128
  v_sub_f32 v126, v126, v128
  v_mul_f32 v130, v112, v112
  s_waitcnt lgkmcnt(2)
  v_mfma_f32_32x32x16_bf16 v[32:47], a[76:79], v[100:103], v[32:47]
  ds_read_b128 v[88:91], v1 offset:43008
  buffer_load_dwordx4 a[116:119], v1, s[8:11], s34 offen offset:1024 sc1
  v_fmac_f32 v130, v114, v114
  v_fmac_f32 v130, v116, v116
  s_waitcnt vmcnt(9) lgkmcnt(2)
  v_mfma_f32_32x32x16_bf16 v[16:31], a[80:83], v[104:107], v[16:31]
  ds_read_b128 v[92:95], v1 offset:44032
  v_fmac_f32 v130, v118, v118
  v_fmac_f32 v130, v120, v120
  s_waitcnt lgkmcnt(2)
  v_mfma_f32_32x32x16_bf16 v[32:47], a[80:83], v[108:111], v[32:47]
  ds_read_b128 v[96:99], v1 offset:45056
  buffer_load_dwordx4 a[120:123], v1, s[8:11], s34 offen offset:2048 sc1
  v_fmac_f32 v130, v122, v122
  v_fmac_f32 v130, v124, v124
  s_waitcnt vmcnt(9) lgkmcnt(2)
  v_mfma_f32_32x32x16_bf16 v[16:31], a[84:87], v[88:91], v[16:31]
  ds_read_b128 v[100:103], v1 offset:46080
  v_fmac_f32 v130, v126, v126
  v_fmamk_f32 v129, v130, 0x42000000, v129
  v_mov_b32 v130, v129
  s_waitcnt lgkmcnt(2)
  v_mfma_f32_32x32x16_bf16 v[32:47], a[84:87], v[92:95], v[32:47]
  ds_read_b128 v[104:107], v1 offset:47104
  buffer_load_dwordx4 a[124:127], v1, s[8:11], s34 offen offset:3072 sc1
  s_add_u32 s34, s34, 4096
  v_permlane32_swap_b32 v130, v129
  v_add_f32 v129, v130, v129
  s_waitcnt vmcnt(9) lgkmcnt(2)
  v_mfma_f32_32x32x16_bf16 v[16:31], a[88:91], v[96:99], v[16:31]
  ds_read_b128 v[108:111], v1 offset:48128
  v_mov_b32 v130, 0x3727c5ac
  v_fmamk_f32 v129, v129, 0x3b000000, v130
  s_waitcnt lgkmcnt(2)
  v_mfma_f32_32x32x16_bf16 v[32:47], a[88:91], v[100:103], v[32:47]
  ds_read_b128 v[88:91], v1 offset:49152
  s_add_u32 m0, s31, 65536
  s_nop 0
  buffer_load_dwordx4 v1, s[8:11], s32 offen offset:0 sc1 lds
  v_rsq_f32 v129, v129
  v_sub_f32 v130, 0, v128
  v_cvt_pk_bf16_f32 v133, v130, 0
  s_waitcnt vmcnt(9) lgkmcnt(2)
  v_mfma_f32_32x32x16_bf16 v[16:31], a[92:95], v[104:107], v[16:31]
  ds_read_b128 v[92:95], v1 offset:50176
  v_lshlrev_b32 v131, 16, v133
  v_sub_f32 v131, v130, v131
  s_waitcnt lgkmcnt(2)
  v_mfma_f32_32x32x16_bf16 v[32:47], a[92:95], v[108:111], v[32:47]
  ds_read_b128 v[96:99], v1 offset:51200
  s_add_u32 m0, s31, 65536
  s_nop 0
  buffer_load_dwordx4 v1, s[8:11], s32 offen offset:1024 sc1 lds
  v_cvt_pk_bf16_f32 v132, v130, v131
  v_mov_b32 v135, 0
  s_waitcnt vmcnt(9) lgkmcnt(2)
  v_mfma_f32_32x32x16_bf16 v[16:31], a[96:99], v[88:91], v[16:31]
  ds_read_b128 v[100:103], v1 offset:52224
  v_mov_b32 v134, 0
  s_lshl_b32 s16, s20, 7
  s_waitcnt lgkmcnt(2)
  v_mfma_f32_32x32x16_bf16 v[32:47], a[96:99], v[92:95], v[32:47]
  ds_read_b128 v[104:107], v1 offset:53248
  s_add_u32 m0, s31, 65536
  s_nop 0
  buffer_load_dwordx4 v1, s[8:11], s32 offen offset:2048 sc1 lds
  s_add_u32 s16, s16, 161792
  v_lshl_add_u32 v7, v2, 2, s16
  ds_write_b32 v7, v129
  s_waitcnt vmcnt(9) lgkmcnt(3)
  v_mfma_f32_32x32x16_bf16 v[16:31], a[100:103], v[96:99], v[16:31]
  ds_read_b128 v[108:111], v1 offset:54272
  v_lshl_add_u32 v7, v3, 4, s16
  ds_read_b128 v[112:115], v7 offset:0
  s_waitcnt lgkmcnt(4)
  v_mfma_f32_32x32x16_bf16 v[32:47], a[100:103], v[100:103], v[32:47]
  ds_read_b128 v[88:91], v1 offset:55296
  s_add_u32 m0, s31, 65536
  s_nop 0
  buffer_load_dwordx4 v1, s[8:11], s32 offen offset:3072 sc1 lds
  s_add_u32 s32, s32, 16384
  ds_read_b128 v[116:119], v7 offset:32
  ds_read_b128 v[120:123], v7 offset:64
  s_waitcnt vmcnt(9) lgkmcnt(6)
  v_mfma_f32_32x32x16_bf16 v[16:31], a[104:107], v[104:107], v[16:31]
  ds_read_b128 v[92:95], v1 offset:56320
  ds_read_b128 v[124:127], v7 offset:96
  s_mov_b32 s38, 0x3fb8aa3b
  s_waitcnt lgkmcnt(6)
  v_mfma_f32_32x32x16_bf16 v[32:47], a[104:107], v[108:111], v[32:47]
  ds_read_b128 v[96:99], v1 offset:57344
  s_add_u32 m0, s31, 81920
  s_nop 0
  buffer_load_dwordx4 v1, s[8:11], s32 offen offset:0 sc1 lds
  v_mul_f32 v128, s38, v129
  s_mov_b32 s40, 0x358637bd
  s_mov_b32 s41, 0x358637bd
  s_waitcnt vmcnt(9) lgkmcnt(5)
  v_mfma_f32_32x32x16_bf16 v[16:31], a[108:111], v[88:91], v[16:31]
  ds_read_b128 v[100:103], v1 offset:58368
  v_mul_f32 v144, s38, v112
  v_mul_f32 v145, s38, v113
  s_waitcnt lgkmcnt(3)
  v_mfma_f32_32x32x16_bf16 v[32:47], a[108:111], v[92:95], v[32:47]
  ds_read_b128 v[104:107], v1 offset:59392
  s_add_u32 m0, s31, 81920
  s_nop 0
  buffer_load_dwordx4 v1, s[8:11], s32 offen offset:1024 sc1 lds
  v_mul_f32 v146, s38, v114
  v_mul_f32 v147, s38, v115
  s_waitcnt vmcnt(9) lgkmcnt(2)
  v_mfma_f32_32x32x16_bf16 v[16:31], a[112:115], v[96:99], v[16:31]
  ds_read_b128 v[108:111], v1 offset:60416
  v_mul_f32 v148, s38, v116
  v_mul_f32 v149, s38, v117
  s_waitcnt lgkmcnt(2)
  v_mfma_f32_32x32x16_bf16 v[32:47], a[112:115], v[100:103], v[32:47]
  ds_read_b128 v[88:91], v1 offset:61440
  s_add_u32 m0, s31, 81920
  s_nop 0
  buffer_load_dwordx4 v1, s[8:11], s32 offen offset:2048 sc1 lds
  v_mul_f32 v150, s38, v118
  v_mul_f32 v151, s38, v119
  v_mul_f32 v152, s38, v120
  s_waitcnt vmcnt(9) lgkmcnt(2)
  v_mfma_f32_32x32x16_bf16 v[16:31], a[116:119], v[104:107], v[16:31]
  ds_read_b128 v[92:95], v1 offset:62464
  v_mul_f32 v153, s38, v121
  v_mul_f32 v154, s38, v122
  s_waitcnt lgkmcnt(2)
  v_mfma_f32_32x32x16_bf16 v[32:47], a[116:119], v[108:111], v[32:47]
  ds_read_b128 v[96:99], v1 offset:63488
  s_add_u32 m0, s31, 81920
  s_nop 0
  buffer_load_dwordx4 v1, s[8:11], s32 offen offset:3072 sc1 lds
  s_add_u32 s32, s32, 16384
  v_mul_f32 v155, s38, v123
  v_mul_f32 v156, s38, v124
  s_waitcnt vmcnt(9) lgkmcnt(2)
  v_mfma_f32_32x32x16_bf16 v[16:31], a[120:123], v[88:91], v[16:31]
  ds_read_b128 v[100:103], v1 offset:64512
  v_mul_f32 v157, s38, v125
  v_mul_f32 v158, s38, v126
  v_mul_f32 v159, s38, v127
  s_waitcnt lgkmcnt(2)
  v_mfma_f32_32x32x16_bf16 v[32:47], a[120:123], v[92:95], v[32:47]
  ds_read_b128 v[104:107], v6 offset:16384
  s_waitcnt vmcnt(8) lgkmcnt(2)
  v_mfma_f32_32x32x16_bf16 v[16:31], a[124:127], v[96:99], v[16:31]
  ds_read_b128 v[108:111], v6 offset:17408
  s_waitcnt lgkmcnt(2)
  v_mfma_f32_32x32x16_bf16 v[32:47], a[124:127], v[100:103], v[32:47]
  s_waitcnt lgkmcnt(1)
  v_mfma_f32_32x32x16_bf16 v[16:31], v[132:135], v[104:107], v[16:31]
  s_waitcnt lgkmcnt(0)
  v_mfma_f32_32x32x16_bf16 v[32:47], v[132:135], v[108:111], v[32:47]
L_safe_epi:
  s_nop 9
  v_pk_mul_f32 v[140:141], v[16:17], v[144:145]
  v_pk_fma_f32 v[16:17], v[16:17], v[112:113], s[40:41]
  v_exp_f32_e64 v140, v140 clamp
  v_exp_f32_e64 v141, v141 clamp
  v_pk_mul_f32 v[32:33], v[32:33], v[112:113]
  v_max_f32 v16, s40, v16
  v_max_f32 v17, s40, v17
  v_cvt_pk_bf16_f32 v104, v32, v33
  v_pk_add_f32 v[16:17], v[16:17], v[140:141]
  v_cvt_pk_bf16_f32 v96, v16, v17
  v_pk_mul_f32 v[130:131], v[18:19], v[146:147]
  v_pk_fma_f32 v[18:19], v[18:19], v[114:115], s[40:41]
  v_exp_f32_e64 v130, v130 clamp
  v_exp_f32_e64 v131, v131 clamp
  v_pk_mul_f32 v[34:35], v[34:35], v[114:115]
  v_max_f32 v18, s40, v18
  v_max_f32 v19, s40, v19
  v_cvt_pk_bf16_f32 v105, v34, v35
  v_pk_add_f32 v[18:19], v[18:19], v[130:131]
  v_cvt_pk_bf16_f32 v97, v18, v19
  v_pk_mul_f32 v[140:141], v[20:21], v[148:149]
  v_pk_fma_f32 v[20:21], v[20:21], v[116:117], s[40:41]
  v_exp_f32_e64 v140, v140 clamp
  v_exp_f32_e64 v141, v141 clamp
  v_pk_mul_f32 v[36:37], v[36:37], v[116:117]
  v_max_f32 v20, s40, v20
  v_max_f32 v21, s40, v21
  v_cvt_pk_bf16_f32 v106, v36, v37
  v_pk_add_f32 v[20:21], v[20:21], v[140:141]
  v_cvt_pk_bf16_f32 v98, v20, v21
  v_pk_mul_f32 v[130:131], v[22:23], v[150:151]
  v_pk_fma_f32 v[22:23], v[22:23], v[118:119], s[40:41]
  v_exp_f32_e64 v130, v130 clamp
  v_exp_f32_e64 v131, v131 clamp
  v_pk_mul_f32 v[38:39], v[38:39], v[118:119]
  v_max_f32 v22, s40, v22
  v_max_f32 v23, s40, v23
  v_cvt_pk_bf16_f32 v107, v38, v39
  v_pk_add_f32 v[22:23], v[22:23], v[130:131]
  v_cvt_pk_bf16_f32 v99, v22, v23
  s_nop 1
  v_mfma_f32_32x32x16_bf16 v[64:79], v[96:99], v[104:107], 0
  v_pk_mul_f32 v[140:141], v[24:25], v[152:153]
  v_pk_fma_f32 v[24:25], v[24:25], v[120:121], s[40:41]
  v_exp_f32_e64 v140, v140 clamp
  v_exp_f32_e64 v141, v141 clamp
  v_pk_mul_f32 v[40:41], v[40:41], v[120:121]
  v_max_f32 v24, s40, v24
  v_max_f32 v25, s40, v25
  v_cvt_pk_bf16_f32 v108, v40, v41
  v_pk_add_f32 v[24:25], v[24:25], v[140:141]
  v_cvt_pk_bf16_f32 v100, v24, v25
  v_pk_mul_f32 v[130:131], v[26:27], v[154:155]
  v_pk_fma_f32 v[26:27], v[26:27], v[122:123], s[40:41]
  v_exp_f32_e64 v130, v130 clamp
  v_exp_f32_e64 v131, v131 clamp
  v_pk_mul_f32 v[42:43], v[42:43], v[122:123]
  v_max_f32 v26, s40, v26
  v_max_f32 v27, s40, v27
  v_cvt_pk_bf16_f32 v109, v42, v43
  v_pk_add_f32 v[26:27], v[26:27], v[130:131]
  v_cvt_pk_bf16_f32 v101, v26, v27
  v_pk_mul_f32 v[140:141], v[28:29], v[156:157]
  v_pk_fma_f32 v[28:29], v[28:29], v[124:125], s[40:41]
  v_exp_f32_e64 v140, v140 clamp
  v_exp_f32_e64 v141, v141 clamp
  v_pk_mul_f32 v[44:45], v[44:45], v[124:125]
  v_max_f32 v28, s40, v28
  v_max_f32 v29, s40, v29
  v_cvt_pk_bf16_f32 v110, v44, v45
  v_pk_add_f32 v[28:29], v[28:29], v[140:141]
  v_cvt_pk_bf16_f32 v102, v28, v29
  v_pk_mul_f32 v[130:131], v[30:31], v[158:159]
  v_pk_fma_f32 v[30:31], v[30:31], v[126:127], s[40:41]
  v_exp_f32_e64 v130, v130 clamp
  v_exp_f32_e64 v131, v131 clamp
  v_pk_mul_f32 v[46:47], v[46:47], v[126:127]
  v_max_f32 v30, s40, v30
  v_max_f32 v31, s40, v31
  v_cvt_pk_bf16_f32 v111, v46, v47
  v_pk_add_f32 v[30:31], v[30:31], v[130:131]
  v_cvt_pk_bf16_f32 v103, v30, v31
  s_nop 1
  v_mfma_f32_32x32x16_bf16 v[64:79], v[100:103], v[108:111], v[64:79]
  v_pk_add_f32 v[16:17], v[16:17], v[20:21]
  v_pk_add_f32 v[18:19], v[18:19], v[22:23]
  v_pk_add_f32 v[16:17], v[16:17], v[24:25]
  v_pk_add_f32 v[18:19], v[18:19], v[26:27]
  v_pk_add_f32 v[16:17], v[16:17], v[28:29]
  v_pk_add_f32 v[18:19], v[18:19], v[30:31]
  v_pk_add_f32 v[16:17], v[16:17], v[18:19]
  v_add_f32 v16, v16, v17
  v_mov_b32 v130, v16
  s_nop 1
  v_permlane32_swap_b32 v130, v16
  v_add_f32 v16, v130, v16
  ds_write_b32 v137, v16 offset:2048
  s_mov_b64 exec, s[64:65]
  ds_write_b128 v136, v[64:67]
  ds_write_b128 v136, v[68:71] offset:16
  s_not_b64 exec, exec
  ds_write_b128 v136, v[72:75]
  ds_write_b128 v136, v[76:79] offset:16
  s_mov_b64 exec, -1
  s_cmp_lg_u32 s26, 0
  s_cbranch_scc1 lay_45_1
  s_waitcnt vmcnt(6)
  s_branch lay_45_2
lay_45_1:
  s_waitcnt vmcnt(0)
lay_45_2:
  s_waitcnt lgkmcnt(0)
  s_barrier
  ds_read_b64 v[16:17], v139 offset:0
  ds_read_b32 v24, v143 offset:0
  ds_read_b64 v[18:19], v139 offset:2176
  ds_read_b32 v25, v143 offset:2176
  ds_read_b64 v[20:21], v139 offset:4352
  ds_read_b32 v26, v143 offset:4352
  ds_read_b64 v[22:23], v139 offset:6528
  ds_read_b32 v27, v143 offset:6528
  ds_read_b128 v[88:91], v5 offset:16384
  ds_read_b128 v[92:95], v5 offset:17408
  ds_read_b128 v[96:99], v5 offset:18432
  s_waitcnt lgkmcnt(8)
  v_pk_add_f32 v[16:17], v[16:17], v[18:19]
  s_waitcnt lgkmcnt(7)
  v_add_f32 v24, v24, v25
  s_waitcnt lgkmcnt(4)
  v_pk_add_f32 v[20:21], v[20:21], v[22:23]
  s_waitcnt lgkmcnt(3)
  v_add_f32 v26, v26, v27
  v_pk_add_f32 v[16:17], v[16:17], v[20:21]
  v_add_f32 v24, v24, v26
  v_min_u32 v16, -2, v16
  v_min_u32 v17, -2, v17
  v_min_u32 v24, -2, v24
  buffer_store_dwordx2 v[16:17], v138, s[8:11], s37 offen sc1
  buffer_store_dword v24, v142, s[8:11], s37 offen sc1
  s_mul_i32 s32, s22, 229376
  s_add_u32 s32, s32, s31
  s_add_u32 s32, s32, 2097152
  s_cmp_lg_u32 s26, 0
  s_cbranch_scc1 lay_46_1
  s_and_b32 s96, s33, 4294967039
  s_add_u32 s96, s96, 128
  v_and_b32 v233, 1, v0
  v_lshlrev_b32 v233, 8, v233
  s_mul_i32 s36, s25, 229376
  s_mul_i32 s16, s20, 57344
  s_add_u32 s36, s36, s16
  s_add_u32 s36, s36, 5767168
  s_waitcnt lgkmcnt(2)
  ds_read_b64_tr_b16 v[88:89], v171 offset:49152
  ds_read_b64_tr_b16 v[90:91], v171 offset:49408
  s_waitcnt lgkmcnt(3)
  ds_read_b64_tr_b16 v[92:93], v171 offset:52224
  ds_read_b64_tr_b16 v[94:95], v171 offset:52480
  s_waitcnt lgkmcnt(4)
  ds_read_b64_tr_b16 v[96:97], v171 offset:55296
  ds_read_b64_tr_b16 v[98:99], v171 offset:55552
  s_waitcnt lgkmcnt(4)
  v_mfma_f32_32x32x16_bf16 v[48:63], v[88:91], a[64:67], 0
  ds_read_b64_tr_b16 v[100:101], v171 offset:58368
  ds_read_b64_tr_b16 v[102:103], v171 offset:58624
  s_lshl_b32 s34, s25, 16
  s_lshl_b32 s17, s20, 14
  s_add_u32 s34, s34, s17
  s_add_u32 s34, s34, 1572864
  v_mul_u32_u24 v136, 2176, v3
  v_lshl_add_u32 v136, v2, 4, v136
  v_lshrrev_b32 v137, 2, v0
  s_waitcnt lgkmcnt(4)
  v_mfma_f32_32x32x16_bf16 v[48:63], v[92:95], a[68:71], v[48:63]
  ds_read_b64_tr_b16 v[104:105], v171 offset:61440
  ds_read_b64_tr_b16 v[106:107], v171 offset:61696
  buffer_load_dwordx4 a[64:67], v10, s[8:11], s34 offen offset:0 sc1
  v_mul_u32_u24 v137, 2176, v137
  v_and_b32 v138, 3, v0
  v_lshl_add_u32 v137, v138, 3, v137
  s_waitcnt lgkmcnt(4)
  v_mfma_f32_32x32x16_bf16 v[48:63], v[96:99], a[72:75], v[48:63]
  ds_read_b64_tr_b16 v[108:109], v171 offset:64512
  ds_read_b64_tr_b16 v[110:111], v171 offset:64768
  buffer_load_dwordx4 a[68:71], v11, s[8:11], s34 offen offset:0 sc1
  s_lshl_b32 s17, s20, 9
  s_add_u32 s37, s39, s17
  s_lshl_b32 s17, s20, 5
  s_waitcnt lgkmcnt(4)
  v_mfma_f32_32x32x16_bf16 v[48:63], v[100:103], a[76:79], v[48:63]
  ds_read_b64_tr_b16 v[88:89], v227 offset:2048
  ds_read_b64_tr_b16 v[90:91], v227 offset:2304
  buffer_load_dwordx4 a[72:75], v10, s[8:11], s34 offen offset:2048 sc1
  s_add_u32 s44, s39, s17
  s_lshr_b32 s16, s20, 1
  s_lshl_b32 s17, s16, 6
  s_lshl_b32 s18, s20, 9
  s_waitcnt lgkmcnt(4)
  v_mfma_f32_32x32x16_bf16 v[48:63], v[104:107], a[80:83], v[48:63]
  ds_read_b64_tr_b16 v[92:93], v227 offset:5120
  ds_read_b64_tr_b16 v[94:95], v227 offset:5376
  buffer_load_dwordx4 a[76:79], v11, s[8:11], s34 offen offset:2048 sc1
  s_add_u32 s34, s34, 4096
  s_add_u32 s17, s17, s18
  s_add_u32 s17, s17, 158720
  v_lshl_add_u32 v142, v2, 4, s17
  s_waitcnt lgkmcnt(4)
  v_mfma_f32_32x32x16_bf16 v[48:63], v[108:111], a[84:87], v[48:63]
  ds_read_b64_tr_b16 v[96:97], v227 offset:8192
  ds_read_b64_tr_b16 v[98:99], v227 offset:8448
  s_mul_i32 s16, s16, 1088
  s_and_b32 s17, s20, 1
  s_lshl_b32 s17, s17, 5
  s_waitcnt lgkmcnt(4)
  v_mfma_f32_32x32x16_bf16 v[48:63], v[88:91], a[88:91], v[48:63]
  ds_read_b64_tr_b16 v[100:101], v227 offset:11264
  ds_read_b64_tr_b16 v[102:103], v227 offset:11520
  s_add_u32 s16, s16, s17
  s_add_u32 s16, s16, 159744
  v_lshl_add_u32 v143, v138, 3, s16
  v_min_u32 v138, 16, v2
  s_waitcnt lgkmcnt(4)
  v_mfma_f32_32x32x16_bf16 v[48:63], v[92:95], a[92:95], v[48:63]
  ds_read_b64_tr_b16 v[104:105], v227 offset:14336
  ds_read_b64_tr_b16 v[106:107], v227 offset:14592
  v_lshlrev_b32 v138, 6, v138
  v_lshl_add_u32 v138, v3, 5, v138
  v_add_u32 v138, 158720, v138
  s_waitcnt lgkmcnt(4)
  v_mfma_f32_32x32x16_bf16 v[48:63], v[96:99], a[96:99], v[48:63]
  ds_read_b64_tr_b16 v[108:109], v227 offset:17408
  ds_read_b64_tr_b16 v[110:111], v227 offset:17664
  s_lshr_b32 s16, s23, 1
  s_lshl_b32 s17, s16, 7
  s_lshl_b32 s16, s16, 4
  s_waitcnt lgkmcnt(4)
  v_mfma_f32_32x32x16_bf16 v[48:63], v[100:103], a[100:103], v[48:63]
  ds_read_b64_tr_b16 v[88:89], v227 offset:20480
  ds_read_b64_tr_b16 v[90:91], v227 offset:20736
  s_add_u32 s16, s16, s22
  s_lshl_b32 s16, s16, 12
  s_and_b32 s18, s20, 1
  s_lshl_b32 s19, s18, 10
  s_waitcnt lgkmcnt(4)
  v_mfma_f32_32x32x16_bf16 v[48:63], v[104:107], a[104:107], v[48:63]
  ds_read_b64_tr_b16 v[92:93], v227 offset:23552
  ds_read_b64_tr_b16 v[94:95], v227 offset:23808
  s_add_u32 s16, s16, s19
  s_mul_i32 s19, s26, 2097152
  s_add_u32 s16, s16, s19
  s_waitcnt lgkmcnt(4)
  v_mfma_f32_32x32x16_bf16 v[48:63], v[108:111], a[108:111], v[48:63]
  ds_read_b64_tr_b16 v[96:97], v227 offset:26624
  ds_read_b64_tr_b16 v[98:99], v227 offset:26880
  s_add_u32 s45, s16, 17039360
  s_lshl_b32 s19, s22, 1
  s_add_u32 s18, s18, s19
  s_waitcnt lgkmcnt(4)
  v_mfma_f32_32x32x16_bf16 v[48:63], v[88:91], a[112:115], v[48:63]
  ds_read_b64_tr_b16 v[100:101], v227 offset:29696
  ds_read_b64_tr_b16 v[102:103], v227 offset:29952
  s_lshl_b32 s18, s18, 2
  s_add_u32 s47, s17, s18
  s_add_u32 s46, s47, 37396480
  s_add_u32 s47, s47, 37400576
  s_waitcnt lgkmcnt(4)
  v_mfma_f32_32x32x16_bf16 v[48:63], v[92:95], a[116:119], v[48:63]
  ds_read_b64_tr_b16 v[104:105], v171 offset:0
  ds_read_b64_tr_b16 v[106:107], v171 offset:256
  s_waitcnt vmcnt(11)
  ds_write_b128 v230, a[128:131]
  s_waitcnt vmcnt(10)
  ds_write_b128 v230, a[132:135] offset:1024
  s_waitcnt lgkmcnt(6)
  v_mfma_f32_32x32x16_bf16 v[48:63], v[96:99], a[120:123], v[48:63]
  ds_read_b64_tr_b16 v[108:109], v171 offset:3072
  ds_read_b64_tr_b16 v[110:111], v171 offset:3328
  ds_read_b64_tr_b16 v[196:197], v173 offset:0
  ds_read_b64_tr_b16 v[198:199], v173 offset:512
  s_waitcnt lgkmcnt(8)
  v_mfma_f32_32x32x16_bf16 v[48:63], v[100:103], a[124:127], v[48:63]
  ds_read_b64_tr_b16 v[88:89], v171 offset:6144
  ds_read_b64_tr_b16 v[90:91], v171 offset:6400
  ds_read_b64_tr_b16 v[204:205], v173 offset:32
  ds_read_b64_tr_b16 v[206:207], v173 offset:544
  s_waitcnt lgkmcnt(10)
  v_mfma_f32_32x32x16_bf16 v[48:63], v[104:107], a[0:3], v[48:63]
  ds_read_b64_tr_b16 v[92:93], v171 offset:9216
  ds_read_b64_tr_b16 v[94:95], v171 offset:9472
  s_waitcnt lgkmcnt(6)
  buffer_store_dwordx4 v[196:199], v1, s[8:11], s53 offen sc1
  v_mfma_f32_32x32x16_bf16 v[48:63], v[108:111], a[4:7], v[48:63]
  ds_read_b64_tr_b16 v[96:97], v171 offset:12288
  ds_read_b64_tr_b16 v[98:99], v171 offset:12544
  s_waitcnt lgkmcnt(4)
  buffer_store_dwordx4 v[204:207], v1, s[8:11], s55 offen sc1
  v_mfma_f32_32x32x16_bf16 v[48:63], v[88:91], a[8:11], v[48:63]
  ds_read_b64_tr_b16 v[100:101], v171 offset:15360
  ds_read_b64_tr_b16 v[102:103], v171 offset:15616
  s_waitcnt vmcnt(11)
  ds_write_b128 v230, a[136:139]
  s_waitcnt vmcnt(10)
  ds_write_b128 v230, a[140:143] offset:1024
  s_waitcnt lgkmcnt(6)
  v_mfma_f32_32x32x16_bf16 v[48:63], v[92:95], a[12:15], v[48:63]
  ds_read_b64_tr_b16 v[104:105], v171 offset:18432
  ds_read_b64_tr_b16 v[106:107], v171 offset:18688
  ds_read_b64_tr_b16 v[200:201], v173 offset:0
  ds_read_b64_tr_b16 v[202:203], v173 offset:512
  s_waitcnt lgkmcnt(8)
  v_mfma_f32_32x32x16_bf16 v[48:63], v[96:99], a[16:19], v[48:63]
  ds_read_b64_tr_b16 v[108:109], v171 offset:21504
  ds_read_b64_tr_b16 v[110:111], v171 offset:21760
  ds_read_b64_tr_b16 v[208:209], v173 offset:32
  ds_read_b64_tr_b16 v[210:211], v173 offset:544
  s_waitcnt lgkmcnt(10)
  v_mfma_f32_32x32x16_bf16 v[48:63], v[100:103], a[20:23], v[48:63]
  ds_read_b64_tr_b16 v[88:89], v171 offset:24576
  ds_read_b64_tr_b16 v[90:91], v171 offset:24832
  s_waitcnt lgkmcnt(6)
  buffer_store_dwordx4 v[200:203], v1, s[8:11], s54 offen sc1
  v_mfma_f32_32x32x16_bf16 v[48:63], v[104:107], a[24:27], v[48:63]
  ds_read_b64_tr_b16 v[92:93], v171 offset:27648
  ds_read_b64_tr_b16 v[94:95], v171 offset:27904
  s_waitcnt lgkmcnt(4)
  buffer_store_dwordx4 v[208:211], v1, s[8:11], s56 offen sc1
  v_mfma_f32_32x32x16_bf16 v[48:63], v[108:111], a[28:31], v[48:63]
  ds_read_b64_tr_b16 v[96:97], v171 offset:30720
  ds_read_b64_tr_b16 v[98:99], v171 offset:30976
  v_mfma_f32_32x32x16_bf16 a[152:167], v[176:179], v[196:199], 0
  v_mfma_f32_32x32x16_bf16 a[152:167], v[176:179], v[200:203], a[152:167]
  s_waitcnt lgkmcnt(4)
  v_mfma_f32_32x32x16_bf16 v[48:63], v[88:91], a[32:35], v[48:63]
  ds_read_b64_tr_b16 v[100:101], v171 offset:33792
  ds_read_b64_tr_b16 v[102:103], v171 offset:34048
  v_mfma_f32_32x32x16_bf16 a[168:183], v[176:179], v[204:207], 0
  v_mfma_f32_32x32x16_bf16 a[168:183], v[176:179], v[208:211], a[168:183]
  s_waitcnt lgkmcnt(4)
  v_mfma_f32_32x32x16_bf16 v[48:63], v[92:95], a[36:39], v[48:63]
  ds_read_b64_tr_b16 v[104:105], v171 offset:36864
  ds_read_b64_tr_b16 v[106:107], v171 offset:37120
  s_nop 0
  s_waitcnt lgkmcnt(4)
  v_mfma_f32_32x32x16_bf16 v[48:63], v[96:99], a[40:43], v[48:63]
  ds_read_b64_tr_b16 v[108:109], v171 offset:39936
  ds_read_b64_tr_b16 v[110:111], v171 offset:40192
  s_nop 0
  s_waitcnt lgkmcnt(4)
  v_mfma_f32_32x32x16_bf16 v[48:63], v[100:103], a[44:47], v[48:63]
  ds_read_b64_tr_b16 v[88:89], v171 offset:43008
  ds_read_b64_tr_b16 v[90:91], v171 offset:43264
  v_accvgpr_read_b32 v220, a152
  buffer_store_dword v220, v174, s[8:11], s52 offen offset:0 sc1
  s_waitcnt lgkmcnt(4)
  v_mfma_f32_32x32x16_bf16 v[48:63], v[104:107], a[48:51], v[48:63]
  ds_read_b64_tr_b16 v[92:93], v171 offset:46080
  ds_read_b64_tr_b16 v[94:95], v171 offset:46336
  v_accvgpr_read_b32 v221, a168
  buffer_store_dword v221, v174, s[8:11], s52 offen offset:128 sc1
  s_waitcnt lgkmcnt(4)
  v_mfma_f32_32x32x16_bf16 v[48:63], v[108:111], a[52:55], v[48:63]
  ds_read_b128 v[96:99], v6 offset:18432
  s_waitcnt vmcnt(13)
  ds_write_b128 v230, a[144:147]
  s_waitcnt vmcnt(12)
  ds_write_b128 v230, a[148:151] offset:1024
  s_waitcnt lgkmcnt(5)
  v_mfma_f32_32x32x16_bf16 v[48:63], v[88:91], a[56:59], v[48:63]
  ds_read_b64_tr_b16 v[212:213], v229 offset:0
  ds_read_b64_tr_b16 v[214:215], v229 offset:512
  s_waitcnt lgkmcnt(5)
  v_mfma_f32_32x32x16_bf16 v[48:63], v[92:95], a[60:63], v[48:63]
  ds_read_b64_tr_b16 v[216:217], v229 offset:1024
  ds_read_b64_tr_b16 v[218:219], v229 offset:1536
  s_waitcnt lgkmcnt(6)
  v_mfma_f32_32x32x16_bf16 v[48:63], v[96:99], v[132:135], v[48:63]
  s_waitcnt lgkmcnt(2)
  buffer_store_dwordx4 v[212:215], v1, s[8:11], s66 offen sc1
  s_waitcnt lgkmcnt(0)
  buffer_store_dwordx4 v[216:219], v1, s[8:11], s66 offen offset:1024 sc1
  s_lshl_b32 s98, s20, 11
  s_add_u32 s98, s98, 150528
  s_add_u32 s99, s98, 1024
  s_branch lay_46_2
lay_46_1:
  s_waitcnt lgkmcnt(2)
  v_mfma_f32_32x32x16_bf16 v[48:63], v[88:91], a[64:67], 0
  ds_read_b128 v[100:103], v5 offset:19456
  s_lshl_b32 s34, s25, 16
  s_lshl_b32 s17, s20, 14
  s_add_u32 s34, s34, s17
  s_add_u32 s34, s34, 1572864
  s_waitcnt lgkmcnt(2)
  v_mfma_f32_32x32x16_bf16 v[48:63], v[92:95], a[68:71], v[48:63]
  ds_read_b128 v[104:107], v5 offset:20480
  buffer_load_dwordx4 a[64:67], v10, s[8:11], s34 offen offset:0 sc1
  v_mul_u32_u24 v136, 2176, v3
  s_waitcnt lgkmcnt(2)
  v_mfma_f32_32x32x16_bf16 v[48:63], v[96:99], a[72:75], v[48:63]
  ds_read_b128 v[108:111], v5 offset:21504
  buffer_load_dwordx4 a[68:71], v11, s[8:11], s34 offen offset:0 sc1
  v_lshl_add_u32 v136, v2, 4, v136
  s_waitcnt lgkmcnt(2)
  v_mfma_f32_32x32x16_bf16 v[48:63], v[100:103], a[76:79], v[48:63]
  ds_read_b128 v[88:91], v5 offset:22528
  buffer_load_dwordx4 a[72:75], v10, s[8:11], s34 offen offset:2048 sc1
  v_lshrrev_b32 v137, 2, v0
  s_waitcnt lgkmcnt(2)
  v_mfma_f32_32x32x16_bf16 v[48:63], v[104:107], a[80:83], v[48:63]
  ds_read_b128 v[92:95], v5 offset:23552
  buffer_load_dwordx4 a[76:79], v11, s[8:11], s34 offen offset:2048 sc1
  s_add_u32 s34, s34, 4096
  s_waitcnt lgkmcnt(2)
  v_mfma_f32_32x32x16_bf16 v[48:63], v[108:111], a[84:87], v[48:63]
  ds_read_b128 v[96:99], v5 offset:24576
  buffer_load_dwordx4 a[80:83], v10, s[8:11], s34 offen offset:0 sc1
  v_mul_u32_u24 v137, 2176, v137
  s_waitcnt lgkmcnt(2)
  v_mfma_f32_32x32x16_bf16 v[48:63], v[88:91], a[88:91], v[48:63]
  ds_read_b128 v[100:103], v5 offset:25600
  buffer_load_dwordx4 a[84:87], v11, s[8:11], s34 offen offset:0 sc1
  v_and_b32 v138, 3, v0
  s_waitcnt lgkmcnt(2)
  v_mfma_f32_32x32x16_bf16 v[48:63], v[92:95], a[92:95], v[48:63]
  ds_read_b128 v[104:107], v5 offset:26624
  buffer_load_dwordx4 a[88:91], v10, s[8:11], s34 offen offset:2048 sc1
  v_lshl_add_u32 v137, v138, 3, v137
  s_waitcnt lgkmcnt(2)
  v_mfma_f32_32x32x16_bf16 v[48:63], v[96:99], a[96:99], v[48:63]
  ds_read_b128 v[108:111], v5 offset:27648
  buffer_load_dwordx4 a[92:95], v11, s[8:11], s34 offen offset:2048 sc1
  s_add_u32 s34, s34, 4096
  s_waitcnt lgkmcnt(2)
  v_mfma_f32_32x32x16_bf16 v[48:63], v[100:103], a[100:103], v[48:63]
  ds_read_b128 v[88:91], v5 offset:28672
  buffer_load_dwordx4 a[96:99], v10, s[8:11], s34 offen offset:0 sc1
  s_lshl_b32 s17, s20, 9
  s_waitcnt lgkmcnt(2)
  v_mfma_f32_32x32x16_bf16 v[48:63], v[104:107], a[104:107], v[48:63]
  ds_read_b128 v[92:95], v5 offset:29696
  buffer_load_dwordx4 a[100:103], v11, s[8:11], s34 offen offset:0 sc1
  s_add_u32 s37, s39, s17
  s_waitcnt lgkmcnt(2)
  v_mfma_f32_32x32x16_bf16 v[48:63], v[108:111], a[108:111], v[48:63]
  ds_read_b128 v[96:99], v5 offset:30720
  buffer_load_dwordx4 a[104:107], v10, s[8:11], s34 offen offset:2048 sc1
  s_lshl_b32 s17, s20, 5
  s_waitcnt lgkmcnt(2)
  v_mfma_f32_32x32x16_bf16 v[48:63], v[88:91], a[112:115], v[48:63]
  ds_read_b128 v[100:103], v5 offset:31744
  buffer_load_dwordx4 a[108:111], v11, s[8:11], s34 offen offset:2048 sc1
  s_add_u32 s34, s34, 4096
  s_waitcnt lgkmcnt(2)
  v_mfma_f32_32x32x16_bf16 v[48:63], v[92:95], a[116:119], v[48:63]
  ds_read_b128 v[104:107], v5 offset:0
  buffer_load_dwordx4 a[112:115], v10, s[8:11], s34 offen offset:0 sc1
  s_add_u32 s44, s39, s17
  s_waitcnt lgkmcnt(2)
  v_mfma_f32_32x32x16_bf16 v[48:63], v[96:99], a[120:123], v[48:63]
  ds_read_b128 v[108:111], v5 offset:1024
  buffer_load_dwordx4 a[116:119], v11, s[8:11], s34 offen offset:0 sc1
  s_lshr_b32 s16, s20, 1
  s_waitcnt lgkmcnt(2)
  v_mfma_f32_32x32x16_bf16 v[48:63], v[100:103], a[124:127], v[48:63]
  ds_read_b128 v[88:91], v5 offset:2048
  buffer_load_dwordx4 a[120:123], v10, s[8:11], s34 offen offset:2048 sc1
  s_lshl_b32 s17, s16, 6
  s_waitcnt lgkmcnt(2)
  v_mfma_f32_32x32x16_bf16 v[48:63], v[104:107], a[0:3], v[48:63]
  ds_read_b128 v[92:95], v5 offset:3072
  buffer_load_dwordx4 a[124:127], v11, s[8:11], s34 offen offset:2048 sc1
  s_add_u32 s34, s34, 4096
  s_lshl_b32 s18, s20, 9
  s_waitcnt lgkmcnt(2)
  v_mfma_f32_32x32x16_bf16 v[48:63], v[108:111], a[4:7], v[48:63]
  ds_read_b128 v[96:99], v5 offset:4096
  s_add_u32 s17, s17, s18
  s_add_u32 s17, s17, 158720
  s_waitcnt lgkmcnt(2)
  v_mfma_f32_32x32x16_bf16 v[48:63], v[88:91], a[8:11], v[48:63]
  ds_read_b128 v[100:103], v5 offset:5120
  v_lshl_add_u32 v142, v2, 4, s17
  s_mul_i32 s16, s16, 1088
  s_waitcnt lgkmcnt(2)
  v_mfma_f32_32x32x16_bf16 v[48:63], v[92:95], a[12:15], v[48:63]
  ds_read_b128 v[104:107], v5 offset:6144
  s_and_b32 s17, s20, 1
  s_lshl_b32 s17, s17, 5
  s_waitcnt lgkmcnt(2)
  v_mfma_f32_32x32x16_bf16 v[48:63], v[96:99], a[16:19], v[48:63]
  ds_read_b128 v[108:111], v5 offset:7168
  s_add_u32 s16, s16, s17
  s_add_u32 s16, s16, 159744
  s_waitcnt lgkmcnt(2)
  v_mfma_f32_32x32x16_bf16 v[48:63], v[100:103], a[20:23], v[48:63]
  ds_read_b128 v[88:91], v5 offset:8192
  v_lshl_add_u32 v143, v138, 3, s16
  s_waitcnt lgkmcnt(2)
  v_mfma_f32_32x32x16_bf16 v[48:63], v[104:107], a[24:27], v[48:63]
  ds_read_b128 v[92:95], v5 offset:9216
  v_min_u32 v138, 16, v2
  v_lshlrev_b32 v138, 6, v138
  s_waitcnt lgkmcnt(2)
  v_mfma_f32_32x32x16_bf16 v[48:63], v[108:111], a[28:31], v[48:63]
  ds_read_b128 v[96:99], v5 offset:10240
  v_lshl_add_u32 v138, v3, 5, v138
  v_add_u32 v138, 158720, v138
  s_waitcnt lgkmcnt(2)
  v_mfma_f32_32x32x16_bf16 v[48:63], v[88:91], a[32:35], v[48:63]
  ds_read_b128 v[100:103], v5 offset:11264
  s_lshr_b32 s16, s23, 1
  s_lshl_b32 s17, s16, 7
  s_waitcnt lgkmcnt(2)
  v_mfma_f32_32x32x16_bf16 v[48:63], v[92:95], a[36:39], v[48:63]
  ds_read_b128 v[104:107], v5 offset:12288
  s_lshl_b32 s16, s16, 4
  s_add_u32 s16, s16, s22
  s_waitcnt lgkmcnt(2)
  v_mfma_f32_32x32x16_bf16 v[48:63], v[96:99], a[40:43], v[48:63]
  ds_read_b128 v[108:111], v5 offset:13312
  s_mov_b32 s43, s37
  buffer_load_dwordx2 v[64:65], v137, s[8:11], s44 offen offset:2048 sc1
  buffer_load_dwordx4 v[16:19], v136, s[8:11], s43 offen sc1
  s_add_u32 s43, s43, 4352
  s_lshl_b32 s16, s16, 12
  s_and_b32 s18, s20, 1
  s_waitcnt lgkmcnt(2)
  v_mfma_f32_32x32x16_bf16 v[48:63], v[100:103], a[44:47], v[48:63]
  ds_read_b128 v[88:91], v5 offset:14336
  buffer_load_dwordx4 v[20:23], v136, s[8:11], s43 offen sc1
  s_add_u32 s43, s43, 4352
  buffer_load_dwordx4 v[24:27], v136, s[8:11], s43 offen sc1
  s_add_u32 s43, s43, 4352
  s_lshl_b32 s19, s18, 10
  s_waitcnt lgkmcnt(2)
  v_mfma_f32_32x32x16_bf16 v[48:63], v[104:107], a[48:51], v[48:63]
  ds_read_b128 v[92:95], v5 offset:15360
  buffer_load_dwordx4 v[28:31], v136, s[8:11], s43 offen sc1
  s_add_u32 s43, s43, 4352
  s_add_u32 s16, s16, s19
  s_mul_i32 s19, s26, 2097152
  s_waitcnt lgkmcnt(2)
  v_mfma_f32_32x32x16_bf16 v[48:63], v[108:111], a[52:55], v[48:63]
  ds_read_b128 v[96:99], v6 offset:18432
  buffer_load_dwordx4 v[32:35], v136, s[8:11], s43 offen sc1
  s_add_u32 s43, s43, 4352
  s_add_u32 s16, s16, s19
  s_add_u32 s45, s16, 17039360
  s_waitcnt lgkmcnt(2)
  v_mfma_f32_32x32x16_bf16 v[48:63], v[88:91], a[56:59], v[48:63]
  buffer_load_dwordx4 v[36:39], v136, s[8:11], s43 offen sc1
  s_add_u32 s43, s43, 4352
  s_lshl_b32 s19, s22, 1
  s_add_u32 s18, s18, s19
  s_waitcnt lgkmcnt(1)
  v_mfma_f32_32x32x16_bf16 v[48:63], v[92:95], a[60:63], v[48:63]
  buffer_load_dwordx4 v[40:43], v136, s[8:11], s43 offen sc1
  s_add_u32 s43, s43, 4352
  s_lshl_b32 s18, s18, 2
  s_add_u32 s47, s17, s18
  s_waitcnt lgkmcnt(0)
  v_mfma_f32_32x32x16_bf16 v[48:63], v[96:99], v[132:135], v[48:63]
  buffer_load_dwordx4 v[44:47], v136, s[8:11], s43 offen sc1
  s_add_u32 s43, s43, 4352
  s_add_u32 s46, s47, 37396480
  s_add_u32 s47, s47, 37400576
lay_46_2:
  s_nop 7
  v_pk_mul_f32 v[140:141], v[48:49], v[128:129] op_sel_hi:[1,0]
  v_pk_fma_f32 v[48:49], v[48:49], v[128:129], s[40:41] op_sel:[0,1,0] op_sel_hi:[1,1,1]
  v_exp_f32_e64 v140, v140 clamp
  v_exp_f32_e64 v141, v141 clamp
  v_max_f32 v48, s40, v48
  v_max_f32 v49, s40, v49
  v_pk_add_f32 v[48:49], v[48:49], v[140:141]
  v_cvt_pk_bf16_f32 v88, v48, v49
  v_pk_mul_f32 v[130:131], v[50:51], v[128:129] op_sel_hi:[1,0]
  v_pk_fma_f32 v[50:51], v[50:51], v[128:129], s[40:41] op_sel:[0,1,0] op_sel_hi:[1,1,1]
  v_exp_f32_e64 v130, v130 clamp
  v_exp_f32_e64 v131, v131 clamp
  v_max_f32 v50, s40, v50
  v_max_f32 v51, s40, v51
  v_pk_add_f32 v[50:51], v[50:51], v[130:131]
  v_cvt_pk_bf16_f32 v89, v50, v51
  v_pk_mul_f32 v[140:141], v[52:53], v[128:129] op_sel_hi:[1,0]
  v_pk_fma_f32 v[52:53], v[52:53], v[128:129], s[40:41] op_sel:[0,1,0] op_sel_hi:[1,1,1]
  v_exp_f32_e64 v140, v140 clamp
  v_exp_f32_e64 v141, v141 clamp
  v_max_f32 v52, s40, v52
  v_max_f32 v53, s40, v53
  v_pk_add_f32 v[52:53], v[52:53], v[140:141]
  v_cvt_pk_bf16_f32 v90, v52, v53
  v_pk_mul_f32 v[130:131], v[54:55], v[128:129] op_sel_hi:[1,0]
  v_pk_fma_f32 v[54:55], v[54:55], v[128:129], s[40:41] op_sel:[0,1,0] op_sel_hi:[1,1,1]
  v_exp_f32_e64 v130, v130 clamp
  v_exp_f32_e64 v131, v131 clamp
  v_max_f32 v54, s40, v54
  v_max_f32 v55, s40, v55
  v_pk_add_f32 v[54:55], v[54:55], v[130:131]
  v_cvt_pk_bf16_f32 v91, v54, v55
  v_pk_mul_f32 v[140:141], v[56:57], v[128:129] op_sel_hi:[1,0]
  v_pk_fma_f32 v[56:57], v[56:57], v[128:129], s[40:41] op_sel:[0,1,0] op_sel_hi:[1,1,1]
  v_exp_f32_e64 v140, v140 clamp
  v_exp_f32_e64 v141, v141 clamp
  v_max_f32 v56, s40, v56
  v_max_f32 v57, s40, v57
  v_pk_add_f32 v[56:57], v[56:57], v[140:141]
  v_cvt_pk_bf16_f32 v92, v56, v57
  v_pk_mul_f32 v[130:131], v[58:59], v[128:129] op_sel_hi:[1,0]
  v_pk_fma_f32 v[58:59], v[58:59], v[128:129], s[40:41] op_sel:[0,1,0] op_sel_hi:[1,1,1]
  v_exp_f32_e64 v130, v130 clamp
  v_exp_f32_e64 v131, v131 clamp
  v_max_f32 v58, s40, v58
  v_max_f32 v59, s40, v59
  v_pk_add_f32 v[58:59], v[58:59], v[130:131]
  v_cvt_pk_bf16_f32 v93, v58, v59
  v_pk_mul_f32 v[140:141], v[60:61], v[128:129] op_sel_hi:[1,0]
  v_pk_fma_f32 v[60:61], v[60:61], v[128:129], s[40:41] op_sel:[0,1,0] op_sel_hi:[1,1,1]
  v_exp_f32_e64 v140, v140 clamp
  v_exp_f32_e64 v141, v141 clamp
  v_max_f32 v60, s40, v60
  v_max_f32 v61, s40, v61
  v_pk_add_f32 v[60:61], v[60:61], v[140:141]
  v_cvt_pk_bf16_f32 v94, v60, v61
  v_pk_mul_f32 v[130:131], v[62:63], v[128:129] op_sel_hi:[1,0]
  v_pk_fma_f32 v[62:63], v[62:63], v[128:129], s[40:41] op_sel:[0,1,0] op_sel_hi:[1,1,1]
  v_exp_f32_e64 v130, v130 clamp
  v_exp_f32_e64 v131, v131 clamp
  v_max_f32 v62, s40, v62
  v_max_f32 v63, s40, v63
  v_pk_add_f32 v[62:63], v[62:63], v[130:131]
  v_cvt_pk_bf16_f32 v95, v62, v63
  s_cmp_lg_u32 s26, 0
  s_cbranch_scc1 lay_47
  s_mov_b32 s43, s37
  buffer_load_dwordx2 v[64:65], v137, s[8:11], s44 offen offset:2048 sc1
  buffer_load_dwordx4 v[16:19], v136, s[8:11], s43 offen sc1
  s_add_u32 s43, s43, 4352
  buffer_load_dwordx4 v[20:23], v136, s[8:11], s43 offen sc1
  s_add_u32 s43, s43, 4352
  buffer_load_dwordx4 v[24:27], v136, s[8:11], s43 offen sc1
  s_add_u32 s43, s43, 4352
  buffer_load_dwordx4 v[28:31], v136, s[8:11], s43 offen sc1
  s_add_u32 s43, s43, 4352
  buffer_load_dwordx4 v[32:35], v136, s[8:11], s43 offen sc1
  s_add_u32 s43, s43, 4352
  buffer_load_dwordx4 v[36:39], v136, s[8:11], s43 offen sc1
  s_add_u32 s43, s43, 4352
  buffer_load_dwordx4 v[40:43], v136, s[8:11], s43 offen sc1
  s_add_u32 s43, s43, 4352
  buffer_load_dwordx4 v[44:47], v136, s[8:11], s43 offen sc1
lay_47:
  s_cmp_lg_u32 s26, 0
  s_cbranch_scc1 lay_48
  s_waitcnt vmcnt(9)
  s_barrier
  s_cmp_lg_u32 s20, 0
  s_cbranch_scc1 arr_49
  v_mov_b32 v14, 1
  s_mov_b64 exec, 1
  buffer_atomic_add v14, v13, s[8:11], s33 offen offset:128 sc1
  s_mov_b64 exec, -1
arr_49:
lay_48:
  s_waitcnt vmcnt(8)
  v_max_u32 v66, v64, v65
  s_waitcnt vmcnt(7)
  v_max3_u32 v66, v66, v16, v17
  v_max3_u32 v66, v66, v18, v19
  s_waitcnt vmcnt(6)
  v_max3_u32 v66, v66, v20, v21
  v_max3_u32 v66, v66, v22, v23
  s_waitcnt vmcnt(5)
  v_max3_u32 v66, v66, v24, v25
  v_max3_u32 v66, v66, v26, v27
  s_waitcnt vmcnt(4)
  v_max3_u32 v66, v66, v28, v29
  v_max3_u32 v66, v66, v30, v31
  s_waitcnt vmcnt(3)
  v_max3_u32 v66, v66, v32, v33
  v_max3_u32 v66, v66, v34, v35
  s_waitcnt vmcnt(2)
  v_max3_u32 v66, v66, v36, v37
  v_max3_u32 v66, v66, v38, v39
  s_waitcnt vmcnt(1)
  v_max3_u32 v66, v66, v40, v41
  v_max3_u32 v66, v66, v42, v43
  s_waitcnt vmcnt(0)
  v_max3_u32 v66, v66, v44, v45
  v_max3_u32 v66, v66, v46, v47
  v_cmp_eq_u32 vcc, -1, v66
  s_mov_b32 s58, 0
  s_cbranch_vccz L_safe_kvx
L_safe_kvr:
  s_mov_b32 s43, s37
  buffer_load_dwordx2 v[64:65], v137, s[8:11], s44 offen offset:2048 sc1
  buffer_load_dwordx4 v[16:19], v136, s[8:11], s43 offen sc1
  s_add_u32 s43, s43, 4352
  buffer_load_dwordx4 v[20:23], v136, s[8:11], s43 offen sc1
  s_add_u32 s43, s43, 4352
  buffer_load_dwordx4 v[24:27], v136, s[8:11], s43 offen sc1
  s_add_u32 s43, s43, 4352
  buffer_load_dwordx4 v[28:31], v136, s[8:11], s43 offen sc1
  s_add_u32 s43, s43, 4352
  buffer_load_dwordx4 v[32:35], v136, s[8:11], s43 offen sc1
  s_add_u32 s43, s43, 4352
  buffer_load_dwordx4 v[36:39], v136, s[8:11], s43 offen sc1
  s_add_u32 s43, s43, 4352
  buffer_load_dwordx4 v[40:43], v136, s[8:11], s43 offen sc1
  s_add_u32 s43, s43, 4352
  buffer_load_dwordx4 v[44:47], v136, s[8:11], s43 offen sc1
  s_add_u32 s58, s58, 1
  s_waitcnt vmcnt(8)
  v_max_u32 v66, v64, v65
  s_waitcnt vmcnt(7)
  v_max3_u32 v66, v66, v16, v17
  v_max3_u32 v66, v66, v18, v19
  s_waitcnt vmcnt(6)
  v_max3_u32 v66, v66, v20, v21
  v_max3_u32 v66, v66, v22, v23
  s_waitcnt vmcnt(5)
  v_max3_u32 v66, v66, v24, v25
  v_max3_u32 v66, v66, v26, v27
  s_waitcnt vmcnt(4)
  v_max3_u32 v66, v66, v28, v29
  v_max3_u32 v66, v66, v30, v31
  s_waitcnt vmcnt(3)
  v_max3_u32 v66, v66, v32, v33
  v_max3_u32 v66, v66, v34, v35
  s_waitcnt vmcnt(2)
  v_max3_u32 v66, v66, v36, v37
  v_max3_u32 v66, v66, v38, v39
  s_waitcnt vmcnt(1)
  v_max3_u32 v66, v66, v40, v41
  v_max3_u32 v66, v66, v42, v43
  s_waitcnt vmcnt(0)
  v_max3_u32 v66, v66, v44, v45
  v_max3_u32 v66, v66, v46, v47
  v_cmp_eq_u32 vcc, -1, v66
  s_cmp_gt_u32 s58, 0x100000
  s_cbranch_scc1 L_safe_kvx
  s_cbranch_vccnz L_safe_kvr
L_safe_kvx:
  s_cmp_lg_u32 s26, 0
  s_cbranch_scc1 lay_50_1
  buffer_load_dwordx4 a[80:83], v10, s[8:11], s34 offen offset:0 sc1
  buffer_load_dwordx4 a[84:87], v11, s[8:11], s34 offen offset:0 sc1
  buffer_load_dwordx4 a[88:91], v10, s[8:11], s34 offen offset:2048 sc1
  buffer_load_dwordx4 a[92:95], v11, s[8:11], s34 offen offset:2048 sc1
  s_add_u32 s34, s34, 4096
  buffer_load_dwordx4 a[96:99], v10, s[8:11], s34 offen offset:0 sc1
  buffer_load_dwordx4 a[100:103], v11, s[8:11], s34 offen offset:0 sc1
  buffer_load_dwordx4 a[104:107], v10, s[8:11], s34 offen offset:2048 sc1
  buffer_load_dwordx4 a[108:111], v11, s[8:11], s34 offen offset:2048 sc1
  s_add_u32 s34, s34, 4096
  buffer_load_dwordx4 a[112:115], v10, s[8:11], s34 offen offset:0 sc1
  buffer_load_dwordx4 a[116:119], v11, s[8:11], s34 offen offset:0 sc1
  buffer_load_dwordx4 a[120:123], v10, s[8:11], s34 offen offset:2048 sc1
  buffer_load_dwordx4 a[124:127], v11, s[8:11], s34 offen offset:2048 sc1
  s_add_u32 s34, s34, 4096
  s_branch lay_50_2
lay_50_1:
  s_add_u32 m0, s31, 0
  s_nop 0
  buffer_load_dwordx4 v1, s[8:11], s32 offen offset:0 sc1 lds
  s_add_u32 m0, s31, 0
  s_nop 0
  buffer_load_dwordx4 v1, s[8:11], s32 offen offset:1024 sc1 lds
  s_add_u32 m0, s31, 0
  s_nop 0
  buffer_load_dwordx4 v1, s[8:11], s32 offen offset:2048 sc1 lds
  s_add_u32 m0, s31, 0
  s_nop 0
  buffer_load_dwordx4 v1, s[8:11], s32 offen offset:3072 sc1 lds
  s_add_u32 s32, s32, 16384
  s_add_u32 m0, s31, 16384
  s_nop 0
  buffer_load_dwordx4 v1, s[8:11], s32 offen offset:0 sc1 lds
  s_add_u32 m0, s31, 16384
  s_nop 0
  buffer_load_dwordx4 v1, s[8:11], s32 offen offset:1024 sc1 lds
  s_add_u32 m0, s31, 16384
  s_nop 0
  buffer_load_dwordx4 v1, s[8:11], s32 offen offset:2048 sc1 lds
  s_add_u32 m0, s31, 16384
  s_nop 0
  buffer_load_dwordx4 v1, s[8:11], s32 offen offset:3072 sc1 lds
  s_add_u32 s32, s32, 16384
lay_50_2:
  v_add_f32_dpp v64, v64, v64 row_ror:4 row_mask:0xf bank_mask:0xf
  v_add_f32_dpp v65, v65, v65 row_ror:4 row_mask:0xf bank_mask:0xf
  v_pk_add_f32 v[16:17], v[16:17], v[20:21]
  v_pk_add_f32 v[18:19], v[18:19], v[22:23]
  v_add_f32_dpp v64, v64, v64 row_ror:8 row_mask:0xf bank_mask:0xf
  v_add_f32_dpp v65, v65, v65 row_ror:8 row_mask:0xf bank_mask:0xf
  v_pk_add_f32 v[16:17], v[16:17], v[24:25]
  v_pk_add_f32 v[18:19], v[18:19], v[26:27]
  v_mov_b32 v66, v64
  v_mov_b32 v67, v65
  v_pk_add_f32 v[16:17], v[16:17], v[28:29]
  v_pk_add_f32 v[18:19], v[18:19], v[30:31]
  v_permlane16_swap_b32 v66, v64
  v_permlane16_swap_b32 v67, v65
  v_pk_add_f32 v[64:65], v[66:67], v[64:65]
  v_pk_add_f32 v[16:17], v[16:17], v[32:33]
  v_pk_add_f32 v[18:19], v[18:19], v[34:35]
  v_mov_b32 v66, v64
  v_mov_b32 v67, v65
  v_pk_add_f32 v[16:17], v[16:17], v[36:37]
  v_pk_add_f32 v[18:19], v[18:19], v[38:39]
  v_permlane32_swap_b32 v66, v64
  v_permlane32_swap_b32 v67, v65
  v_pk_add_f32 v[64:65], v[66:67], v[64:65]
  v_pk_add_f32 v[16:17], v[16:17], v[40:41]
  v_pk_add_f32 v[18:19], v[18:19], v[42:43]
  ds_write_b64 v143, v[64:65]
  v_pk_add_f32 v[16:17], v[16:17], v[44:45]
  v_pk_add_f32 v[18:19], v[18:19], v[46:47]
  v_mov_b32 v20, v16
  v_mov_b32 v21, v17
  v_mov_b32 v22, v18
  v_mov_b32 v23, v19
  v_permlane32_swap_b32 v20, v16
  v_permlane32_swap_b32 v21, v17
  v_permlane32_swap_b32 v22, v18
  v_permlane32_swap_b32 v23, v19
  v_pk_add_f32 v[16:17], v[20:21], v[16:17]
  v_pk_add_f32 v[18:19], v[22:23], v[18:19]
  ds_write_b128 v142, v[16:19]
  s_waitcnt lgkmcnt(0)
  s_barrier
  ds_read_b128 v[16:19], v138 offset:0
  ds_read_b128 v[20:23], v138 offset:16
  ds_read_b128 v[24:27], v138 offset:1088
  ds_read_b128 v[28:31], v138 offset:1104
  s_waitcnt lgkmcnt(3)
  v_cvt_pk_bf16_f32 v16, v16, v17
  v_cvt_pk_bf16_f32 v17, v18, v19
  s_waitcnt lgkmcnt(2)
  v_cvt_pk_bf16_f32 v18, v20, v21
  v_cvt_pk_bf16_f32 v19, v22, v23
  s_nop 1
  v_mfma_f32_32x32x16_bf16 v[32:47], v[16:19], v[88:91], 0
  s_waitcnt lgkmcnt(1)
  v_cvt_pk_bf16_f32 v24, v24, v25
  v_cvt_pk_bf16_f32 v25, v26, v27
  s_waitcnt lgkmcnt(0)
  v_cvt_pk_bf16_f32 v26, v28, v29
  v_cvt_pk_bf16_f32 v27, v30, v31
  s_nop 1
  v_mfma_f32_32x32x16_bf16 v[48:63], v[24:27], v[92:95], 0
  s_lshl_b32 s16, s24, 7
  s_lshl_b32 s17, s20, 5
  s_add_u32 s51, s16, s17
  s_add_u32 s55, s51, 37396480
  s_add_u32 s51, s51, 37400576
  v_and_b32 v7, 7, v0
  v_lshlrev_b32 v139, 2, v7
  s_lshl_b32 s56, s26, 1
  s_add_u32 s56, s56, 1
  v_add_f32 v130, s40, v40
  v_rcp_f32 v130, v130
  s_nop 0
  v_pk_mul_f32 v[32:33], v[32:33], v[130:131] op_sel_hi:[1,0]
  v_pk_mul_f32 v[34:35], v[34:35], v[130:131] op_sel_hi:[1,0]
  v_pk_mul_f32 v[36:37], v[36:37], v[130:131] op_sel_hi:[1,0]
  v_pk_mul_f32 v[38:39], v[38:39], v[130:131] op_sel_hi:[1,0]
  v_cvt_pk_bf16_f32 v96, v32, v33
  v_cvt_pk_bf16_f32 v97, v34, v35
  v_cvt_pk_bf16_f32 v98, v36, v37
  v_cvt_pk_bf16_f32 v99, v38, v39
  buffer_store_dwordx4 v[96:99], v1, s[8:11], s45 offen offset:0 sc1
  v_add_f32 v130, s40, v56
  v_rcp_f32 v130, v130
  s_nop 0
  v_pk_mul_f32 v[48:49], v[48:49], v[130:131] op_sel_hi:[1,0]
  v_pk_mul_f32 v[50:51], v[50:51], v[130:131] op_sel_hi:[1,0]
  v_pk_mul_f32 v[52:53], v[52:53], v[130:131] op_sel_hi:[1,0]
  v_pk_mul_f32 v[54:55], v[54:55], v[130:131] op_sel_hi:[1,0]
  v_cvt_pk_bf16_f32 v100, v48, v49
  v_cvt_pk_bf16_f32 v101, v50, v51
  v_cvt_pk_bf16_f32 v102, v52, v53
  v_cvt_pk_bf16_f32 v103, v54, v55
  buffer_store_dwordx4 v[100:103], v1, s[8:11], s45 offen offset:2048 sc1
  s_lshl_b32 s34, s24, 16
  s_lshl_b32 s17, s20, 14
  s_add_u32 s34, s34, s17
  s_mul_i32 s17, s26, 2097152
  s_add_u32 s34, s34, s17
  s_add_u32 s34, s34, 17039360
  s_waitcnt vmcnt(0)
  v_mov_b32 v14, s56
  s_mov_b64 exec, 1
  buffer_store_dword v14, v13, s[8:11], s46 offen sc1
  s_mov_b64 exec, -1
  s_mul_i32 s48, s26, 4194304
  s_add_u32 s48, s48, s28
  s_add_u32 s48, s48, 9699328
  s_mul_i32 s49, s26, 524288
  s_add_u32 s49, s49, s29
  s_add_u32 s49, s49, 16252928
  s_mul_i32 s50, s26, 48
  s_add_u32 s50, s50, 48
  s_lshl_b32 s42, s23, 7
  s_add_u32 s42, s42, 37388288
  v_and_b32 v138, 15, v0
  v_lshlrev_b32 v138, 2, v138
  s_cmp_lg_u32 s26, 0
  s_cbranch_scc1 lay_51_1
  buffer_load_dword v234, v233, s[8:11], s96 offen sc1
  s_branch lay_51_2
lay_51_1:
lay_51_2:
  s_mov_b32 s58, 0
poll_52:
  buffer_load_dword v14, v139, s[8:11], s55 offen sc1
  s_waitcnt vmcnt(0)
  v_cmp_gt_u32 vcc, s56, v14
  s_add_u32 s58, s58, 1
  s_cmp_gt_u32 s58, 0x200000
  s_cbranch_scc1 poll_52_x
  s_cbranch_vccnz poll_52
poll_52_x:
  s_add_u32 s16, s34, 0
  buffer_load_dwordx4 a[0:3], v8, s[8:11], s16 offen offset:0 sc1
  buffer_load_dwordx4 a[4:7], v9, s[8:11], s16 offen offset:0 sc1
  buffer_load_dwordx4 a[8:11], v8, s[8:11], s16 offen offset:2048 sc1
  buffer_load_dwordx4 a[12:15], v9, s[8:11], s16 offen offset:2048 sc1
  s_add_u32 s16, s34, 4096
  buffer_load_dwordx4 a[16:19], v8, s[8:11], s16 offen offset:0 sc1
  buffer_load_dwordx4 a[20:23], v9, s[8:11], s16 offen offset:0 sc1
  buffer_load_dwordx4 a[24:27], v8, s[8:11], s16 offen offset:2048 sc1
  buffer_load_dwordx4 a[28:31], v9, s[8:11], s16 offen offset:2048 sc1
  s_add_u32 s16, s34, 8192
  buffer_load_dwordx4 a[32:35], v8, s[8:11], s16 offen offset:0 sc1
  buffer_load_dwordx4 a[36:39], v9, s[8:11], s16 offen offset:0 sc1
  buffer_load_dwordx4 a[40:43], v8, s[8:11], s16 offen offset:2048 sc1
  buffer_load_dwordx4 a[44:47], v9, s[8:11], s16 offen offset:2048 sc1
  s_add_u32 s16, s34, 12288
  buffer_load_dwordx4 a[48:51], v8, s[8:11], s16 offen offset:0 sc1
  buffer_load_dwordx4 a[52:55], v9, s[8:11], s16 offen offset:0 sc1
  buffer_load_dwordx4 a[56:59], v8, s[8:11], s16 offen offset:2048 sc1
  buffer_load_dwordx4 a[60:63], v9, s[8:11], s16 offen offset:2048 sc1
  s_cmp_lg_u32 s26, 0
  s_cbranch_scc1 lay_53
  v_cmp_gt_u32 vcc, 16, v234
  s_nop 0
  s_cbranch_vccz poll_54_x
  s_mov_b32 s58, 0
poll_54:
  buffer_load_dword v234, v233, s[8:11], s96 offen sc1
  s_waitcnt vmcnt(0)
  v_cmp_gt_u32 vcc, 16, v234
  s_add_u32 s58, s58, 1
  s_cmp_gt_u32 s58, 0x200000
  s_cbranch_scc1 poll_54_x
  s_cbranch_vccnz poll_54
poll_54_x:
  s_add_u32 m0, s31, 0
  s_nop 0
  buffer_load_dwordx4 v1, s[8:11], s32 offen offset:0 sc1 lds
  buffer_load_dwordx4 v1, s[8:11], s32 offen offset:1024 sc1 lds
  buffer_load_dwordx4 v1, s[8:11], s32 offen offset:2048 sc1 lds
  buffer_load_dwordx4 v1, s[8:11], s32 offen offset:3072 sc1 lds
  s_add_u32 s32, s32, 16384
  s_add_u32 m0, s31, 16384
  s_nop 0
  buffer_load_dwordx4 v1, s[8:11], s32 offen offset:0 sc1 lds
  buffer_load_dwordx4 v1, s[8:11], s32 offen offset:1024 sc1 lds
  buffer_load_dwordx4 v1, s[8:11], s32 offen offset:2048 sc1 lds
  buffer_load_dwordx4 v1, s[8:11], s32 offen offset:3072 sc1 lds
  s_add_u32 s32, s32, 16384
lay_53:
  s_xor_b32 s16, s20, 3
  s_mul_i32 s16, s16, 12288
  s_add_u32 s16, s16, 106496
  v_add_u32 v95, s16, v1
  s_xor_b32 s16, s20, 2
  s_mul_i32 s16, s16, 12288
  s_add_u32 s16, s16, 102400
  v_add_u32 v94, s16, v1
  s_xor_b32 s16, s20, 1
  s_mul_i32 s16, s16, 12288
  s_add_u32 s16, s16, 98304
  v_add_u32 v93, s16, v1
  s_mul_i32 s16, s20, 12288
  s_add_u32 s16, s16, 98304
  v_add_u32 v92, s16, v1
  s_mov_b32 s17, 0xffff0000
  v_lshlrev_b32 v96, 16, v80
  v_and_b32 v97, s17, v80
  v_lshlrev_b32 v98, 16, v81
  v_and_b32 v99, s17, v81
  v_lshlrev_b32 v100, 16, v82
  v_and_b32 v101, s17, v82
  v_lshlrev_b32 v102, 16, v83
  v_and_b32 v103, s17, v83
  v_lshlrev_b32 v104, 16, v84
  v_and_b32 v105, s17, v84
  v_lshlrev_b32 v106, 16, v85
  v_and_b32 v107, s17, v85
  v_lshlrev_b32 v108, 16, v86
  v_and_b32 v109, s17, v86
  v_lshlrev_b32 v110, 16, v87
  v_and_b32 v111, s17, v87
  s_waitcnt vmcnt(14)
  v_mfma_f32_32x32x16_bf16 v[64:79], a[68:71], a[4:7], 0
  v_mfma_f32_32x32x16_bf16 v[48:63], a[64:67], a[4:7], 0
  v_mfma_f32_32x32x16_bf16 v[32:47], a[68:71], a[0:3], 0
  v_mfma_f32_32x32x16_bf16 v[16:31], a[64:67], a[0:3], 0
  s_waitcnt vmcnt(12)
  v_mfma_f32_32x32x16_bf16 v[64:79], a[76:79], a[12:15], v[64:79]
  v_mfma_f32_32x32x16_bf16 v[48:63], a[72:75], a[12:15], v[48:63]
  v_mfma_f32_32x32x16_bf16 v[32:47], a[76:79], a[8:11], v[32:47]
  v_mfma_f32_32x32x16_bf16 v[16:31], a[72:75], a[8:11], v[16:31]
  s_waitcnt vmcnt(10)
  v_mfma_f32_32x32x16_bf16 v[64:79], a[84:87], a[20:23], v[64:79]
  v_mfma_f32_32x32x16_bf16 v[48:63], a[80:83], a[20:23], v[48:63]
  v_mfma_f32_32x32x16_bf16 v[32:47], a[84:87], a[16:19], v[32:47]
  v_mfma_f32_32x32x16_bf16 v[16:31], a[80:83], a[16:19], v[16:31]
  s_waitcnt vmcnt(8)
  v_mfma_f32_32x32x16_bf16 v[64:79], a[92:95], a[28:31], v[64:79]
  v_mfma_f32_32x32x16_bf16 v[48:63], a[88:91], a[28:31], v[48:63]
  v_mfma_f32_32x32x16_bf16 v[32:47], a[92:95], a[24:27], v[32:47]
  v_mfma_f32_32x32x16_bf16 v[16:31], a[88:91], a[24:27], v[16:31]
  s_waitcnt vmcnt(6)
  v_mfma_f32_32x32x16_bf16 v[64:79], a[100:103], a[36:39], v[64:79]
  s_add_u32 m0, s31, 32768
  s_nop 0
  buffer_load_dwordx4 v1, s[8:11], s32 offen offset:0 sc1 lds
  s_waitcnt vmcnt(5)
  v_mfma_f32_32x32x16_bf16 v[64:79], a[108:111], a[44:47], v[64:79]
  buffer_load_dwordx4 v1, s[8:11], s32 offen offset:1024 sc1 lds
  s_waitcnt vmcnt(4)
  v_mfma_f32_32x32x16_bf16 v[64:79], a[116:119], a[52:55], v[64:79]
  buffer_load_dwordx4 v1, s[8:11], s32 offen offset:2048 sc1 lds
  s_waitcnt vmcnt(3)
  v_mfma_f32_32x32x16_bf16 v[64:79], a[124:127], a[60:63], v[64:79]
  buffer_load_dwordx4 v1, s[8:11], s32 offen offset:3072 sc1 lds
  s_add_u32 s32, s32, 16384
  v_mfma_f32_32x32x16_bf16 v[48:63], a[96:99], a[36:39], v[48:63]
  s_add_u32 m0, s31, 49152
  s_nop 0
  buffer_load_dwordx4 v1, s[8:11], s32 offen offset:0 sc1 lds
  v_mfma_f32_32x32x16_bf16 v[48:63], a[104:107], a[44:47], v[48:63]
  buffer_load_dwordx4 v1, s[8:11], s32 offen offset:1024 sc1 lds
  s_nop 3
  ds_write_b128 v95, v[64:67] offset:0
  ds_write_b128 v95, v[68:71] offset:1024
  v_mfma_f32_32x32x16_bf16 v[48:63], a[112:115], a[52:55], v[48:63]
  buffer_load_dwordx4 v1, s[8:11], s32 offen offset:2048 sc1 lds
  ds_write_b128 v95, v[72:75] offset:2048
  v_mfma_f32_32x32x16_bf16 v[48:63], a[120:123], a[60:63], v[48:63]
  buffer_load_dwordx4 v1, s[8:11], s32 offen offset:3072 sc1 lds
  s_add_u32 s32, s32, 16384
  ds_write_b128 v95, v[76:79] offset:3072
  v_mfma_f32_32x32x16_bf16 v[32:47], a[100:103], a[32:35], v[32:47]
  s_add_u32 m0, s31, 65536
  s_nop 0
  buffer_load_dwordx4 v1, s[8:11], s32 offen offset:0 sc1 lds
  v_mfma_f32_32x32x16_bf16 v[32:47], a[108:111], a[40:43], v[32:47]
  buffer_load_dwordx4 v1, s[8:11], s32 offen offset:1024 sc1 lds
  s_nop 2
  ds_write_b128 v94, v[48:51] offset:0
  ds_write_b128 v94, v[52:55] offset:1024
  v_mfma_f32_32x32x16_bf16 v[32:47], a[116:119], a[48:51], v[32:47]
  buffer_load_dwordx4 v1, s[8:11], s32 offen offset:2048 sc1 lds
  ds_write_b128 v94, v[56:59] offset:2048
  v_mfma_f32_32x32x16_bf16 v[32:47], a[124:127], a[56:59], v[32:47]
  buffer_load_dwordx4 v1, s[8:11], s32 offen offset:3072 sc1 lds
  s_add_u32 s32, s32, 16384
  ds_write_b128 v94, v[60:63] offset:3072
  v_mfma_f32_32x32x16_bf16 v[16:31], a[96:99], a[32:35], v[16:31]
  v_mfma_f32_32x32x16_bf16 v[16:31], a[104:107], a[40:43], v[16:31]
  s_nop 6
  ds_write_b128 v93, v[32:35] offset:0
  ds_write_b128 v93, v[36:39] offset:1024
  v_mfma_f32_32x32x16_bf16 v[16:31], a[112:115], a[48:51], v[16:31]
  ds_write_b128 v93, v[40:43] offset:2048
  v_mfma_f32_32x32x16_bf16 v[16:31], a[120:123], a[56:59], v[16:31]
  ds_write_b128 v93, v[44:47] offset:3072
L_safe_k2ok:
  s_waitcnt lgkmcnt(0)
  s_barrier
  ds_read_b128 v[32:35], v92 offset:0
  ds_read_b128 v[48:51], v92 offset:4096
  ds_read_b128 v[64:67], v92 offset:8192
  ds_read_b128 v[36:39], v92 offset:1024
  ds_read_b128 v[52:55], v92 offset:5120
  ds_read_b128 v[68:71], v92 offset:9216
  ds_read_b128 v[40:43], v92 offset:2048
  ds_read_b128 v[56:59], v92 offset:6144
  ds_read_b128 v[72:75], v92 offset:10240
  ds_read_b128 v[44:47], v92 offset:3072
  ds_read_b128 v[60:63], v92 offset:7168
  ds_read_b128 v[76:79], v92 offset:11264
  s_add_u32 m0, s31, 81920
  s_nop 0
  buffer_load_dwordx4 v1, s[8:11], s32 offen offset:0 sc1 lds
  buffer_load_dwordx4 v1, s[8:11], s32 offen offset:1024 sc1 lds
  buffer_load_dwordx4 v1, s[8:11], s32 offen offset:2048 sc1 lds
  buffer_load_dwordx4 v1, s[8:11], s32 offen offset:3072 sc1 lds
  s_add_u32 s32, s32, 16384
  v_pk_add_f32 v[16:17], v[16:17], v[96:97]
  v_pk_add_f32 v[18:19], v[18:19], v[98:99]
  v_pk_add_f32 v[20:21], v[20:21], v[100:101]
  v_pk_add_f32 v[22:23], v[22:23], v[102:103]
  v_pk_add_f32 v[24:25], v[24:25], v[104:105]
  v_pk_add_f32 v[26:27], v[26:27], v[106:107]
  v_pk_add_f32 v[28:29], v[28:29], v[108:109]
  v_pk_add_f32 v[30:31], v[30:31], v[110:111]
  s_waitcnt lgkmcnt(11)
  v_pk_add_f32 v[16:17], v[16:17], v[32:33]
  v_pk_add_f32 v[18:19], v[18:19], v[34:35]
  s_waitcnt lgkmcnt(10)
  v_pk_add_f32 v[16:17], v[16:17], v[48:49]
  v_pk_add_f32 v[18:19], v[18:19], v[50:51]
  s_waitcnt lgkmcnt(9)
  v_pk_add_f32 v[16:17], v[16:17], v[64:65]
  v_pk_add_f32 v[18:19], v[18:19], v[66:67]
  v_cvt_pk_bf16_f32 v80, v16, v17
  v_cvt_pk_bf16_f32 v81, v18, v19
  s_waitcnt lgkmcnt(8)
  v_pk_add_f32 v[20:21], v[20:21], v[36:37]
  v_pk_add_f32 v[22:23], v[22:23], v[38:39]
  s_waitcnt lgkmcnt(7)
  v_pk_add_f32 v[20:21], v[20:21], v[52:53]
  v_pk_add_f32 v[22:23], v[22:23], v[54:55]
  s_waitcnt lgkmcnt(6)
  v_pk_add_f32 v[20:21], v[20:21], v[68:69]
  v_pk_add_f32 v[22:23], v[22:23], v[70:71]
  v_cvt_pk_bf16_f32 v82, v20, v21
  v_cvt_pk_bf16_f32 v83, v22, v23
  buffer_store_dwordx4 v[80:83], v1, s[8:11], s48 offen offset:0 sc1
  s_waitcnt lgkmcnt(5)
  v_pk_add_f32 v[24:25], v[24:25], v[40:41]
  v_pk_add_f32 v[26:27], v[26:27], v[42:43]
  s_waitcnt lgkmcnt(4)
  v_pk_add_f32 v[24:25], v[24:25], v[56:57]
  v_pk_add_f32 v[26:27], v[26:27], v[58:59]
  s_waitcnt lgkmcnt(3)
  v_pk_add_f32 v[24:25], v[24:25], v[72:73]
  v_pk_add_f32 v[26:27], v[26:27], v[74:75]
  v_cvt_pk_bf16_f32 v84, v24, v25
  v_cvt_pk_bf16_f32 v85, v26, v27
  s_waitcnt lgkmcnt(2)
  v_pk_add_f32 v[28:29], v[28:29], v[44:45]
  v_pk_add_f32 v[30:31], v[30:31], v[46:47]
  s_waitcnt lgkmcnt(1)
  v_pk_add_f32 v[28:29], v[28:29], v[60:61]
  v_pk_add_f32 v[30:31], v[30:31], v[62:63]
  s_waitcnt lgkmcnt(0)
  v_pk_add_f32 v[28:29], v[28:29], v[76:77]
  v_pk_add_f32 v[30:31], v[30:31], v[78:79]
  v_cvt_pk_bf16_f32 v86, v28, v29
  v_cvt_pk_bf16_f32 v87, v30, v31
  buffer_store_dwordx4 v[84:87], v1, s[8:11], s48 offen offset:1024 sc1
  v_pk_add_f32 v[112:113], v[16:17], v[18:19]
  v_pk_add_f32 v[114:115], v[20:21], v[22:23]
  v_pk_add_f32 v[112:113], v[112:113], v[24:25]
  v_pk_add_f32 v[114:115], v[114:115], v[26:27]
  v_pk_add_f32 v[112:113], v[112:113], v[28:29]
  v_pk_add_f32 v[114:115], v[114:115], v[30:31]
  v_pk_add_f32 v[112:113], v[112:113], v[114:115]
  v_add_f32 v112, v112, v113
  v_mov_b32 v114, v112
  s_nop 1
  v_permlane32_swap_b32 v114, v112
  v_add_f32 v112, v114, v112
  v_mul_f32 v112, 0x3d000000, v112
  v_pk_add_f32 v[16:17], v[16:17], v[112:113] op_sel_hi:[1,0] neg_lo:[0,1] neg_hi:[0,1]
  v_pk_add_f32 v[18:19], v[18:19], v[112:113] op_sel_hi:[1,0] neg_lo:[0,1] neg_hi:[0,1]
  v_pk_add_f32 v[20:21], v[20:21], v[112:113] op_sel_hi:[1,0] neg_lo:[0,1] neg_hi:[0,1]
  v_pk_add_f32 v[22:23], v[22:23], v[112:113] op_sel_hi:[1,0] neg_lo:[0,1] neg_hi:[0,1]
  v_pk_add_f32 v[24:25], v[24:25], v[112:113] op_sel_hi:[1,0] neg_lo:[0,1] neg_hi:[0,1]
  v_pk_add_f32 v[26:27], v[26:27], v[112:113] op_sel_hi:[1,0] neg_lo:[0,1] neg_hi:[0,1]
  v_pk_add_f32 v[28:29], v[28:29], v[112:113] op_sel_hi:[1,0] neg_lo:[0,1] neg_hi:[0,1]
  v_pk_add_f32 v[30:31], v[30:31], v[112:113] op_sel_hi:[1,0] neg_lo:[0,1] neg_hi:[0,1]
  v_pk_mul_f32 v[114:115], v[16:17], v[16:17]
  v_pk_mul_f32 v[16:17], v[18:19], v[18:19]
  v_pk_fma_f32 v[114:115], v[20:21], v[20:21], v[114:115]
  v_pk_fma_f32 v[16:17], v[22:23], v[22:23], v[16:17]
  v_pk_fma_f32 v[114:115], v[24:25], v[24:25], v[114:115]
  v_pk_fma_f32 v[16:17], v[26:27], v[26:27], v[16:17]
  v_pk_fma_f32 v[114:115], v[28:29], v[28:29], v[114:115]
  v_pk_fma_f32 v[16:17], v[30:31], v[30:31], v[16:17]
  v_pk_add_f32 v[114:115], v[114:115], v[16:17]
  v_add_f32 v113, v114, v115
  v_min_u32 v112, -2, v112
  v_mov_b32 v114, v113
  s_nop 1
  v_permlane32_swap_b32 v114, v113
  v_add_f32 v113, v114, v113
  buffer_store_dwordx2 v[112:113], v12, s[8:11], s49 offen sc1
  s_waitcnt vmcnt(3)
  s_barrier
  ds_read_b128 v[88:91], v1 offset:0
  ds_read_b128 v[92:95], v1 offset:1024
  ds_read_b128 v[96:99], v1 offset:2048
  ds_read_b128 v[100:103], v1 offset:3072
  s_cmp_lg_u32 s26, 0
  s_cbranch_scc1 lay_55
  s_lshl_b32 s16, s22, 14
  s_lshl_b32 s17, s20, 8
  s_add_u32 s16, s16, s17
  s_add_u32 s16, s16, 37126144
  s_add_u32 s17, s16, 128
  v_lshlrev_b32 v7, 2, v2
  v_lshl_add_u32 v7, v3, 13, v7
  buffer_load_dword v196, v7, s[8:11], s16 offen offset:0 sc1
  buffer_load_dword v197, v7, s[8:11], s16 offen offset:1024 sc1
  buffer_load_dword v198, v7, s[8:11], s16 offen offset:2048 sc1
  buffer_load_dword v199, v7, s[8:11], s16 offen offset:3072 sc1
  s_add_u32 s19, s16, 4096
  buffer_load_dword v200, v7, s[8:11], s19 offen offset:0 sc1
  buffer_load_dword v201, v7, s[8:11], s19 offen offset:1024 sc1
  buffer_load_dword v202, v7, s[8:11], s19 offen offset:2048 sc1
  buffer_load_dword v203, v7, s[8:11], s19 offen offset:3072 sc1
  buffer_load_dword v204, v7, s[8:11], s17 offen offset:0 sc1
  buffer_load_dword v205, v7, s[8:11], s17 offen offset:1024 sc1
  buffer_load_dword v206, v7, s[8:11], s17 offen offset:2048 sc1
  buffer_load_dword v207, v7, s[8:11], s17 offen offset:3072 sc1
  s_add_u32 s19, s17, 4096
  buffer_load_dword v208, v7, s[8:11], s19 offen offset:0 sc1
  buffer_load_dword v209, v7, s[8:11], s19 offen offset:1024 sc1
  buffer_load_dword v210, v7, s[8:11], s19 offen offset:2048 sc1
  buffer_load_dword v211, v7, s[8:11], s19 offen offset:3072 sc1
lay_55:
  s_add_u32 m0, s31, 98304
  s_nop 0
  buffer_load_dwordx4 v1, s[8:11], s32 offen offset:0 sc1 lds
  buffer_load_dwordx4 v1, s[8:11], s32 offen offset:1024 sc1 lds
  buffer_load_dwordx4 v1, s[8:11], s32 offen offset:2048 sc1 lds
  buffer_load_dwordx4 v1, s[8:11], s32 offen offset:3072 sc1 lds
  s_add_u32 s32, s32, 16384
  s_lshr_b32 s16, s23, 1
  s_mul_i32 s16, s16, 112
  s_lshr_b32 s17, s22, 2
  s_mul_i32 s17, s17, 28
  s_add_u32 s16, s16, s17
  s_and_b32 s17, s22, 3
  s_add_u32 s16, s16, s17
  s_lshl_b32 s16, s16, 1
  s_and_b32 s17, s20, 1
  s_add_u32 s16, s16, s17
  s_lshl_b32 s16, s16, 10
  s_mul_i32 s17, s26, 7340032
  s_add_u32 s16, s16, s17
  s_add_u32 s52, s16, 21233664
  s_lshl_b32 s53, s26, 2
  s_add_u32 s54, s53, 2
  s_add_u32 s55, s53, 3
  s_add_u32 s53, s53, 1
  s_mul_i32 s37, s24, 229376
  s_mul_i32 s16, s20, 57344
  s_add_u32 s37, s37, s16
  s_add_u32 s37, s37, s17
  s_add_u32 s37, s37, 21233664
  s_waitcnt vmcnt(4)
  v_mov_b32 v14, s50
  s_mov_b64 exec, 1
  buffer_store_dword v14, v13, s[8:11], s30 offen sc1
  s_mov_b64 exec, -1
  s_mul_i32 s34, s26, 4194304
  s_lshl_b32 s16, s23, 15
  s_add_u32 s34, s34, s16
  s_add_u32 s34, s34, 9699328
  s_mul_i32 s35, s26, 524288
  s_lshl_b32 s16, s23, 12
  s_add_u32 s35, s35, s16
  s_add_u32 s35, s35, 16252928
  s_mov_b32 s58, 0
poll_56:
  buffer_load_dword v14, v138, s[8:11], s42 offen sc1
  s_waitcnt vmcnt(0)
  v_cmp_gt_u32 vcc, s50, v14
  s_add_u32 s58, s58, 1
  s_cmp_gt_u32 s58, 0x200000
  s_cbranch_scc1 poll_56_x
  s_cbranch_vccnz poll_56
poll_56_x:
  buffer_load_dwordx4 a[0:3], v1, s[8:11], s34 offen offset:0 sc1
  buffer_load_dwordx4 a[4:7], v1, s[8:11], s34 offen offset:1024 sc1
  buffer_load_dwordx4 a[8:11], v1, s[8:11], s34 offen offset:2048 sc1
  buffer_load_dwordx4 a[12:15], v1, s[8:11], s34 offen offset:3072 sc1
  s_add_u32 s34, s34, 4096
  buffer_load_dwordx4 a[16:19], v1, s[8:11], s34 offen offset:0 sc1
  buffer_load_dwordx4 a[20:23], v1, s[8:11], s34 offen offset:1024 sc1
  buffer_load_dwordx4 a[24:27], v1, s[8:11], s34 offen offset:2048 sc1
  buffer_load_dwordx4 a[28:31], v1, s[8:11], s34 offen offset:3072 sc1
  s_add_u32 s34, s34, 4096
  buffer_load_dwordx4 a[32:35], v1, s[8:11], s34 offen offset:0 sc1
  buffer_load_dwordx4 a[36:39], v1, s[8:11], s34 offen offset:1024 sc1
  s_waitcnt vmcnt(9) lgkmcnt(3)
  v_mfma_f32_32x32x16_bf16 v[16:31], v[88:91], a[0:3], 0
  ds_read_b128 v[104:107], v1 offset:4096
  s_waitcnt lgkmcnt(3)
  v_mfma_f32_32x32x16_bf16 v[32:47], v[92:95], a[0:3], 0
  ds_read_b128 v[108:111], v1 offset:5120
  s_waitcnt lgkmcnt(2)
  v_mfma_f32_32x32x16_bf16 v[48:63], v[96:99], a[0:3], 0
  ds_read_b128 v[112:115], v1 offset:6144
  buffer_load_dwordx4 a[40:43], v1, s[8:11], s34 offen offset:2048 sc1
  s_waitcnt vmcnt(9)
  v_mfma_f32_32x32x16_bf16 v[16:31], v[100:103], a[4:7], v[16:31]
  ds_read_b128 v[116:119], v1 offset:7168
  buffer_load_dwordx2 v[120:121], v4, s[8:11], s35 offen offset:0 sc1
  s_waitcnt lgkmcnt(2)
  v_mfma_f32_32x32x16_bf16 v[32:47], v[104:107], a[4:7], v[32:47]
  ds_read_b128 v[88:91], v1 offset:8192
  s_add_u32 m0, s31, 114688
  s_nop 0
  buffer_load_dwordx4 v1, s[8:11], s32 offen offset:0 sc1 lds
  buffer_load_dwordx2 v[122:123], v4, s[8:11], s35 offen offset:256 sc1
  v_mfma_f32_32x32x16_bf16 v[48:63], v[108:111], a[4:7], v[48:63]
  ds_read_b128 v[92:95], v1 offset:9216
  buffer_load_dwordx4 a[44:47], v1, s[8:11], s34 offen offset:3072 sc1
  s_add_u32 s34, s34, 4096
  buffer_load_dwordx2 v[124:125], v4, s[8:11], s35 offen offset:512 sc1
  s_waitcnt lgkmcnt(2)
  s_waitcnt vmcnt(13)
  v_mfma_f32_32x32x16_bf16 v[16:31], v[112:115], a[8:11], v[16:31]
  ds_read_b128 v[96:99], v1 offset:10240
  buffer_load_dwordx2 v[126:127], v4, s[8:11], s35 offen offset:768 sc1
  v_mfma_f32_32x32x16_bf16 v[32:47], v[116:119], a[8:11], v[32:47]
  ds_read_b128 v[100:103], v1 offset:11264
  buffer_load_dwordx2 v[128:129], v4, s[8:11], s35 offen offset:1024 sc1
  s_waitcnt lgkmcnt(2)
  v_mfma_f32_32x32x16_bf16 v[48:63], v[88:91], a[8:11], v[48:63]
  ds_read_b128 v[104:107], v1 offset:12288
  buffer_load_dwordx4 a[48:51], v1, s[8:11], s34 offen offset:0 sc1
  buffer_load_dwordx2 v[130:131], v4, s[8:11], s35 offen offset:1280 sc1
  s_waitcnt vmcnt(16)
  v_mfma_f32_32x32x16_bf16 v[16:31], v[92:95], a[12:15], v[16:31]
  ds_read_b128 v[108:111], v1 offset:13312
  buffer_load_dwordx2 v[132:133], v4, s[8:11], s35 offen offset:1536 sc1
  s_waitcnt lgkmcnt(2)
  v_mfma_f32_32x32x16_bf16 v[32:47], v[96:99], a[12:15], v[32:47]
  ds_read_b128 v[112:115], v1 offset:14336
  buffer_load_dwordx2 v[134:135], v4, s[8:11], s35 offen offset:1792 sc1
  v_mfma_f32_32x32x16_bf16 v[48:63], v[100:103], a[12:15], v[48:63]
  ds_read_b128 v[116:119], v1 offset:15360
  buffer_load_dwordx4 a[52:55], v1, s[8:11], s34 offen offset:1024 sc1
  buffer_load_dwordx4 v1, s[8:11], s32 offen offset:1024 sc1 lds
  s_waitcnt lgkmcnt(2)
  s_waitcnt vmcnt(19)
  v_mfma_f32_32x32x16_bf16 v[16:31], v[104:107], a[16:19], v[16:31]
  ds_read_b128 v[88:91], v1 offset:16384
  v_mfma_f32_32x32x16_bf16 v[32:47], v[108:111], a[16:19], v[32:47]
  ds_read_b128 v[92:95], v1 offset:17408
  s_waitcnt lgkmcnt(2)
  v_mfma_f32_32x32x16_bf16 v[48:63], v[112:115], a[16:19], v[48:63]
  ds_read_b128 v[96:99], v1 offset:18432
  buffer_load_dwordx4 a[56:59], v1, s[8:11], s34 offen offset:2048 sc1
  s_waitcnt vmcnt(19)
  v_mfma_f32_32x32x16_bf16 v[16:31], v[116:119], a[20:23], v[16:31]
  ds_read_b128 v[100:103], v1 offset:19456
  s_waitcnt lgkmcnt(2)
  v_mfma_f32_32x32x16_bf16 v[32:47], v[88:91], a[20:23], v[32:47]
  ds_read_b128 v[104:107], v1 offset:20480
  v_mfma_f32_32x32x16_bf16 v[48:63], v[92:95], a[20:23], v[48:63]
  ds_read_b128 v[108:111], v1 offset:21504
  buffer_load_dwordx4 a[60:63], v1, s[8:11], s34 offen offset:3072 sc1
  s_add_u32 s34, s34, 4096
  s_waitcnt lgkmcnt(2)
  s_waitcnt vmcnt(19)
  v_mfma_f32_32x32x16_bf16 v[16:31], v[96:99], a[24:27], v[16:31]
  ds_read_b128 v[112:115], v1 offset:22528
  buffer_load_dwordx4 v1, s[8:11], s32 offen offset:2048 sc1 lds
  v_mfma_f32_32x32x16_bf16 v[32:47], v[100:103], a[24:27], v[32:47]
  ds_read_b128 v[116:119], v1 offset:23552
  s_waitcnt lgkmcnt(2)
  v_mfma_f32_32x32x16_bf16 v[48:63], v[104:107], a[24:27], v[48:63]
  ds_read_b128 v[88:91], v1 offset:24576
  buffer_load_dwordx4 a[64:67], v1, s[8:11], s34 offen offset:0 sc1
  s_waitcnt vmcnt(20)
  v_mfma_f32_32x32x16_bf16 v[16:31], v[108:111], a[28:31], v[16:31]
  ds_read_b128 v[92:95], v1 offset:25600
  s_waitcnt lgkmcnt(2)
  v_mfma_f32_32x32x16_bf16 v[32:47], v[112:115], a[28:31], v[32:47]
  ds_read_b128 v[96:99], v1 offset:26624
  v_mfma_f32_32x32x16_bf16 v[48:63], v[116:119], a[28:31], v[48:63]
  ds_read_b128 v[100:103], v1 offset:27648
  buffer_load_dwordx4 a[68:71], v1, s[8:11], s34 offen offset:1024 sc1
  s_waitcnt lgkmcnt(2)
  s_waitcnt vmcnt(20)
  v_mfma_f32_32x32x16_bf16 v[16:31], v[88:91], a[32:35], v[16:31]
  ds_read_b128 v[104:107], v1 offset:28672
  v_mfma_f32_32x32x16_bf16 v[32:47], v[92:95], a[32:35], v[32:47]
  ds_read_b128 v[108:111], v1 offset:29696
  buffer_load_dwordx4 v1, s[8:11], s32 offen offset:3072 sc1 lds
  s_add_u32 s32, s32, 16384
  s_waitcnt lgkmcnt(2)
  v_mfma_f32_32x32x16_bf16 v[48:63], v[96:99], a[32:35], v[48:63]
  ds_read_b128 v[112:115], v1 offset:30720
  buffer_load_dwordx4 a[72:75], v1, s[8:11], s34 offen offset:2048 sc1
  s_waitcnt vmcnt(21)
  v_mfma_f32_32x32x16_bf16 v[16:31], v[100:103], a[36:39], v[16:31]
  ds_read_b128 v[116:119], v1 offset:31744
  s_waitcnt lgkmcnt(2)
  v_mfma_f32_32x32x16_bf16 v[32:47], v[104:107], a[36:39], v[32:47]
  s_cmp_lg_u32 s26, 0
  s_cbranch_scc1 lay_57
  v_add_f32 v196, v196, v197
  v_add_f32 v196, v196, v198
  v_add_f32 v196, v196, v199
  v_add_f32 v196, v196, v200
  v_add_f32 v196, v196, v201
  v_add_f32 v196, v196, v202
  v_add_f32 v196, v196, v203
  v_mov_b32 v197, v196
  s_nop 1
  v_permlane32_swap_b32 v197, v196
  v_add_f32 v196, v197, v196
  v_cvt_pk_bf16_f32 v212, v196, v196
  v_lshlrev_b32 v197, 16, v212
  v_sub_f32 v197, v196, v197
  v_cvt_pk_bf16_f32 v213, v197, 0
  v_cmp_eq_u32 vcc, 0, v3
  v_mov_b32 v214, 0
  v_mov_b32 v215, 0
  v_cndmask_b32 v212, 0, v212, vcc
  v_cndmask_b32 v213, 0, v213, vcc
  v_add_u32 v198, s98, v1
  ds_write_b128 v198, v[212:215]
  s_cmp_eq_u32 s20, 3
  s_cbranch_scc1 cs_58
  v_add_f32 v204, v204, v205
  v_add_f32 v204, v204, v206
  v_add_f32 v204, v204, v207
  v_add_f32 v204, v204, v208
  v_add_f32 v204, v204, v209
  v_add_f32 v204, v204, v210
  v_add_f32 v204, v204, v211
  v_mov_b32 v205, v204
  s_nop 1
  v_permlane32_swap_b32 v205, v204
  v_add_f32 v204, v205, v204
  v_cvt_pk_bf16_f32 v216, v204, v204
  v_lshlrev_b32 v205, 16, v216
  v_sub_f32 v205, v204, v205
  v_cvt_pk_bf16_f32 v217, v205, 0
  v_cmp_eq_u32 vcc, 0, v3
  v_mov_b32 v218, 0
  v_mov_b32 v219, 0
  v_cndmask_b32 v216, 0, v216, vcc
  v_cndmask_b32 v217, 0, v217, vcc
  v_add_u32 v206, s99, v1
  ds_write_b128 v206, v[216:219]
cs_58:
lay_57:
  s_waitcnt lgkmcnt(0)
  s_barrier
  ds_read_b128 v[88:91], v1 offset:32768
  v_mfma_f32_32x32x16_bf16 v[48:63], v[108:111], a[36:39], v[48:63]
  ds_read_b128 v[92:95], v1 offset:33792
  buffer_load_dwordx4 a[76:79], v1, s[8:11], s34 offen offset:3072 sc1
  s_add_u32 s34, s34, 4096
  s_waitcnt lgkmcnt(2)
  s_waitcnt vmcnt(21)
  v_mfma_f32_32x32x16_bf16 v[16:31], v[112:115], a[40:43], v[16:31]
  ds_read_b128 v[96:99], v1 offset:34816
  v_mfma_f32_32x32x16_bf16 v[32:47], v[116:119], a[40:43], v[32:47]
  ds_read_b128 v[100:103], v1 offset:35840
  s_waitcnt lgkmcnt(2)
  v_mfma_f32_32x32x16_bf16 v[48:63], v[88:91], a[40:43], v[48:63]
  ds_read_b128 v[104:107], v1 offset:36864
  buffer_load_dwordx4 a[80:83], v1, s[8:11], s34 offen offset:0 sc1
  s_add_u32 m0, s31, 131072
  s_nop 0
  buffer_load_dwordx4 v1, s[8:11], s32 offen offset:0 sc1 lds
  s_waitcnt vmcnt(19)
  v_mfma_f32_32x32x16_bf16 v[16:31], v[92:95], a[44:47], v[16:31]
  ds_read_b128 v[108:111], v1 offset:37888
  s_waitcnt lgkmcnt(2)
  v_mfma_f32_32x32x16_bf16 v[32:47], v[96:99], a[44:47], v[32:47]
  ds_read_b128 v[112:115], v1 offset:38912
  v_mfma_f32_32x32x16_bf16 v[48:63], v[100:103], a[44:47], v[48:63]
  ds_read_b128 v[116:119], v1 offset:39936
  buffer_load_dwordx4 a[84:87], v1, s[8:11], s34 offen offset:1024 sc1
  s_waitcnt lgkmcnt(2)
  s_waitcnt vmcnt(16)
  v_mfma_f32_32x32x16_bf16 v[16:31], v[104:107], a[48:51], v[16:31]
  ds_read_b128 v[88:91], v1 offset:40960
  v_mfma_f32_32x32x16_bf16 v[32:47], v[108:111], a[48:51], v[32:47]
  ds_read_b128 v[92:95], v1 offset:41984
  s_waitcnt lgkmcnt(2)
  v_mfma_f32_32x32x16_bf16 v[48:63], v[112:115], a[48:51], v[48:63]
  ds_read_b128 v[96:99], v1 offset:43008
  buffer_load_dwordx4 a[88:91], v1, s[8:11], s34 offen offset:2048 sc1
  s_waitcnt vmcnt(13)
  v_mfma_f32_32x32x16_bf16 v[16:31], v[116:119], a[52:55], v[16:31]
  ds_read_b128 v[100:103], v1 offset:44032
  buffer_load_dwordx4 v1, s[8:11], s32 offen offset:1024 sc1 lds
  s_waitcnt lgkmcnt(2)
  v_mfma_f32_32x32x16_bf16 v[32:47], v[88:91], a[52:55], v[32:47]
  ds_read_b128 v[104:107], v1 offset:45056
  v_add_f32 v136, v120, v122
  v_mfma_f32_32x32x16_bf16 v[48:63], v[92:95], a[52:55], v[48:63]
  ds_read_b128 v[108:111], v1 offset:46080
  buffer_load_dwordx4 a[92:95], v1, s[8:11], s34 offen offset:3072 sc1
  s_add_u32 s34, s34, 4096
  v_add_f32 v137, v121, v123
  s_waitcnt lgkmcnt(2)
  s_waitcnt vmcnt(13)
  v_mfma_f32_32x32x16_bf16 v[16:31], v[96:99], a[56:59], v[16:31]
  ds_read_b128 v[112:115], v1 offset:47104
  v_add_f32 v136, v136, v124
  v_mfma_f32_32x32x16_bf16 v[32:47], v[100:103], a[56:59], v[32:47]
  ds_read_b128 v[116:119], v1 offset:48128
  v_add_f32 v137, v137, v125
  s_waitcnt lgkmcnt(2)
  v_mfma_f32_32x32x16_bf16 v[48:63], v[104:107], a[56:59], v[48:63]
  ds_read_b128 v[88:91], v1 offset:49152
  buffer_load_dwordx4 a[96:99], v1, s[8:11], s34 offen offset:0 sc1
  v_add_f32 v136, v136, v126
  s_waitcnt vmcnt(13)
  v_mfma_f32_32x32x16_bf16 v[16:31], v[108:111], a[60:63], v[16:31]
  ds_read_b128 v[92:95], v1 offset:50176
  v_add_f32 v137, v137, v127
  s_waitcnt lgkmcnt(2)
  v_mfma_f32_32x32x16_bf16 v[32:47], v[112:115], a[60:63], v[32:47]
  ds_read_b128 v[96:99], v1 offset:51200
  buffer_load_dwordx4 v1, s[8:11], s32 offen offset:2048 sc1 lds
  v_add_f32 v136, v136, v128
  v_mfma_f32_32x32x16_bf16 v[48:63], v[116:119], a[60:63], v[48:63]
  ds_read_b128 v[100:103], v1 offset:52224
  buffer_load_dwordx4 a[100:103], v1, s[8:11], s34 offen offset:1024 sc1
  v_add_f32 v137, v137, v129
  s_waitcnt lgkmcnt(2)
  s_waitcnt vmcnt(13)
  v_mfma_f32_32x32x16_bf16 v[16:31], v[88:91], a[64:67], v[16:31]
  ds_read_b128 v[104:107], v1 offset:53248
  v_add_f32 v136, v136, v130
  v_mfma_f32_32x32x16_bf16 v[32:47], v[92:95], a[64:67], v[32:47]
  ds_read_b128 v[108:111], v1 offset:54272
  v_add_f32 v137, v137, v131
  s_waitcnt lgkmcnt(2)
  v_mfma_f32_32x32x16_bf16 v[48:63], v[96:99], a[64:67], v[48:63]
  ds_read_b128 v[112:115], v1 offset:55296
  buffer_load_dwordx4 a[104:107], v1, s[8:11], s34 offen offset:2048 sc1
  v_add_f32 v136, v136, v132
  s_waitcnt vmcnt(13)
  v_mfma_f32_32x32x16_bf16 v[16:31], v[100:103], a[68:71], v[16:31]
  ds_read_b128 v[116:119], v1 offset:56320
  v_add_f32 v137, v137, v133
  s_waitcnt lgkmcnt(2)
  v_mfma_f32_32x32x16_bf16 v[32:47], v[104:107], a[68:71], v[32:47]
  ds_read_b128 v[88:91], v1 offset:57344
  v_add_f32 v136, v136, v134
  v_mfma_f32_32x32x16_bf16 v[48:63], v[108:111], a[68:71], v[48:63]
  ds_read_b128 v[92:95], v1 offset:58368
  buffer_load_dwordx4 a[108:111], v1, s[8:11], s34 offen offset:3072 sc1
  s_add_u32 s34, s34, 4096
  buffer_load_dwordx4 v1, s[8:11], s32 offen offset:3072 sc1 lds
  s_add_u32 s32, s32, 16384
  v_add_f32 v137, v137, v135
  s_waitcnt lgkmcnt(2)
  s_waitcnt vmcnt(13)
  v_mfma_f32_32x32x16_bf16 v[16:31], v[112:115], a[72:75], v[16:31]
  ds_read_b128 v[96:99], v1 offset:59392
  v_mov_b32 v156, v136
  v_mfma_f32_32x32x16_bf16 v[32:47], v[116:119], a[72:75], v[32:47]
  ds_read_b128 v[100:103], v1 offset:60416
  v_permlane32_swap_b32 v156, v136
  s_waitcnt lgkmcnt(2)
  v_mfma_f32_32x32x16_bf16 v[48:63], v[88:91], a[72:75], v[48:63]
  ds_read_b128 v[104:107], v1 offset:61440
  buffer_load_dwordx4 a[112:115], v1, s[8:11], s34 offen offset:0 sc1
  v_add_f32 v136, v156, v136
  s_waitcnt vmcnt(13)
  v_mfma_f32_32x32x16_bf16 v[16:31], v[92:95], a[76:79], v[16:31]
  ds_read_b128 v[108:111], v1 offset:62464
  v_mul_f32 v136, 0x3d800000, v136
  s_waitcnt lgkmcnt(2)
  v_mfma_f32_32x32x16_bf16 v[32:47], v[96:99], a[76:79], v[32:47]
  ds_read_b128 v[112:115], v1 offset:63488
  v_sub_f32 v120, v120, v136
  v_mfma_f32_32x32x16_bf16 v[48:63], v[100:103], a[76:79], v[48:63]
  ds_read_b128 v[116:119], v1 offset:64512
  buffer_load_dwordx4 a[116:119], v1, s[8:11], s34 offen offset:1024 sc1
  v_sub_f32 v122, v122, v136
  s_waitcnt lgkmcnt(2)
  s_waitcnt vmcnt(13)
  v_mfma_f32_32x32x16_bf16 v[16:31], v[104:107], a[80:83], v[16:31]
  ds_read_b128 v[88:91], v5 offset:0
  s_add_u32 m0, s31, 0
  s_nop 0
  buffer_load_dwordx4 v1, s[8:11], s32 offen offset:0 sc1 lds
  v_sub_f32 v124, v124, v136
  v_mfma_f32_32x32x16_bf16 v[32:47], v[108:111], a[80:83], v[32:47]
  ds_read_b128 v[92:95], v5 offset:1024
  v_sub_f32 v126, v126, v136
  s_waitcnt lgkmcnt(2)
  v_mfma_f32_32x32x16_bf16 v[48:63], v[112:115], a[80:83], v[48:63]
  ds_read_b128 v[96:99], v5 offset:2048
  buffer_load_dwordx4 a[120:123], v1, s[8:11], s34 offen offset:2048 sc1
  v_sub_f32 v128, v128, v136
  s_waitcnt vmcnt(13)
  v_mfma_f32_32x32x16_bf16 v[16:31], v[116:119], a[84:87], v[16:31]
  ds_read_b128 v[100:103], v5 offset:3072
  v_sub_f32 v130, v130, v136
  v_sub_f32 v132, v132, v136
  s_waitcnt lgkmcnt(2)
  v_mfma_f32_32x32x16_bf16 v[32:47], v[88:91], a[84:87], v[32:47]
  ds_read_b128 v[104:107], v5 offset:4096
  v_sub_f32 v134, v134, v136
  v_mfma_f32_32x32x16_bf16 v[48:63], v[92:95], a[84:87], v[48:63]
  ds_read_b128 v[108:111], v5 offset:5120
  buffer_load_dwordx4 a[124:127], v1, s[8:11], s34 offen offset:3072 sc1
  s_add_u32 s34, s34, 4096
  v_mul_f32 v156, v120, v120
  s_waitcnt lgkmcnt(2)
  s_waitcnt vmcnt(13)
  v_mfma_f32_32x32x16_bf16 v[16:31], v[96:99], a[88:91], v[16:31]
  ds_read_b128 v[112:115], v5 offset:6144
  v_fmac_f32 v156, v122, v122
  v_mfma_f32_32x32x16_bf16 v[32:47], v[100:103], a[88:91], v[32:47]
  ds_read_b128 v[116:119], v5 offset:7168
  buffer_load_dwordx4 v1, s[8:11], s32 offen offset:1024 sc1 lds
  v_fmac_f32 v156, v124, v124
  s_waitcnt lgkmcnt(2)
  v_mfma_f32_32x32x16_bf16 v[48:63], v[104:107], a[88:91], v[48:63]
  ds_read_b128 v[88:91], v5 offset:8192
  v_fmac_f32 v156, v126, v126
  s_waitcnt vmcnt(12)
  v_mfma_f32_32x32x16_bf16 v[16:31], v[108:111], a[92:95], v[16:31]
  ds_read_b128 v[92:95], v5 offset:9216
  v_fmac_f32 v156, v128, v128
  s_waitcnt lgkmcnt(2)
  v_mfma_f32_32x32x16_bf16 v[32:47], v[112:115], a[92:95], v[32:47]
  ds_read_b128 v[96:99], v5 offset:10240
  v_fmac_f32 v156, v130, v130
  v_mfma_f32_32x32x16_bf16 v[48:63], v[116:119], a[92:95], v[48:63]
  ds_read_b128 v[100:103], v5 offset:11264
  v_fmac_f32 v156, v132, v132
  s_waitcnt lgkmcnt(2)
  s_waitcnt vmcnt(11)
  v_mfma_f32_32x32x16_bf16 v[16:31], v[88:91], a[96:99], v[16:31]
  ds_read_b128 v[104:107], v5 offset:12288
  v_fmac_f32 v156, v134, v134
  v_mfma_f32_32x32x16_bf16 v[32:47], v[92:95], a[96:99], v[32:47]
  ds_read_b128 v[108:111], v5 offset:13312
  v_fmamk_f32 v137, v156, 0x42000000, v137
  s_waitcnt lgkmcnt(2)
  v_mfma_f32_32x32x16_bf16 v[48:63], v[96:99], a[96:99], v[48:63]
  ds_read_b128 v[112:115], v5 offset:14336
  v_mov_b32 v156, v137
  s_waitcnt vmcnt(9)
  v_mfma_f32_32x32x16_bf16 v[16:31], v[100:103], a[100:103], v[16:31]
  ds_read_b128 v[116:119], v5 offset:15360
  buffer_load_dwordx4 v1, s[8:11], s32 offen offset:2048 sc1 lds
  v_permlane32_swap_b32 v156, v137
  s_waitcnt lgkmcnt(2)
  v_mfma_f32_32x32x16_bf16 v[32:47], v[104:107], a[100:103], v[32:47]
  ds_read_b128 v[88:91], v5 offset:16384
  v_add_f32 v137, v156, v137
  v_mfma_f32_32x32x16_bf16 v[48:63], v[108:111], a[100:103], v[48:63]
  ds_read_b128 v[92:95], v5 offset:17408
  v_mov_b32 v156, 0x3727c5ac
  s_waitcnt lgkmcnt(2)
  s_waitcnt vmcnt(9)
  v_mfma_f32_32x32x16_bf16 v[16:31], v[112:115], a[104:107], v[16:31]
  ds_read_b128 v[96:99], v5 offset:18432
  v_fmamk_f32 v137, v137, 0x3b000000, v156
  v_mfma_f32_32x32x16_bf16 v[32:47], v[116:119], a[104:107], v[32:47]
  ds_read_b128 v[100:103], v5 offset:19456
  v_rsq_f32 v137, v137
  s_waitcnt lgkmcnt(2)
  v_mfma_f32_32x32x16_bf16 v[48:63], v[88:91], a[104:107], v[48:63]
  ds_read_b128 v[104:107], v5 offset:20480
  v_sub_f32 v156, 0, v136
  s_waitcnt vmcnt(8)
  v_mfma_f32_32x32x16_bf16 v[16:31], v[92:95], a[108:111], v[16:31]
  ds_read_b128 v[108:111], v5 offset:21504
  v_cvt_pk_bf16_f32 v141, v156, 0
  s_waitcnt lgkmcnt(2)
  v_mfma_f32_32x32x16_bf16 v[32:47], v[96:99], a[108:111], v[32:47]
  ds_read_b128 v[112:115], v5 offset:22528
  buffer_load_dwordx4 v1, s[8:11], s32 offen offset:3072 sc1 lds
  s_add_u32 s32, s32, 16384
  v_lshlrev_b32 v157, 16, v141
  v_mfma_f32_32x32x16_bf16 v[48:63], v[100:103], a[108:111], v[48:63]
  ds_read_b128 v[116:119], v5 offset:23552
  v_sub_f32 v157, v156, v157
  s_waitcnt lgkmcnt(2)
  s_waitcnt vmcnt(7)
  v_mfma_f32_32x32x16_bf16 v[16:31], v[104:107], a[112:115], v[16:31]
  ds_read_b128 v[88:91], v5 offset:24576
  v_cvt_pk_bf16_f32 v140, v156, v157
  v_mfma_f32_32x32x16_bf16 v[32:47], v[108:111], a[112:115], v[32:47]
  ds_read_b128 v[92:95], v5 offset:25600
  v_mov_b32 v143, 0
  s_waitcnt lgkmcnt(2)
  v_mfma_f32_32x32x16_bf16 v[48:63], v[112:115], a[112:115], v[48:63]
  ds_read_b128 v[96:99], v5 offset:26624
  v_mov_b32 v142, 0
  s_waitcnt vmcnt(6)
  v_mfma_f32_32x32x16_bf16 v[16:31], v[116:119], a[116:119], v[16:31]
  ds_read_b128 v[100:103], v5 offset:27648
  v_mul_f32 v136, 0xbfb8aa3b, v137
  v_rcp_f32 v137, v137
  s_waitcnt lgkmcnt(2)
  v_mfma_f32_32x32x16_bf16 v[32:47], v[88:91], a[116:119], v[32:47]
  ds_read_b128 v[104:107], v5 offset:28672
  v_mfma_f32_32x32x16_bf16 v[48:63], v[92:95], a[116:119], v[48:63]
  ds_read_b128 v[108:111], v5 offset:29696
  s_waitcnt lgkmcnt(2)
  s_waitcnt vmcnt(4)
  v_mfma_f32_32x32x16_bf16 v[16:31], v[96:99], a[120:123], v[16:31]
  ds_read_b128 v[112:115], v5 offset:30720
  v_mfma_f32_32x32x16_bf16 v[32:47], v[100:103], a[120:123], v[32:47]
  ds_read_b128 v[116:119], v5 offset:31744
  s_waitcnt lgkmcnt(2)
  v_mfma_f32_32x32x16_bf16 v[48:63], v[104:107], a[120:123], v[48:63]
  ds_read_b128 v[88:91], v6 offset:19456
  s_waitcnt vmcnt(3)
  v_mfma_f32_32x32x16_bf16 v[16:31], v[108:111], a[124:127], v[16:31]
  ds_read_b128 v[92:95], v6 offset:20480
  s_waitcnt lgkmcnt(2)
  v_mfma_f32_32x32x16_bf16 v[32:47], v[112:115], a[124:127], v[32:47]
  ds_read_b128 v[96:99], v6 offset:21504
  v_mfma_f32_32x32x16_bf16 v[48:63], v[116:119], a[124:127], v[48:63]
  s_barrier
  ds_read_b128 v[100:103], v5 offset:32768
  s_waitcnt lgkmcnt(2)
  v_mfma_f32_32x32x16_bf16 v[16:31], v[88:91], v[140:143], v[16:31]
  ds_read_b128 v[104:107], v5 offset:33792
  v_mfma_f32_32x32x16_bf16 v[32:47], v[92:95], v[140:143], v[32:47]
  ds_read_b128 v[108:111], v5 offset:34816
  s_waitcnt lgkmcnt(2)
  v_mfma_f32_32x32x16_bf16 v[48:63], v[96:99], v[140:143], v[48:63]
  ds_read_b128 v[112:115], v5 offset:35840
  v_mfma_f32_32x32x16_bf16 v[64:79], v[100:103], a[0:3], 0
  ds_read_b128 v[116:119], v5 offset:36864
  s_waitcnt lgkmcnt(2)
  v_mfma_f32_32x32x16_bf16 v[64:79], v[104:107], a[4:7], v[64:79]
  ds_read_b128 v[88:91], v5 offset:37888
  s_add_u32 m0, s31, 16384
  s_nop 0
  buffer_load_dwordx4 v1, s[8:11], s32 offen offset:0 sc1 lds
  v_mul_f32 v144, v136, v16
  v_mul_f32 v145, v136, v17
  v_mfma_f32_32x32x16_bf16 v[64:79], v[108:111], a[8:11], v[64:79]
  ds_read_b128 v[92:95], v5 offset:38912
  v_exp_f32 v144, v144
  v_mul_f32 v146, v136, v18
  s_waitcnt lgkmcnt(2)
  v_mfma_f32_32x32x16_bf16 v[64:79], v[112:115], a[12:15], v[64:79]
  ds_read_b128 v[96:99], v5 offset:39936
  buffer_load_dwordx4 v1, s[8:11], s32 offen offset:1024 sc1 lds
  v_exp_f32 v145, v145
  v_fma_f32 v144, v144, v137, v137
  v_mfma_f32_32x32x16_bf16 v[64:79], v[116:119], a[16:19], v[64:79]
  ds_read_b128 v[100:103], v5 offset:40960
  v_mul_f32 v147, v136, v19
  v_exp_f32 v146, v146
  s_waitcnt lgkmcnt(2)
  v_mfma_f32_32x32x16_bf16 v[64:79], v[88:91], a[20:23], v[64:79]
  ds_read_b128 v[104:107], v5 offset:41984
  v_fma_f32 v145, v145, v137, v137
  v_rcp_f32 v144, v144
  v_mfma_f32_32x32x16_bf16 v[64:79], v[92:95], a[24:27], v[64:79]
  ds_read_b128 v[108:111], v5 offset:43008
  buffer_load_dwordx4 v1, s[8:11], s32 offen offset:2048 sc1 lds
  v_mul_f32 v148, v136, v20
  v_exp_f32 v147, v147
  s_waitcnt lgkmcnt(2)
  v_mfma_f32_32x32x16_bf16 v[64:79], v[96:99], a[28:31], v[64:79]
  ds_read_b128 v[112:115], v5 offset:44032
  v_fma_f32 v146, v146, v137, v137
  v_rcp_f32 v145, v145
  v_mul_f32 v144, v144, v24
  v_mfma_f32_32x32x16_bf16 v[64:79], v[100:103], a[32:35], v[64:79]
  ds_read_b128 v[116:119], v5 offset:45056
  buffer_load_dwordx4 v1, s[8:11], s32 offen offset:3072 sc1 lds
  s_add_u32 s32, s32, 16384
  v_mul_f32 v149, v136, v21
  v_exp_f32 v148, v148
  s_waitcnt lgkmcnt(2)
  v_mfma_f32_32x32x16_bf16 v[64:79], v[104:107], a[36:39], v[64:79]
  ds_read_b128 v[88:91], v5 offset:46080
  v_fma_f32 v147, v147, v137, v137
  v_rcp_f32 v146, v146
  v_mfma_f32_32x32x16_bf16 v[64:79], v[108:111], a[40:43], v[64:79]
  ds_read_b128 v[92:95], v5 offset:47104
  v_mul_f32 v145, v145, v25
  v_cvt_pk_bf16_f32 v120, v144, v145
  s_waitcnt lgkmcnt(2)
  v_mfma_f32_32x32x16_bf16 v[64:79], v[112:115], a[44:47], v[64:79]
  ds_read_b128 v[96:99], v5 offset:48128
  s_add_u32 m0, s31, 32768
  s_nop 0
  buffer_load_dwordx4 v1, s[8:11], s32 offen offset:0 sc1 lds
  v_mul_f32 v150, v136, v22
  v_exp_f32 v149, v149
  v_mfma_f32_32x32x16_bf16 v[64:79], v[116:119], a[48:51], v[64:79]
  ds_read_b128 v[100:103], v5 offset:49152
  v_fma_f32 v148, v148, v137, v137
  v_rcp_f32 v147, v147
  s_waitcnt lgkmcnt(2)
  v_mfma_f32_32x32x16_bf16 v[64:79], v[88:91], a[52:55], v[64:79]
  ds_read_b128 v[104:107], v5 offset:50176
  buffer_load_dwordx4 v1, s[8:11], s32 offen offset:1024 sc1 lds
  v_mul_f32 v146, v146, v26
  v_mul_f32 v151, v136, v23
  v_exp_f32 v150, v150
  v_mfma_f32_32x32x16_bf16 v[64:79], v[92:95], a[56:59], v[64:79]
  ds_read_b128 v[108:111], v5 offset:51200
  v_fma_f32 v149, v149, v137, v137
  v_rcp_f32 v148, v148
  s_waitcnt lgkmcnt(2)
  v_mfma_f32_32x32x16_bf16 v[64:79], v[96:99], a[60:63], v[64:79]
  ds_read_b128 v[112:115], v5 offset:52224
  v_mul_f32 v147, v147, v27
  v_cvt_pk_bf16_f32 v121, v146, v147
  v_mfma_f32_32x32x16_bf16 v[64:79], v[100:103], a[64:67], v[64:79]
  ds_read_b128 v[116:119], v5 offset:53248
  buffer_load_dwordx4 v1, s[8:11], s32 offen offset:2048 sc1 lds
  v_exp_f32 v151, v151
  v_fma_f32 v150, v150, v137, v137
  s_waitcnt lgkmcnt(2)
  v_mfma_f32_32x32x16_bf16 v[64:79], v[104:107], a[68:71], v[64:79]
  ds_read_b128 v[88:91], v5 offset:54272
  v_rcp_f32 v149, v149
  v_mul_f32 v148, v148, v28
  v_mfma_f32_32x32x16_bf16 v[64:79], v[108:111], a[72:75], v[64:79]
  ds_read_b128 v[92:95], v5 offset:55296
  buffer_load_dwordx4 v1, s[8:11], s32 offen offset:3072 sc1 lds
  s_add_u32 s32, s32, 16384
  v_fma_f32 v151, v151, v137, v137
  v_rcp_f32 v150, v150
  s_waitcnt lgkmcnt(2)
  v_mfma_f32_32x32x16_bf16 v[64:79], v[112:115], a[76:79], v[64:79]
  ds_read_b128 v[96:99], v5 offset:56320
  v_mul_f32 v149, v149, v29
  v_cvt_pk_bf16_f32 v122, v148, v149
  v_rcp_f32 v151, v151
  v_mfma_f32_32x32x16_bf16 v[64:79], v[116:119], a[80:83], v[64:79]
  ds_read_b128 v[100:103], v5 offset:57344
  v_mul_f32 v150, v150, v30
  v_mul_f32 v151, v151, v31
  s_waitcnt lgkmcnt(2)
  v_mfma_f32_32x32x16_bf16 v[64:79], v[88:91], a[84:87], v[64:79]
  ds_read_b128 v[104:107], v5 offset:58368
  s_cmp_lg_u32 s26, 0
  s_cbranch_scc1 lay_59
  s_add_u32 s67, s36, 0
  buffer_load_dwordx4 a[128:131], v10, s[8:11], s67 offen offset:0 sc1
  buffer_load_dwordx4 a[132:135], v11, s[8:11], s67 offen offset:0 sc1
lay_59:
  v_cvt_pk_bf16_f32 v123, v150, v151
  buffer_store_dwordx4 v[120:123], v1, s[8:11], s52 offen sc1
  s_add_u32 s52, s52, 8192
  v_mfma_f32_32x32x16_bf16 v[64:79], v[92:95], a[88:91], v[64:79]
  ds_read_b128 v[108:111], v5 offset:59392
  v_mul_f32 v144, v136, v32
  v_mul_f32 v145, v136, v33
  s_waitcnt lgkmcnt(2)
  v_mfma_f32_32x32x16_bf16 v[64:79], v[96:99], a[92:95], v[64:79]
  ds_read_b128 v[112:115], v5 offset:60416
  s_cmp_lg_u32 s26, 0
  s_cbranch_scc1 lay_60
  s_add_u32 s67, s36, 0
  buffer_load_dwordx4 a[136:139], v10, s[8:11], s67 offen offset:2048 sc1
  buffer_load_dwordx4 a[140:143], v11, s[8:11], s67 offen offset:2048 sc1
lay_60:
  v_exp_f32 v144, v144
  v_mul_f32 v146, v136, v34
  v_mfma_f32_32x32x16_bf16 v[64:79], v[100:103], a[96:99], v[64:79]
  ds_read_b128 v[116:119], v5 offset:61440
  v_exp_f32 v145, v145
  v_fma_f32 v144, v144, v137, v137
  s_waitcnt lgkmcnt(2)
  v_mfma_f32_32x32x16_bf16 v[64:79], v[104:107], a[100:103], v[64:79]
  ds_read_b128 v[88:91], v5 offset:62464
  v_mul_f32 v147, v136, v35
  v_exp_f32 v146, v146
  v_fma_f32 v145, v145, v137, v137
  v_mfma_f32_32x32x16_bf16 v[64:79], v[108:111], a[104:107], v[64:79]
  ds_read_b128 v[92:95], v5 offset:63488
  s_cmp_lg_u32 s26, 0
  s_cbranch_scc1 lay_61
  s_add_u32 s67, s36, 4096
  buffer_load_dwordx4 a[144:147], v10, s[8:11], s67 offen offset:0 sc1
  buffer_load_dwordx4 a[148:151], v11, s[8:11], s67 offen offset:0 sc1
lay_61:
  v_rcp_f32 v144, v144
  v_mul_f32 v148, v136, v36
  s_waitcnt lgkmcnt(2)
  v_mfma_f32_32x32x16_bf16 v[64:79], v[112:115], a[108:111], v[64:79]
  ds_read_b128 v[96:99], v5 offset:64512
  v_exp_f32 v147, v147
  v_fma_f32 v146, v146, v137, v137
  v_mfma_f32_32x32x16_bf16 v[64:79], v[116:119], a[112:115], v[64:79]
  ds_read_b128 v[100:103], v6 offset:22528
  s_cmp_lg_u32 s26, 0
  s_cbranch_scc1 lay_62
  s_add_u32 s67, s36, 4096
  buffer_load_dwordx4 a[152:155], v10, s[8:11], s67 offen offset:2048 sc1
  buffer_load_dwordx4 a[156:159], v11, s[8:11], s67 offen offset:2048 sc1
lay_62:
  v_rcp_f32 v145, v145
  v_mul_f32 v144, v144, v40
  s_waitcnt lgkmcnt(2)
  v_mfma_f32_32x32x16_bf16 v[64:79], v[88:91], a[116:119], v[64:79]
  s_waitcnt vmcnt(9)
  s_barrier
  ds_read_b128 v[104:107], v6 offset:0
  v_mul_f32 v149, v136, v37
  v_exp_f32 v148, v148
  v_mfma_f32_32x32x16_bf16 v[64:79], v[92:95], a[120:123], v[64:79]
  ds_read_b128 v[108:111], v6 offset:1024
  v_fma_f32 v147, v147, v137, v137
  v_rcp_f32 v146, v146
  s_waitcnt lgkmcnt(2)
  v_mfma_f32_32x32x16_bf16 v[64:79], v[96:99], a[124:127], v[64:79]
  ds_read_b128 v[112:115], v6 offset:2048
  v_mul_f32 v145, v145, v41
  v_cvt_pk_bf16_f32 v124, v144, v145
  v_mul_f32 v150, v136, v38
  v_mfma_f32_32x32x16_bf16 v[64:79], v[100:103], v[140:143], v[64:79]
  ds_read_b128 v[116:119], v6 offset:3072
  s_waitcnt lgkmcnt(2)
  v_mfma_f32_32x32x16_bf16 v[16:31], v[104:107], a[0:3], 0
  ds_read_b128 v[88:91], v6 offset:4096
  v_mfma_f32_32x32x16_bf16 v[16:31], v[108:111], a[4:7], v[16:31]
  ds_read_b128 v[92:95], v6 offset:5120
  s_add_u32 m0, s31, 49152
  s_nop 0
  buffer_load_dwordx4 v1, s[8:11], s32 offen offset:0 sc1 lds
  v_exp_f32 v149, v149
  v_fma_f32 v148, v148, v137, v137
  s_waitcnt lgkmcnt(2)
  v_mfma_f32_32x32x16_bf16 v[16:31], v[112:115], a[8:11], v[16:31]
  ds_read_b128 v[96:99], v6 offset:6144
  v_rcp_f32 v147, v147
  v_mul_f32 v146, v146, v42
  v_mfma_f32_32x32x16_bf16 v[16:31], v[116:119], a[12:15], v[16:31]
  ds_read_b128 v[100:103], v6 offset:7168
  buffer_load_dwordx4 v1, s[8:11], s32 offen offset:1024 sc1 lds
  v_mul_f32 v151, v136, v39
  v_exp_f32 v150, v150
  s_waitcnt lgkmcnt(2)
  v_mfma_f32_32x32x16_bf16 v[16:31], v[88:91], a[16:19], v[16:31]
  ds_read_b128 v[104:107], v6 offset:8192
  v_fma_f32 v149, v149, v137, v137
  v_rcp_f32 v148, v148
  v_mfma_f32_32x32x16_bf16 v[16:31], v[92:95], a[20:23], v[16:31]
  ds_read_b128 v[108:111], v6 offset:9216
  v_mul_f32 v147, v147, v43
  v_cvt_pk_bf16_f32 v125, v146, v147
  s_waitcnt lgkmcnt(2)
  v_mfma_f32_32x32x16_bf16 v[16:31], v[96:99], a[24:27], v[16:31]
  ds_read_b128 v[112:115], v6 offset:10240
  buffer_load_dwordx4 v1, s[8:11], s32 offen offset:2048 sc1 lds
  v_exp_f32 v151, v151
  v_fma_f32 v150, v150, v137, v137
  v_rcp_f32 v149, v149
  v_mfma_f32_32x32x16_bf16 v[16:31], v[100:103], a[28:31], v[16:31]
  ds_read_b128 v[116:119], v6 offset:11264
  v_mul_f32 v148, v148, v44
  v_fma_f32 v151, v151, v137, v137
  s_waitcnt lgkmcnt(2)
  v_mfma_f32_32x32x16_bf16 v[16:31], v[104:107], a[32:35], v[16:31]
  ds_read_b128 v[88:91], v6 offset:12288
  buffer_load_dwordx4 v1, s[8:11], s32 offen offset:3072 sc1 lds
  s_add_u32 s32, s32, 16384
  v_rcp_f32 v150, v150
  v_mul_f32 v149, v149, v45
  v_mfma_f32_32x32x16_bf16 v[16:31], v[108:111], a[36:39], v[16:31]
  ds_read_b128 v[92:95], v6 offset:13312
  v_cvt_pk_bf16_f32 v126, v148, v149
  v_rcp_f32 v151, v151
  s_waitcnt lgkmcnt(2)
  v_mfma_f32_32x32x16_bf16 v[16:31], v[112:115], a[40:43], v[16:31]
  ds_read_b128 v[96:99], v6 offset:14336
  v_mul_f32 v150, v150, v46
  v_mul_f32 v151, v151, v47
  v_mfma_f32_32x32x16_bf16 v[16:31], v[116:119], a[44:47], v[16:31]
  ds_read_b128 v[100:103], v6 offset:15360
  s_add_u32 m0, s31, 65536
  s_nop 0
  buffer_load_dwordx4 v1, s[8:11], s32 offen offset:0 sc1 lds
  v_cvt_pk_bf16_f32 v127, v150, v151
  buffer_store_dwordx4 v[124:127], v1, s[8:11], s52 offen sc1
  s_add_u32 s52, s52, 8192
  v_mul_f32 v144, v136, v48
  s_waitcnt lgkmcnt(2)
  v_mfma_f32_32x32x16_bf16 v[16:31], v[88:91], a[48:51], v[16:31]
  ds_read_b128 v[104:107], v1 offset:0
  v_mul_f32 v145, v136, v49
  v_exp_f32 v144, v144
  v_mfma_f32_32x32x16_bf16 v[16:31], v[92:95], a[52:55], v[16:31]
  ds_read_b128 v[108:111], v1 offset:1024
  buffer_load_dwordx4 v1, s[8:11], s32 offen offset:1024 sc1 lds
  v_mul_f32 v146, v136, v50
  v_exp_f32 v145, v145
  s_waitcnt lgkmcnt(2)
  v_mfma_f32_32x32x16_bf16 v[16:31], v[96:99], a[56:59], v[16:31]
  ds_read_b128 v[112:115], v1 offset:2048
  v_fma_f32 v144, v144, v137, v137
  v_mul_f32 v147, v136, v51
  v_mfma_f32_32x32x16_bf16 v[16:31], v[100:103], a[60:63], v[16:31]
  ds_read_b128 v[116:119], v1 offset:3072
  v_exp_f32 v146, v146
  v_fma_f32 v145, v145, v137, v137
  s_waitcnt lgkmcnt(2)
  v_mfma_f32_32x32x16_bf16 v[16:31], v[104:107], a[64:67], v[16:31]
  ds_read_b128 v[88:91], v1 offset:4096
  buffer_load_dwordx4 v1, s[8:11], s32 offen offset:2048 sc1 lds
  v_rcp_f32 v144, v144
  v_mul_f32 v148, v136, v52
  v_exp_f32 v147, v147
  v_mfma_f32_32x32x16_bf16 v[16:31], v[108:111], a[68:71], v[16:31]
  ds_read_b128 v[92:95], v1 offset:5120
  v_fma_f32 v146, v146, v137, v137
  v_rcp_f32 v145, v145
  s_waitcnt lgkmcnt(2)
  v_mfma_f32_32x32x16_bf16 v[16:31], v[112:115], a[72:75], v[16:31]
  ds_read_b128 v[96:99], v1 offset:6144
  buffer_load_dwordx4 v1, s[8:11], s32 offen offset:3072 sc1 lds
  s_add_u32 s32, s32, 16384
  v_mul_f32 v144, v144, v56
  v_mul_f32 v149, v136, v53
  v_mfma_f32_32x32x16_bf16 v[16:31], v[116:119], a[76:79], v[16:31]
  ds_read_b128 v[100:103], v1 offset:7168
  v_exp_f32 v148, v148
  v_fma_f32 v147, v147, v137, v137
  s_waitcnt lgkmcnt(2)
  v_mfma_f32_32x32x16_bf16 v[16:31], v[88:91], a[80:83], v[16:31]
  ds_read_b128 v[104:107], v1 offset:8192
  v_rcp_f32 v146, v146
  v_mul_f32 v145, v145, v57
  v_mfma_f32_32x32x16_bf16 v[16:31], v[92:95], a[84:87], v[16:31]
  ds_read_b128 v[108:111], v1 offset:9216
  s_cmp_lg_u32 s26, 0
  s_cbranch_scc1 lay_63
  s_add_u32 s67, s36, 8192
  buffer_load_dwordx4 a[160:163], v10, s[8:11], s67 offen offset:0 sc1
  buffer_load_dwordx4 a[164:167], v11, s[8:11], s67 offen offset:0 sc1
lay_63:
  v_cvt_pk_bf16_f32 v120, v144, v145
  v_mul_f32 v150, v136, v54
  v_exp_f32 v149, v149
  s_waitcnt lgkmcnt(2)
  v_mfma_f32_32x32x16_bf16 v[16:31], v[96:99], a[88:91], v[16:31]
  ds_read_b128 v[112:115], v1 offset:10240
  v_fma_f32 v148, v148, v137, v137
  v_rcp_f32 v147, v147
  v_mfma_f32_32x32x16_bf16 v[16:31], v[100:103], a[92:95], v[16:31]
  ds_read_b128 v[116:119], v1 offset:11264
  s_cmp_lg_u32 s26, 0
  s_cbranch_scc1 lay_64
  s_add_u32 s67, s36, 8192
  buffer_load_dwordx4 a[168:171], v10, s[8:11], s67 offen offset:2048 sc1
  buffer_load_dwordx4 a[172:175], v11, s[8:11], s67 offen offset:2048 sc1
lay_64:
  v_mul_f32 v146, v146, v58
  v_mul_f32 v151, v136, v55
  s_waitcnt lgkmcnt(2)
  v_mfma_f32_32x32x16_bf16 v[16:31], v[104:107], a[96:99], v[16:31]
  ds_read_b128 v[88:91], v1 offset:12288
  v_exp_f32 v150, v150
  v_fma_f32 v149, v149, v137, v137
  v_mfma_f32_32x32x16_bf16 v[16:31], v[108:111], a[100:103], v[16:31]
  ds_read_b128 v[92:95], v1 offset:13312
  v_rcp_f32 v148, v148
  v_mul_f32 v147, v147, v59
  s_waitcnt lgkmcnt(2)
  v_mfma_f32_32x32x16_bf16 v[16:31], v[112:115], a[104:107], v[16:31]
  ds_read_b128 v[96:99], v1 offset:14336
  s_cmp_lg_u32 s26, 0
  s_cbranch_scc1 lay_65
  s_add_u32 s67, s36, 12288
  buffer_load_dwordx4 a[176:179], v10, s[8:11], s67 offen offset:0 sc1
  buffer_load_dwordx4 a[180:183], v11, s[8:11], s67 offen offset:0 sc1
lay_65:
  v_cvt_pk_bf16_f32 v121, v146, v147
  v_exp_f32 v151, v151
  v_fma_f32 v150, v150, v137, v137
  v_mfma_f32_32x32x16_bf16 v[16:31], v[116:119], a[108:111], v[16:31]
  ds_read_b128 v[100:103], v1 offset:15360
  v_rcp_f32 v149, v149
  v_mul_f32 v148, v148, v60
  s_waitcnt lgkmcnt(2)
  v_mfma_f32_32x32x16_bf16 v[16:31], v[88:91], a[112:115], v[16:31]
  ds_read_b128 v[104:107], v6 offset:23552
  s_cmp_lg_u32 s26, 0
  s_cbranch_scc1 lay_66
  s_add_u32 s67, s36, 12288
  buffer_load_dwordx4 a[184:187], v10, s[8:11], s67 offen offset:2048 sc1
  buffer_load_dwordx4 a[188:191], v11, s[8:11], s67 offen offset:2048 sc1
lay_66:
  v_fma_f32 v151, v151, v137, v137
  v_rcp_f32 v150, v150
  v_mfma_f32_32x32x16_bf16 v[16:31], v[92:95], a[116:119], v[16:31]
  s_waitcnt vmcnt(10)
  s_barrier
  ds_read_b128 v[108:111], v1 offset:16384
  v_mul_f32 v149, v149, v61
  v_cvt_pk_bf16_f32 v122, v148, v149
  s_waitcnt lgkmcnt(2)
  v_mfma_f32_32x32x16_bf16 v[16:31], v[96:99], a[120:123], v[16:31]
  ds_read_b128 v[112:115], v1 offset:17408
  v_rcp_f32 v151, v151
  v_mul_f32 v150, v150, v62
  v_mfma_f32_32x32x16_bf16 v[16:31], v[100:103], a[124:127], v[16:31]
  ds_read_b128 v[116:119], v1 offset:18432
  v_mul_f32 v151, v151, v63
  v_cvt_pk_bf16_f32 v123, v150, v151
  buffer_store_dwordx4 v[120:123], v1, s[8:11], s52 offen sc1
  s_add_u32 s52, s52, 8192
  s_waitcnt lgkmcnt(2)
  v_mfma_f32_32x32x16_bf16 v[16:31], v[104:107], v[140:143], v[16:31]
  ds_read_b128 v[88:91], v1 offset:19456
  v_mfma_f32_32x32x16_bf16 v[32:47], v[108:111], a[0:3], 0
  ds_read_b128 v[92:95], v1 offset:20480
  s_waitcnt lgkmcnt(2)
  v_mfma_f32_32x32x16_bf16 v[32:47], v[112:115], a[4:7], v[32:47]
  ds_read_b128 v[96:99], v1 offset:21504
  s_cmp_lg_u32 s26, 0
  s_cbranch_scc1 lay_67
  s_add_u32 s67, s36, 16384
  buffer_load_dwordx4 a[192:195], v10, s[8:11], s67 offen offset:0 sc1
  buffer_load_dwordx4 a[196:199], v11, s[8:11], s67 offen offset:0 sc1
lay_67:
  v_mul_f32 v144, v136, v64
  v_mul_f32 v145, v136, v65
  v_mfma_f32_32x32x16_bf16 v[32:47], v[116:119], a[8:11], v[32:47]
  ds_read_b128 v[100:103], v1 offset:22528
  v_exp_f32 v144, v144
  v_mul_f32 v146, v136, v66
  s_waitcnt lgkmcnt(2)
  v_mfma_f32_32x32x16_bf16 v[32:47], v[88:91], a[12:15], v[32:47]
  ds_read_b128 v[104:107], v1 offset:23552
  v_exp_f32 v145, v145
  v_fma_f32 v144, v144, v137, v137
  v_mfma_f32_32x32x16_bf16 v[32:47], v[92:95], a[16:19], v[32:47]
  ds_read_b128 v[108:111], v1 offset:24576
  s_cmp_lg_u32 s26, 0
  s_cbranch_scc1 lay_68
  s_add_u32 s67, s36, 16384
  buffer_load_dwordx4 a[200:203], v10, s[8:11], s67 offen offset:2048 sc1
  buffer_load_dwordx4 a[204:207], v11, s[8:11], s67 offen offset:2048 sc1
lay_68:
  v_mul_f32 v147, v136, v67
  v_exp_f32 v146, v146
  s_waitcnt lgkmcnt(2)
  v_mfma_f32_32x32x16_bf16 v[32:47], v[96:99], a[20:23], v[32:47]
  ds_read_b128 v[112:115], v1 offset:25600
  v_fma_f32 v145, v145, v137, v137
  v_rcp_f32 v144, v144
  v_mfma_f32_32x32x16_bf16 v[32:47], v[100:103], a[24:27], v[32:47]
  ds_read_b128 v[116:119], v1 offset:26624
  v_mul_f32 v148, v136, v68
  v_exp_f32 v147, v147
  s_waitcnt lgkmcnt(2)
  v_mfma_f32_32x32x16_bf16 v[32:47], v[104:107], a[28:31], v[32:47]
  ds_read_b128 v[88:91], v1 offset:27648
  v_fma_f32 v146, v146, v137, v137
  v_rcp_f32 v145, v145
  v_mfma_f32_32x32x16_bf16 v[32:47], v[108:111], a[32:35], v[32:47]
  ds_read_b128 v[92:95], v1 offset:28672
  s_cmp_lg_u32 s26, 0
  s_cbranch_scc1 lay_69
  s_add_u32 s67, s36, 20480
  buffer_load_dwordx4 a[208:211], v10, s[8:11], s67 offen offset:0 sc1
  buffer_load_dwordx4 a[212:215], v11, s[8:11], s67 offen offset:0 sc1
lay_69:
  v_mul_f32 v144, v144, v72
  v_mul_f32 v149, v136, v69
  s_waitcnt lgkmcnt(2)
  v_mfma_f32_32x32x16_bf16 v[32:47], v[112:115], a[36:39], v[32:47]
  ds_read_b128 v[96:99], v1 offset:29696
  v_exp_f32 v148, v148
  v_fma_f32 v147, v147, v137, v137
  v_mfma_f32_32x32x16_bf16 v[32:47], v[116:119], a[40:43], v[32:47]
  ds_read_b128 v[100:103], v1 offset:30720
  v_rcp_f32 v146, v146
  v_mul_f32 v145, v145, v73
  s_waitcnt lgkmcnt(2)
  v_mfma_f32_32x32x16_bf16 v[32:47], v[88:91], a[44:47], v[32:47]
  ds_read_b128 v[104:107], v1 offset:31744
  v_cvt_pk_bf16_f32 v124, v144, v145
  v_mul_f32 v150, v136, v70
  v_mfma_f32_32x32x16_bf16 v[32:47], v[92:95], a[48:51], v[32:47]
  ds_read_b128 v[108:111], v1 offset:32768
  s_cmp_lg_u32 s26, 0
  s_cbranch_scc1 lay_70
  s_add_u32 s67, s36, 20480
  buffer_load_dwordx4 a[216:219], v10, s[8:11], s67 offen offset:2048 sc1
  buffer_load_dwordx4 a[220:223], v11, s[8:11], s67 offen offset:2048 sc1
lay_70:
  v_exp_f32 v149, v149
  v_fma_f32 v148, v148, v137, v137
  s_waitcnt lgkmcnt(2)
  v_mfma_f32_32x32x16_bf16 v[32:47], v[96:99], a[52:55], v[32:47]
  ds_read_b128 v[112:115], v1 offset:33792
  s_cmp_lg_u32 s26, 1
  s_cbranch_scc1 lay_71
  s_waitcnt vmcnt(0)
  v_mov_b32 v14, s53
  s_mov_b64 exec, 1
  buffer_store_dword v14, v13, s[8:11], s47 offen sc1
  s_mov_b64 exec, -1
lay_71:
  v_rcp_f32 v147, v147
  v_mul_f32 v146, v146, v74
  v_mfma_f32_32x32x16_bf16 v[32:47], v[100:103], a[56:59], v[32:47]
  ds_read_b128 v[116:119], v1 offset:34816
  v_mul_f32 v151, v136, v71
  v_exp_f32 v150, v150
  s_waitcnt lgkmcnt(2)
  v_mfma_f32_32x32x16_bf16 v[32:47], v[104:107], a[60:63], v[32:47]
  ds_read_b128 v[88:91], v1 offset:35840
  v_fma_f32 v149, v149, v137, v137
  v_rcp_f32 v148, v148
  v_mfma_f32_32x32x16_bf16 v[32:47], v[108:111], a[64:67], v[32:47]
  ds_read_b128 v[92:95], v1 offset:36864
  s_cmp_lg_u32 s26, 0
  s_cbranch_scc1 lay_72
  s_add_u32 s67, s36, 24576
  buffer_load_dwordx4 a[224:227], v10, s[8:11], s67 offen offset:0 sc1
  buffer_load_dwordx4 a[228:231], v11, s[8:11], s67 offen offset:0 sc1
lay_72:
  v_mul_f32 v147, v147, v75
  v_cvt_pk_bf16_f32 v125, v146, v147
  s_waitcnt lgkmcnt(2)
  v_mfma_f32_32x32x16_bf16 v[32:47], v[112:115], a[68:71], v[32:47]
  ds_read_b128 v[96:99], v1 offset:37888
  v_exp_f32 v151, v151
  v_fma_f32 v150, v150, v137, v137
  v_mfma_f32_32x32x16_bf16 v[32:47], v[116:119], a[72:75], v[32:47]
  ds_read_b128 v[100:103], v1 offset:38912
  v_rcp_f32 v149, v149
  v_mul_f32 v148, v148, v76
  s_waitcnt lgkmcnt(2)
  v_mfma_f32_32x32x16_bf16 v[32:47], v[88:91], a[76:79], v[32:47]
  ds_read_b128 v[104:107], v1 offset:39936
  s_cmp_lg_u32 s26, 0
  s_cbranch_scc1 lay_73
  s_add_u32 s67, s36, 24576
  buffer_load_dwordx4 a[232:235], v10, s[8:11], s67 offen offset:2048 sc1
  buffer_load_dwordx4 a[236:239], v11, s[8:11], s67 offen offset:2048 sc1
lay_73:
  s_cmp_lg_u32 s26, 0
  s_cbranch_scc1 lay_74
  s_waitcnt vmcnt(12)
  v_mov_b32 v14, s53
  s_mov_b64 exec, 1
  buffer_store_dword v14, v13, s[8:11], s47 offen sc1
  s_mov_b64 exec, -1
lay_74:
  v_fma_f32 v151, v151, v137, v137
  v_rcp_f32 v150, v150
  v_mfma_f32_32x32x16_bf16 v[32:47], v[92:95], a[80:83], v[32:47]
  ds_read_b128 v[108:111], v1 offset:40960
  v_mul_f32 v149, v149, v77
  v_cvt_pk_bf16_f32 v126, v148, v149
  s_waitcnt lgkmcnt(2)
  v_mfma_f32_32x32x16_bf16 v[32:47], v[96:99], a[84:87], v[32:47]
  ds_read_b128 v[112:115], v1 offset:41984
  v_rcp_f32 v151, v151
  v_mul_f32 v150, v150, v78
  v_mfma_f32_32x32x16_bf16 v[32:47], v[100:103], a[88:91], v[32:47]
  ds_read_b128 v[116:119], v1 offset:43008
  v_mul_f32 v151, v151, v79
  v_cvt_pk_bf16_f32 v127, v150, v151
  s_waitcnt lgkmcnt(2)
  v_mfma_f32_32x32x16_bf16 v[32:47], v[104:107], a[92:95], v[32:47]
  ds_read_b128 v[88:91], v1 offset:44032
  s_cmp_lg_u32 s26, 0
  s_cbranch_scc1 lay_75
  s_add_u32 s67, s36, 28672
  buffer_load_dwordx4 a[240:243], v10, s[8:11], s67 offen offset:0 sc1
  buffer_load_dwordx4 a[244:247], v11, s[8:11], s67 offen offset:0 sc1
lay_75:
  buffer_store_dwordx4 v[124:127], v1, s[8:11], s52 offen sc1
  s_add_u32 s52, s52, 8192
  v_mul_f32 v144, v136, v16
  v_mfma_f32_32x32x16_bf16 v[32:47], v[108:111], a[96:99], v[32:47]
  ds_read_b128 v[92:95], v1 offset:45056
  v_mul_f32 v145, v136, v17
  v_exp_f32 v144, v144
  s_waitcnt lgkmcnt(2)
  v_mfma_f32_32x32x16_bf16 v[32:47], v[112:115], a[100:103], v[32:47]
  ds_read_b128 v[96:99], v1 offset:46080
  v_mul_f32 v146, v136, v18
  v_exp_f32 v145, v145
  v_mfma_f32_32x32x16_bf16 v[32:47], v[116:119], a[104:107], v[32:47]
  ds_read_b128 v[100:103], v1 offset:47104
  v_fma_f32 v144, v144, v137, v137
  v_mul_f32 v147, v136, v19
  s_waitcnt lgkmcnt(2)
  v_mfma_f32_32x32x16_bf16 v[32:47], v[88:91], a[108:111], v[32:47]
  ds_read_b128 v[104:107], v1 offset:48128
  s_cmp_lg_u32 s26, 0
  s_cbranch_scc1 lay_76
  s_add_u32 s67, s36, 28672
  buffer_load_dwordx4 a[248:251], v10, s[8:11], s67 offen offset:2048 sc1
  buffer_load_dwordx4 a[252:255], v11, s[8:11], s67 offen offset:2048 sc1
lay_76:
  v_exp_f32 v146, v146
  v_fma_f32 v145, v145, v137, v137
  v_mfma_f32_32x32x16_bf16 v[32:47], v[92:95], a[112:115], v[32:47]
  ds_read_b128 v[108:111], v6 offset:24576
  v_rcp_f32 v144, v144
  v_mul_f32 v148, v136, v20
  s_waitcnt lgkmcnt(2)
  v_mfma_f32_32x32x16_bf16 v[32:47], v[96:99], a[116:119], v[32:47]
  s_barrier
  ds_read_b128 v[112:115], v1 offset:49152
  v_exp_f32 v147, v147
  v_fma_f32 v146, v146, v137, v137
  v_mfma_f32_32x32x16_bf16 v[32:47], v[100:103], a[120:123], v[32:47]
  ds_read_b128 v[116:119], v1 offset:50176
  v_rcp_f32 v145, v145
  v_mul_f32 v144, v144, v24
  s_waitcnt lgkmcnt(2)
  v_mfma_f32_32x32x16_bf16 v[32:47], v[104:107], a[124:127], v[32:47]
  ds_read_b128 v[88:91], v1 offset:51200
  buffer_load_dword v158, v139, s[8:11], s51 offen sc1
  v_mul_f32 v149, v136, v21
  v_exp_f32 v148, v148
  v_mfma_f32_32x32x16_bf16 v[32:47], v[108:111], v[140:143], v[32:47]
  ds_read_b128 v[92:95], v1 offset:52224
  v_fma_f32 v147, v147, v137, v137
  v_rcp_f32 v146, v146
  s_waitcnt lgkmcnt(2)
  v_mfma_f32_32x32x16_bf16 v[48:63], v[112:115], a[0:3], 0
  ds_read_b128 v[96:99], v1 offset:53248
  v_mul_f32 v145, v145, v25
  v_cvt_pk_bf16_f32 v120, v144, v145
  v_mul_f32 v150, v136, v22
  v_mfma_f32_32x32x16_bf16 v[48:63], v[116:119], a[4:7], v[48:63]
  ds_read_b128 v[100:103], v1 offset:54272
  v_exp_f32 v149, v149
  v_fma_f32 v148, v148, v137, v137
  s_waitcnt lgkmcnt(2)
  v_mfma_f32_32x32x16_bf16 v[48:63], v[88:91], a[8:11], v[48:63]
  ds_read_b128 v[104:107], v1 offset:55296
  v_rcp_f32 v147, v147
  v_mul_f32 v146, v146, v26
  v_mfma_f32_32x32x16_bf16 v[48:63], v[92:95], a[12:15], v[48:63]
  ds_read_b128 v[108:111], v1 offset:56320
  v_mul_f32 v151, v136, v23
  v_exp_f32 v150, v150
  s_waitcnt lgkmcnt(2)
  v_mfma_f32_32x32x16_bf16 v[48:63], v[96:99], a[16:19], v[48:63]
  ds_read_b128 v[112:115], v1 offset:57344
  v_fma_f32 v149, v149, v137, v137
  v_rcp_f32 v148, v148
  v_mfma_f32_32x32x16_bf16 v[48:63], v[100:103], a[20:23], v[48:63]
  ds_read_b128 v[116:119], v1 offset:58368
  v_mul_f32 v147, v147, v27
  v_cvt_pk_bf16_f32 v121, v146, v147
  s_waitcnt lgkmcnt(2)
  v_mfma_f32_32x32x16_bf16 v[48:63], v[104:107], a[24:27], v[48:63]
  ds_read_b128 v[88:91], v1 offset:59392
  v_exp_f32 v151, v151
  v_fma_f32 v150, v150, v137, v137
  v_mfma_f32_32x32x16_bf16 v[48:63], v[108:111], a[28:31], v[48:63]
  ds_read_b128 v[92:95], v1 offset:60416
  v_rcp_f32 v149, v149
  v_mul_f32 v148, v148, v28
  s_waitcnt lgkmcnt(2)
  v_mfma_f32_32x32x16_bf16 v[48:63], v[112:115], a[32:35], v[48:63]
  ds_read_b128 v[96:99], v1 offset:61440
  v_fma_f32 v151, v151, v137, v137
  v_rcp_f32 v150, v150
  v_mul_f32 v149, v149, v29
  v_mfma_f32_32x32x16_bf16 v[48:63], v[116:119], a[36:39], v[48:63]
  ds_read_b128 v[100:103], v1 offset:62464
  v_cvt_pk_bf16_f32 v122, v148, v149
  v_rcp_f32 v151, v151
  s_waitcnt lgkmcnt(2)
  v_mfma_f32_32x32x16_bf16 v[48:63], v[88:91], a[40:43], v[48:63]
  ds_read_b128 v[104:107], v1 offset:63488
  v_mul_f32 v150, v150, v30
  v_mul_f32 v151, v151, v31
  v_mfma_f32_32x32x16_bf16 v[48:63], v[92:95], a[44:47], v[48:63]
  ds_read_b128 v[108:111], v1 offset:64512
  v_cvt_pk_bf16_f32 v123, v150, v151
  buffer_store_dwordx4 v[120:123], v1, s[8:11], s52 offen sc1
  s_add_u32 s52, s52, 8192
  s_waitcnt lgkmcnt(2)
  v_mfma_f32_32x32x16_bf16 v[48:63], v[96:99], a[48:51], v[48:63]
  ds_read_b128 v[112:115], v5 offset:0
  s_waitcnt vmcnt(1)
  v_cmp_gt_u32 vcc, s53, v158
  s_nop 0
  s_cbranch_vccz poll_77_x
  s_mov_b32 s58, 0
poll_77:
  buffer_load_dword v158, v139, s[8:11], s51 offen sc1
  s_waitcnt vmcnt(0)
  v_cmp_gt_u32 vcc, s53, v158
  s_add_u32 s58, s58, 1
  s_cmp_gt_u32 s58, 0x200000
  s_cbranch_scc1 poll_77_x
  s_cbranch_vccnz poll_77
poll_77_x:
  v_mul_f32 v144, v136, v32
  v_mul_f32 v145, v136, v33
  v_mfma_f32_32x32x16_bf16 v[48:63], v[100:103], a[52:55], v[48:63]
  ds_read_b128 v[116:119], v5 offset:1024
  buffer_load_dwordx4 a[0:3], v8, s[8:11], s37 offen offset:0 sc1
  buffer_load_dwordx4 a[4:7], v9, s[8:11], s37 offen offset:0 sc1
  v_exp_f32 v144, v144
  v_mul_f32 v146, v136, v34
  s_waitcnt lgkmcnt(2)
  v_mfma_f32_32x32x16_bf16 v[48:63], v[104:107], a[56:59], v[48:63]
  ds_read_b128 v[88:91], v5 offset:2048
  v_exp_f32 v145, v145
  v_fma_f32 v144, v144, v137, v137
  v_mfma_f32_32x32x16_bf16 v[48:63], v[108:111], a[60:63], v[48:63]
  ds_read_b128 v[92:95], v5 offset:3072
  v_mul_f32 v147, v136, v35
  v_exp_f32 v146, v146
  s_waitcnt lgkmcnt(2)
  v_mfma_f32_32x32x16_bf16 v[48:63], v[112:115], a[64:67], v[48:63]
  ds_read_b128 v[96:99], v5 offset:4096
  buffer_load_dwordx4 a[8:11], v8, s[8:11], s37 offen offset:2048 sc1
  buffer_load_dwordx4 a[12:15], v9, s[8:11], s37 offen offset:2048 sc1
  s_add_u32 s37, s37, 4096
  v_fma_f32 v145, v145, v137, v137
  v_rcp_f32 v144, v144
  v_mul_f32 v148, v136, v36
  v_mfma_f32_32x32x16_bf16 v[48:63], v[116:119], a[68:71], v[48:63]
  ds_read_b128 v[100:103], v5 offset:5120
  v_exp_f32 v147, v147
  v_fma_f32 v146, v146, v137, v137
  s_waitcnt lgkmcnt(2)
  v_mfma_f32_32x32x16_bf16 v[48:63], v[88:91], a[72:75], v[48:63]
  ds_read_b128 v[104:107], v5 offset:6144
  v_rcp_f32 v145, v145
  v_mul_f32 v144, v144, v40
  v_mfma_f32_32x32x16_bf16 v[48:63], v[92:95], a[76:79], v[48:63]
  ds_read_b128 v[108:111], v5 offset:7168
  buffer_load_dwordx4 a[16:19], v8, s[8:11], s37 offen offset:0 sc1
  buffer_load_dwordx4 a[20:23], v9, s[8:11], s37 offen offset:0 sc1
  v_mul_f32 v149, v136, v37
  v_exp_f32 v148, v148
  s_waitcnt lgkmcnt(2)
  v_mfma_f32_32x32x16_bf16 v[48:63], v[96:99], a[80:83], v[48:63]
  ds_read_b128 v[112:115], v5 offset:8192
  v_fma_f32 v147, v147, v137, v137
  v_rcp_f32 v146, v146
  v_mfma_f32_32x32x16_bf16 v[48:63], v[100:103], a[84:87], v[48:63]
  ds_read_b128 v[116:119], v5 offset:9216
  v_mul_f32 v145, v145, v41
  v_cvt_pk_bf16_f32 v124, v144, v145
  s_waitcnt lgkmcnt(2)
  v_mfma_f32_32x32x16_bf16 v[48:63], v[104:107], a[88:91], v[48:63]
  ds_read_b128 v[88:91], v5 offset:10240
  buffer_load_dwordx4 a[24:27], v8, s[8:11], s37 offen offset:2048 sc1
  buffer_load_dwordx4 a[28:31], v9, s[8:11], s37 offen offset:2048 sc1
  s_add_u32 s37, s37, 4096
  v_mul_f32 v150, v136, v38
  v_exp_f32 v149, v149
  v_mfma_f32_32x32x16_bf16 v[48:63], v[108:111], a[92:95], v[48:63]
  ds_read_b128 v[92:95], v5 offset:11264
  v_fma_f32 v148, v148, v137, v137
  v_rcp_f32 v147, v147
  s_waitcnt lgkmcnt(2)
  v_mfma_f32_32x32x16_bf16 v[48:63], v[112:115], a[96:99], v[48:63]
  ds_read_b128 v[96:99], v5 offset:12288
  v_mul_f32 v146, v146, v42
  v_mul_f32 v151, v136, v39
  v_exp_f32 v150, v150
  v_mfma_f32_32x32x16_bf16 v[48:63], v[116:119], a[100:103], v[48:63]
  ds_read_b128 v[100:103], v5 offset:13312
  buffer_load_dwordx4 a[32:35], v8, s[8:11], s37 offen offset:0 sc1
  buffer_load_dwordx4 a[36:39], v9, s[8:11], s37 offen offset:0 sc1
  v_fma_f32 v149, v149, v137, v137
  v_rcp_f32 v148, v148
  s_waitcnt lgkmcnt(2)
  v_mfma_f32_32x32x16_bf16 v[48:63], v[88:91], a[104:107], v[48:63]
  ds_read_b128 v[104:107], v5 offset:14336
  v_mul_f32 v147, v147, v43
  v_cvt_pk_bf16_f32 v125, v146, v147
  v_mfma_f32_32x32x16_bf16 v[48:63], v[92:95], a[108:111], v[48:63]
  ds_read_b128 v[108:111], v5 offset:15360
  v_exp_f32 v151, v151
  v_fma_f32 v150, v150, v137, v137
  s_waitcnt lgkmcnt(3)
  v_mfma_f32_32x32x16_bf16 v[48:63], v[96:99], a[112:115], v[48:63]
  ds_read_b128 v[112:115], v6 offset:25600
  buffer_load_dwordx4 a[40:43], v8, s[8:11], s37 offen offset:2048 sc1
  buffer_load_dwordx4 a[44:47], v9, s[8:11], s37 offen offset:2048 sc1
  s_add_u32 s37, s37, 4096
  v_rcp_f32 v149, v149
  v_mul_f32 v148, v148, v44
  s_waitcnt lgkmcnt(3)
  v_mfma_f32_32x32x16_bf16 v[48:63], v[100:103], a[116:119], v[48:63]
  v_fma_f32 v151, v151, v137, v137
  v_rcp_f32 v150, v150
  s_waitcnt lgkmcnt(2)
  v_mfma_f32_32x32x16_bf16 v[48:63], v[104:107], a[120:123], v[48:63]
  v_mul_f32 v149, v149, v45
  v_cvt_pk_bf16_f32 v126, v148, v149
  s_waitcnt lgkmcnt(1)
  v_mfma_f32_32x32x16_bf16 v[48:63], v[108:111], a[124:127], v[48:63]
  s_waitcnt vmcnt(12)
  v_mov_b32 v14, s54
  s_mov_b64 exec, 1
  buffer_store_dword v14, v13, s[8:11], s47 offen sc1
  s_mov_b64 exec, -1
  v_rcp_f32 v151, v151
  v_mul_f32 v150, v150, v46
  s_waitcnt lgkmcnt(0)
  v_mfma_f32_32x32x16_bf16 v[48:63], v[112:115], v[140:143], v[48:63]
  v_mul_f32 v151, v151, v47
  v_cvt_pk_bf16_f32 v127, v150, v151
  buffer_store_dwordx4 v[124:127], v1, s[8:11], s52 offen sc1
  s_add_u32 s52, s52, 8192
  s_cmp_lg_u32 s26, 0
  s_cbranch_scc1 L_safe_k4b
  s_waitcnt vmcnt(12)
  v_mfma_f32_32x32x16_bf16 v[64:79], a[132:135], a[4:7], 0
  buffer_load_dwordx4 a[48:51], v8, s[8:11], s37 offen offset:0 sc1
  buffer_load_dwordx4 a[52:55], v9, s[8:11], s37 offen offset:0 sc1
  s_nop 1
  v_mul_f32 v144, v136, v48
  v_mul_f32 v145, v136, v49
  v_exp_f32 v144, v144
  v_mfma_f32_32x32x16_bf16 v[88:103], a[128:131], a[4:7], 0
  v_mul_f32 v146, v136, v50
  v_exp_f32 v145, v145
  v_fma_f32 v144, v144, v137, v137
  v_mul_f32 v147, v136, v51
  v_mfma_f32_32x32x16_bf16 v[32:47], a[132:135], a[0:3], 0
  v_exp_f32 v146, v146
  v_fma_f32 v145, v145, v137, v137
  v_rcp_f32 v144, v144
  v_mul_f32 v148, v136, v52
  v_mfma_f32_32x32x16_bf16 v[16:31], a[128:131], a[0:3], 0
  v_exp_f32 v147, v147
  v_fma_f32 v146, v146, v137, v137
  v_rcp_f32 v145, v145
  v_mul_f32 v144, v144, v56
  s_waitcnt vmcnt(12)
  v_mfma_f32_32x32x16_bf16 v[64:79], a[140:143], a[12:15], v[64:79]
  buffer_load_dwordx4 a[56:59], v8, s[8:11], s37 offen offset:2048 sc1
  buffer_load_dwordx4 a[60:63], v9, s[8:11], s37 offen offset:2048 sc1
  s_add_u32 s37, s37, 4096
  v_mul_f32 v149, v136, v53
  v_exp_f32 v148, v148
  v_fma_f32 v147, v147, v137, v137
  v_mfma_f32_32x32x16_bf16 v[88:103], a[136:139], a[12:15], v[88:103]
  v_rcp_f32 v146, v146
  v_mul_f32 v145, v145, v57
  v_cvt_pk_bf16_f32 v120, v144, v145
  v_mul_f32 v150, v136, v54
  v_mfma_f32_32x32x16_bf16 v[32:47], a[140:143], a[8:11], v[32:47]
  v_exp_f32 v149, v149
  v_fma_f32 v148, v148, v137, v137
  v_rcp_f32 v147, v147
  v_mul_f32 v146, v146, v58
  v_mfma_f32_32x32x16_bf16 v[16:31], a[136:139], a[8:11], v[16:31]
  s_barrier
  s_mul_i32 s32, s22, 98304
  s_add_u32 s32, s32, s31
  s_add_u32 s32, s32, 0
  v_mul_f32 v151, v136, v55
  v_exp_f32 v150, v150
  v_fma_f32 v149, v149, v137, v137
  v_rcp_f32 v148, v148
  s_waitcnt vmcnt(12)
  v_mfma_f32_32x32x16_bf16 v[64:79], a[148:151], a[20:23], v[64:79]
  buffer_load_dwordx4 a[64:67], v8, s[8:11], s37 offen offset:0 sc1
  buffer_load_dwordx4 a[68:71], v9, s[8:11], s37 offen offset:0 sc1
  v_mul_f32 v147, v147, v59
  v_cvt_pk_bf16_f32 v121, v146, v147
  v_exp_f32 v151, v151
  v_mfma_f32_32x32x16_bf16 v[88:103], a[144:147], a[20:23], v[88:103]
  v_fma_f32 v150, v150, v137, v137
  v_rcp_f32 v149, v149
  v_mul_f32 v148, v148, v60
  v_fma_f32 v151, v151, v137, v137
  v_mfma_f32_32x32x16_bf16 v[32:47], a[148:151], a[16:19], v[32:47]
  v_rcp_f32 v150, v150
  v_mul_f32 v149, v149, v61
  v_cvt_pk_bf16_f32 v122, v148, v149
  v_rcp_f32 v151, v151
  v_mfma_f32_32x32x16_bf16 v[16:31], a[144:147], a[16:19], v[16:31]
  buffer_load_dword v158, v139, s[8:11], s51 offen sc1
  s_add_u32 m0, s31, 0
  s_nop 0
  buffer_load_dwordx4 v1, s[8:11], s32 offen offset:0 sc1 lds
  buffer_load_dwordx4 v1, s[8:11], s32 offen offset:1024 sc1 lds
  v_mul_f32 v150, v150, v62
  v_mul_f32 v151, v151, v63
  v_cvt_pk_bf16_f32 v123, v150, v151
  buffer_store_dwordx4 v[120:123], v1, s[8:11], s52 offen sc1
  s_add_u32 s52, s52, 8192
  s_waitcnt vmcnt(16)
  v_mfma_f32_32x32x16_bf16 v[64:79], a[156:159], a[28:31], v[64:79]
  buffer_load_dwordx4 a[72:75], v8, s[8:11], s37 offen offset:2048 sc1
  buffer_load_dwordx4 a[76:79], v9, s[8:11], s37 offen offset:2048 sc1
  s_add_u32 s37, s37, 4096
  v_mfma_f32_32x32x16_bf16 v[88:103], a[152:155], a[28:31], v[88:103]
  v_mfma_f32_32x32x16_bf16 v[32:47], a[156:159], a[24:27], v[32:47]
  v_mfma_f32_32x32x16_bf16 v[16:31], a[152:155], a[24:27], v[16:31]
  s_waitcnt vmcnt(16)
  v_mfma_f32_32x32x16_bf16 v[64:79], a[164:167], a[36:39], v[64:79]
  buffer_load_dwordx4 a[80:83], v8, s[8:11], s37 offen offset:0 sc1
  buffer_load_dwordx4 a[84:87], v9, s[8:11], s37 offen offset:0 sc1
  v_mfma_f32_32x32x16_bf16 v[88:103], a[160:163], a[36:39], v[88:103]
  v_mfma_f32_32x32x16_bf16 v[32:47], a[164:167], a[32:35], v[32:47]
  v_mfma_f32_32x32x16_bf16 v[16:31], a[160:163], a[32:35], v[16:31]
  s_waitcnt vmcnt(16)
  v_mfma_f32_32x32x16_bf16 v[64:79], a[172:175], a[44:47], v[64:79]
  buffer_load_dwordx4 a[88:91], v8, s[8:11], s37 offen offset:2048 sc1
  buffer_load_dwordx4 a[92:95], v9, s[8:11], s37 offen offset:2048 sc1
  s_add_u32 s37, s37, 4096
  v_mfma_f32_32x32x16_bf16 v[88:103], a[168:171], a[44:47], v[88:103]
  v_mfma_f32_32x32x16_bf16 v[32:47], a[172:175], a[40:43], v[32:47]
  s_add_u32 s67, s36, 32768
  buffer_load_dwordx4 v[160:163], v10, s[8:11], s67 offen offset:0 sc1
  buffer_load_dwordx4 v[164:167], v11, s[8:11], s67 offen offset:0 sc1
  v_mfma_f32_32x32x16_bf16 v[16:31], a[168:171], a[40:43], v[16:31]
  s_waitcnt vmcnt(8)
  v_mov_b32 v14, s55
  s_mov_b64 exec, 1
  buffer_store_dword v14, v13, s[8:11], s47 offen sc1
  s_mov_b64 exec, -1
  s_add_u32 m0, s31, 0
  s_nop 0
  buffer_load_dwordx4 v1, s[8:11], s32 offen offset:2048 sc1 lds
  buffer_load_dwordx4 v1, s[8:11], s32 offen offset:3072 sc1 lds
  s_add_u32 s32, s32, 16384
  v_mfma_f32_32x32x16_bf16 v[64:79], a[180:183], a[52:55], v[64:79]
  v_cmp_gt_u32 vcc, s54, v158
  s_nop 0
  s_cbranch_vccz poll_78_x
  s_mov_b32 s58, 0
poll_78:
  buffer_load_dword v158, v139, s[8:11], s51 offen sc1
  s_waitcnt vmcnt(0)
  v_cmp_gt_u32 vcc, s54, v158
  s_add_u32 s58, s58, 1
  s_cmp_gt_u32 s58, 0x200000
  s_cbranch_scc1 poll_78_x
  s_cbranch_vccnz poll_78
poll_78_x:
  buffer_load_dwordx4 a[96:99], v8, s[8:11], s37 offen offset:0 sc1
  buffer_load_dwordx4 a[100:103], v9, s[8:11], s37 offen offset:0 sc1
  v_mfma_f32_32x32x16_bf16 v[88:103], a[176:179], a[52:55], v[88:103]
  v_mfma_f32_32x32x16_bf16 v[32:47], a[180:183], a[48:51], v[32:47]
  v_mfma_f32_32x32x16_bf16 v[16:31], a[176:179], a[48:51], v[16:31]
  v_mfma_f32_32x32x16_bf16 v[64:79], a[188:191], a[60:63], v[64:79]
  buffer_load_dwordx4 a[104:107], v8, s[8:11], s37 offen offset:2048 sc1
  buffer_load_dwordx4 a[108:111], v9, s[8:11], s37 offen offset:2048 sc1
  s_add_u32 s37, s37, 4096
  v_mfma_f32_32x32x16_bf16 v[88:103], a[184:187], a[60:63], v[88:103]
  v_mfma_f32_32x32x16_bf16 v[32:47], a[188:191], a[56:59], v[32:47]
  v_mfma_f32_32x32x16_bf16 v[16:31], a[184:187], a[56:59], v[16:31]
  v_mfma_f32_32x32x16_bf16 v[64:79], a[196:199], a[68:71], v[64:79]
  buffer_load_dwordx4 a[112:115], v8, s[8:11], s37 offen offset:0 sc1
  buffer_load_dwordx4 a[116:119], v9, s[8:11], s37 offen offset:0 sc1
  v_mfma_f32_32x32x16_bf16 v[88:103], a[192:195], a[68:71], v[88:103]
  v_mfma_f32_32x32x16_bf16 v[32:47], a[196:199], a[64:67], v[32:47]
  v_mfma_f32_32x32x16_bf16 v[16:31], a[192:195], a[64:67], v[16:31]
  s_waitcnt vmcnt(15)
  v_mfma_f32_32x32x16_bf16 v[64:79], a[204:207], a[76:79], v[64:79]
  buffer_load_dwordx4 a[120:123], v8, s[8:11], s37 offen offset:2048 sc1
  buffer_load_dwordx4 a[124:127], v9, s[8:11], s37 offen offset:2048 sc1
  s_add_u32 s37, s37, 4096
  v_mfma_f32_32x32x16_bf16 v[88:103], a[200:203], a[76:79], v[88:103]
  v_mfma_f32_32x32x16_bf16 v[32:47], a[204:207], a[72:75], v[32:47]
  v_mfma_f32_32x32x16_bf16 v[16:31], a[200:203], a[72:75], v[16:31]
  s_mul_i32 s48, s26, 4194304
  s_add_u32 s48, s48, s28
  s_add_u32 s48, s48, 11796480
  s_mul_i32 s49, s26, 524288
  s_add_u32 s49, s49, s29
  s_add_u32 s49, s49, 16515072
  s_mul_i32 s50, s26, 48
  s_add_u32 s50, s50, 64
  s_lshl_b32 s42, s23, 7
  s_add_u32 s42, s42, 37388288
  v_and_b32 v138, 15, v0
  v_lshlrev_b32 v138, 2, v138
  buffer_load_dword v159, v139, s[8:11], s51 offen sc1
  s_waitcnt vmcnt(16)
  v_mfma_f32_32x32x16_bf16 v[64:79], a[212:215], a[84:87], v[64:79]
  buffer_load_dwordx4 a[0:3], v8, s[8:11], s37 offen offset:0 sc1
  buffer_load_dwordx4 a[4:7], v9, s[8:11], s37 offen offset:0 sc1
  v_mfma_f32_32x32x16_bf16 v[88:103], a[208:211], a[84:87], v[88:103]
  v_mfma_f32_32x32x16_bf16 v[32:47], a[212:215], a[80:83], v[32:47]
  v_mfma_f32_32x32x16_bf16 v[16:31], a[208:211], a[80:83], v[16:31]
  s_waitcnt vmcnt(16)
  v_mfma_f32_32x32x16_bf16 v[64:79], a[220:223], a[92:95], v[64:79]
  s_add_u32 s67, s36, 32768
  buffer_load_dwordx4 v[168:171], v10, s[8:11], s67 offen offset:2048 sc1
  buffer_load_dwordx4 v[172:175], v11, s[8:11], s67 offen offset:2048 sc1
  buffer_load_dwordx4 a[8:11], v8, s[8:11], s37 offen offset:2048 sc1
  buffer_load_dwordx4 a[12:15], v9, s[8:11], s37 offen offset:2048 sc1
  s_add_u32 s37, s37, 4096
  v_mfma_f32_32x32x16_bf16 v[88:103], a[216:219], a[92:95], v[88:103]
  v_mfma_f32_32x32x16_bf16 v[32:47], a[220:223], a[88:91], v[32:47]
  v_mfma_f32_32x32x16_bf16 v[16:31], a[216:219], a[88:91], v[16:31]
  s_waitcnt vmcnt(13)
  v_mfma_f32_32x32x16_bf16 v[64:79], a[228:231], a[100:103], v[64:79]
  s_add_u32 s67, s36, 36864
  buffer_load_dwordx4 v[176:179], v10, s[8:11], s67 offen offset:0 sc1
  buffer_load_dwordx4 v[180:183], v11, s[8:11], s67 offen offset:0 sc1
  buffer_load_dwordx4 a[16:19], v8, s[8:11], s37 offen offset:0 sc1
  buffer_load_dwordx4 a[20:23], v9, s[8:11], s37 offen offset:0 sc1
  v_mfma_f32_32x32x16_bf16 v[88:103], a[224:227], a[100:103], v[88:103]
  v_mfma_f32_32x32x16_bf16 v[32:47], a[228:231], a[96:99], v[32:47]
  v_mfma_f32_32x32x16_bf16 v[16:31], a[224:227], a[96:99], v[16:31]
  s_waitcnt vmcnt(15)
  v_mfma_f32_32x32x16_bf16 v[64:79], a[236:239], a[108:111], v[64:79]
  s_add_u32 s67, s36, 36864
  buffer_load_dwordx4 v[184:187], v10, s[8:11], s67 offen offset:2048 sc1
  buffer_load_dwordx4 v[188:191], v11, s[8:11], s67 offen offset:2048 sc1
  buffer_load_dwordx4 a[24:27], v8, s[8:11], s37 offen offset:2048 sc1
  buffer_load_dwordx4 a[28:31], v9, s[8:11], s37 offen offset:2048 sc1
  s_add_u32 s37, s37, 4096
  v_mfma_f32_32x32x16_bf16 v[88:103], a[232:235], a[108:111], v[88:103]
  v_mfma_f32_32x32x16_bf16 v[32:47], a[236:239], a[104:107], v[32:47]
  s_add_u32 s67, s36, 40960
  buffer_load_dwordx4 v[192:195], v10, s[8:11], s67 offen offset:0 sc1
  buffer_load_dwordx4 v[196:199], v11, s[8:11], s67 offen offset:0 sc1
  v_mfma_f32_32x32x16_bf16 v[16:31], a[232:235], a[104:107], v[16:31]
  s_waitcnt vmcnt(19)
  v_mfma_f32_32x32x16_bf16 v[64:79], a[244:247], a[116:119], v[64:79]
  s_waitcnt vmcnt(16)
  v_cmp_gt_u32 vcc, s55, v159
  s_nop 0
  s_cbranch_vccz poll_79_x
  s_mov_b32 s58, 0
poll_79:
  buffer_load_dword v159, v139, s[8:11], s51 offen sc1
  s_waitcnt vmcnt(0)
  v_cmp_gt_u32 vcc, s55, v159
  s_add_u32 s58, s58, 1
  s_cmp_gt_u32 s58, 0x200000
  s_cbranch_scc1 poll_79_x
  s_cbranch_vccnz poll_79
poll_79_x:
  buffer_load_dwordx4 a[32:35], v8, s[8:11], s37 offen offset:0 sc1
  buffer_load_dwordx4 a[36:39], v9, s[8:11], s37 offen offset:0 sc1
  v_mfma_f32_32x32x16_bf16 v[88:103], a[240:243], a[116:119], v[88:103]
  v_mfma_f32_32x32x16_bf16 v[32:47], a[244:247], a[112:115], v[32:47]
  v_mfma_f32_32x32x16_bf16 v[16:31], a[240:243], a[112:115], v[16:31]
  v_mfma_f32_32x32x16_bf16 v[64:79], a[252:255], a[124:127], v[64:79]
  s_add_u32 s67, s36, 40960
  buffer_load_dwordx4 v[200:203], v10, s[8:11], s67 offen offset:2048 sc1
  buffer_load_dwordx4 v[204:207], v11, s[8:11], s67 offen offset:2048 sc1
  buffer_load_dwordx4 a[40:43], v8, s[8:11], s37 offen offset:2048 sc1
  buffer_load_dwordx4 a[44:47], v9, s[8:11], s37 offen offset:2048 sc1
  s_add_u32 s37, s37, 4096
  v_mfma_f32_32x32x16_bf16 v[88:103], a[248:251], a[124:127], v[88:103]
  v_mfma_f32_32x32x16_bf16 v[32:47], a[252:255], a[120:123], v[32:47]
  v_mfma_f32_32x32x16_bf16 v[16:31], a[248:251], a[120:123], v[16:31]
  s_waitcnt vmcnt(20)
  v_mfma_f32_32x32x16_bf16 v[64:79], v[164:167], a[4:7], v[64:79]
  s_add_u32 s67, s36, 45056
  buffer_load_dwordx4 v[208:211], v10, s[8:11], s67 offen offset:0 sc1
  buffer_load_dwordx4 v[212:215], v11, s[8:11], s67 offen offset:0 sc1
  buffer_load_dwordx4 a[48:51], v8, s[8:11], s37 offen offset:0 sc1
  buffer_load_dwordx4 a[52:55], v9, s[8:11], s37 offen offset:0 sc1
  s_xor_b32 s16, s20, 3
  v_mfma_f32_32x32x16_bf16 v[88:103], v[160:163], a[4:7], v[88:103]
  s_mul_i32 s16, s16, 12288
  v_mfma_f32_32x32x16_bf16 v[32:47], v[164:167], a[0:3], v[32:47]
  s_add_u32 s16, s16, 106496
  v_mfma_f32_32x32x16_bf16 v[16:31], v[160:163], a[0:3], v[16:31]
  v_add_u32 v107, s16, v1
  s_waitcnt vmcnt(20)
  v_mfma_f32_32x32x16_bf16 v[64:79], v[172:175], a[12:15], v[64:79]
  s_add_u32 s67, s36, 45056
  buffer_load_dwordx4 v[216:219], v10, s[8:11], s67 offen offset:2048 sc1
  buffer_load_dwordx4 v[220:223], v11, s[8:11], s67 offen offset:2048 sc1
  buffer_load_dwordx4 a[56:59], v8, s[8:11], s37 offen offset:2048 sc1
  buffer_load_dwordx4 a[60:63], v9, s[8:11], s37 offen offset:2048 sc1
  s_add_u32 s37, s37, 4096
  s_xor_b32 s16, s20, 2
  v_mfma_f32_32x32x16_bf16 v[88:103], v[168:171], a[12:15], v[88:103]
  s_mul_i32 s16, s16, 12288
  v_mfma_f32_32x32x16_bf16 v[32:47], v[172:175], a[8:11], v[32:47]
  s_add_u32 s16, s16, 102400
  v_mfma_f32_32x32x16_bf16 v[16:31], v[168:171], a[8:11], v[16:31]
  v_add_u32 v106, s16, v1
  s_waitcnt vmcnt(20)
  v_mfma_f32_32x32x16_bf16 v[64:79], v[180:183], a[20:23], v[64:79]
  s_add_u32 s67, s36, 49152
  buffer_load_dwordx4 v[224:227], v10, s[8:11], s67 offen offset:0 sc1
  buffer_load_dwordx4 v[228:231], v11, s[8:11], s67 offen offset:0 sc1
  buffer_load_dwordx4 a[64:67], v8, s[8:11], s37 offen offset:0 sc1
  buffer_load_dwordx4 a[68:71], v9, s[8:11], s37 offen offset:0 sc1
  s_xor_b32 s16, s20, 1
  v_mfma_f32_32x32x16_bf16 v[88:103], v[176:179], a[20:23], v[88:103]
  s_mul_i32 s16, s16, 12288
  v_mfma_f32_32x32x16_bf16 v[32:47], v[180:183], a[16:19], v[32:47]
  s_add_u32 s16, s16, 98304
  v_mfma_f32_32x32x16_bf16 v[16:31], v[176:179], a[16:19], v[16:31]
  v_add_u32 v105, s16, v1
  s_waitcnt vmcnt(20)
  v_mfma_f32_32x32x16_bf16 v[64:79], v[188:191], a[28:31], v[64:79]
  s_add_u32 s67, s36, 49152
  buffer_load_dwordx4 v[232:235], v10, s[8:11], s67 offen offset:2048 sc1
  buffer_load_dwordx4 v[236:239], v11, s[8:11], s67 offen offset:2048 sc1
  buffer_load_dwordx4 a[72:75], v8, s[8:11], s37 offen offset:2048 sc1
  buffer_load_dwordx4 a[76:79], v9, s[8:11], s37 offen offset:2048 sc1
  s_add_u32 s37, s37, 4096
  s_mul_i32 s16, s20, 12288
  v_mfma_f32_32x32x16_bf16 v[88:103], v[184:187], a[28:31], v[88:103]
  s_add_u32 s16, s16, 98304
  v_mfma_f32_32x32x16_bf16 v[32:47], v[188:191], a[24:27], v[32:47]
  v_add_u32 v104, s16, v1
  v_mfma_f32_32x32x16_bf16 v[16:31], v[184:187], a[24:27], v[16:31]
  s_mov_b32 s17, 0xffff0000
  s_waitcnt vmcnt(20)
  v_mfma_f32_32x32x16_bf16 v[64:79], v[196:199], a[36:39], v[64:79]
  s_add_u32 s67, s36, 53248
  buffer_load_dwordx4 v[240:243], v10, s[8:11], s67 offen offset:0 sc1
  buffer_load_dwordx4 v[244:247], v11, s[8:11], s67 offen offset:0 sc1
  buffer_load_dwordx4 a[80:83], v8, s[8:11], s37 offen offset:0 sc1
  buffer_load_dwordx4 a[84:87], v9, s[8:11], s37 offen offset:0 sc1
  v_lshlrev_b32 v48, 16, v80
  v_mfma_f32_32x32x16_bf16 v[88:103], v[192:195], a[36:39], v[88:103]
  v_and_b32 v49, s17, v80
  v_mfma_f32_32x32x16_bf16 v[32:47], v[196:199], a[32:35], v[32:47]
  v_lshlrev_b32 v50, 16, v81
  v_mfma_f32_32x32x16_bf16 v[16:31], v[192:195], a[32:35], v[16:31]
  v_and_b32 v51, s17, v81
  s_waitcnt vmcnt(20)
  v_mfma_f32_32x32x16_bf16 v[64:79], v[204:207], a[44:47], v[64:79]
  s_add_u32 s67, s36, 53248
  buffer_load_dwordx4 v[248:251], v10, s[8:11], s67 offen offset:2048 sc1
  buffer_load_dwordx4 v[252:255], v11, s[8:11], s67 offen offset:2048 sc1
  buffer_load_dwordx4 a[88:91], v8, s[8:11], s37 offen offset:2048 sc1
  buffer_load_dwordx4 a[92:95], v9, s[8:11], s37 offen offset:2048 sc1
  s_add_u32 s37, s37, 4096
  v_lshlrev_b32 v52, 16, v82
  v_mfma_f32_32x32x16_bf16 v[88:103], v[200:203], a[44:47], v[88:103]
  v_and_b32 v53, s17, v82
  v_mfma_f32_32x32x16_bf16 v[32:47], v[204:207], a[40:43], v[32:47]
  s_add_u32 m0, s31, 16384
  s_nop 0
  buffer_load_dwordx4 v1, s[8:11], s32 offen offset:0 sc1 lds
  v_lshlrev_b32 v54, 16, v83
  v_mfma_f32_32x32x16_bf16 v[16:31], v[200:203], a[40:43], v[16:31]
  v_and_b32 v55, s17, v83
  s_waitcnt vmcnt(21)
  v_mfma_f32_32x32x16_bf16 v[64:79], v[212:215], a[52:55], v[64:79]
  s_add_u32 m0, s31, 16384
  s_nop 0
  buffer_load_dwordx4 v1, s[8:11], s32 offen offset:1024 sc1 lds
  v_lshlrev_b32 v56, 16, v84
  v_mfma_f32_32x32x16_bf16 v[88:103], v[208:211], a[52:55], v[88:103]
  v_and_b32 v57, s17, v84
  v_mfma_f32_32x32x16_bf16 v[32:47], v[212:215], a[48:51], v[32:47]
  s_add_u32 m0, s31, 16384
  s_nop 0
  buffer_load_dwordx4 v1, s[8:11], s32 offen offset:2048 sc1 lds
  v_lshlrev_b32 v58, 16, v85
  v_mfma_f32_32x32x16_bf16 v[16:31], v[208:211], a[48:51], v[16:31]
  v_and_b32 v59, s17, v85
  s_waitcnt vmcnt(19)
  v_mfma_f32_32x32x16_bf16 v[64:79], v[220:223], a[60:63], v[64:79]
  s_add_u32 m0, s31, 16384
  s_nop 0
  buffer_load_dwordx4 v1, s[8:11], s32 offen offset:3072 sc1 lds
  s_add_u32 s32, s32, 16384
  v_lshlrev_b32 v60, 16, v86
  v_mfma_f32_32x32x16_bf16 v[88:103], v[216:219], a[60:63], v[88:103]
  v_and_b32 v61, s17, v86
  v_mfma_f32_32x32x16_bf16 v[32:47], v[220:223], a[56:59], v[32:47]
  s_add_u32 m0, s31, 32768
  s_nop 0
  buffer_load_dwordx4 v1, s[8:11], s32 offen offset:0 sc1 lds
  v_lshlrev_b32 v62, 16, v87
  v_mfma_f32_32x32x16_bf16 v[16:31], v[216:219], a[56:59], v[16:31]
  v_and_b32 v63, s17, v87
  s_waitcnt vmcnt(17)
  v_mfma_f32_32x32x16_bf16 v[64:79], v[228:231], a[68:71], v[64:79]
  s_add_u32 m0, s31, 32768
  s_nop 0
  buffer_load_dwordx4 v1, s[8:11], s32 offen offset:1024 sc1 lds
  s_waitcnt vmcnt(14)
  v_mfma_f32_32x32x16_bf16 v[64:79], v[236:239], a[76:79], v[64:79]
  s_add_u32 m0, s31, 32768
  s_nop 0
  buffer_load_dwordx4 v1, s[8:11], s32 offen offset:2048 sc1 lds
  s_waitcnt vmcnt(11)
  v_mfma_f32_32x32x16_bf16 v[64:79], v[244:247], a[84:87], v[64:79]
  s_add_u32 m0, s31, 32768
  s_nop 0
  buffer_load_dwordx4 v1, s[8:11], s32 offen offset:3072 sc1 lds
  s_add_u32 s32, s32, 16384
  s_waitcnt vmcnt(8)
  v_mfma_f32_32x32x16_bf16 v[64:79], v[252:255], a[92:95], v[64:79]
  s_add_u32 m0, s31, 49152
  s_nop 0
  buffer_load_dwordx4 v1, s[8:11], s32 offen offset:0 sc1 lds
  v_mfma_f32_32x32x16_bf16 v[88:103], v[224:227], a[68:71], v[88:103]
  v_mfma_f32_32x32x16_bf16 v[88:103], v[232:235], a[76:79], v[88:103]
  s_nop 6
  ds_write_b128 v107, v[64:67] offset:0
  ds_write_b128 v107, v[68:71] offset:1024
  v_mfma_f32_32x32x16_bf16 v[88:103], v[240:243], a[84:87], v[88:103]
  ds_write_b128 v107, v[72:75] offset:2048
  v_mfma_f32_32x32x16_bf16 v[88:103], v[248:251], a[92:95], v[88:103]
  ds_write_b128 v107, v[76:79] offset:3072
  v_mfma_f32_32x32x16_bf16 v[32:47], v[228:231], a[64:67], v[32:47]
  s_add_u32 m0, s31, 49152
  s_nop 0
  buffer_load_dwordx4 v1, s[8:11], s32 offen offset:1024 sc1 lds
  v_mfma_f32_32x32x16_bf16 v[32:47], v[236:239], a[72:75], v[32:47]
  s_add_u32 m0, s31, 49152
  s_nop 0
  buffer_load_dwordx4 v1, s[8:11], s32 offen offset:2048 sc1 lds
  s_nop 2
  ds_write_b128 v106, v[88:91] offset:0
  ds_write_b128 v106, v[92:95] offset:1024
  v_mfma_f32_32x32x16_bf16 v[32:47], v[244:247], a[80:83], v[32:47]
  s_add_u32 m0, s31, 49152
  s_nop 0
  buffer_load_dwordx4 v1, s[8:11], s32 offen offset:3072 sc1 lds
  s_add_u32 s32, s32, 16384
  ds_write_b128 v106, v[96:99] offset:2048
  v_mfma_f32_32x32x16_bf16 v[32:47], v[252:255], a[88:91], v[32:47]
  ds_write_b128 v106, v[100:103] offset:3072
  v_mfma_f32_32x32x16_bf16 v[16:31], v[224:227], a[64:67], v[16:31]
  v_mfma_f32_32x32x16_bf16 v[16:31], v[232:235], a[72:75], v[16:31]
  s_nop 8
  ds_write_b128 v105, v[32:35] offset:0
  ds_write_b128 v105, v[36:39] offset:1024
  v_mfma_f32_32x32x16_bf16 v[16:31], v[240:243], a[80:83], v[16:31]
  ds_write_b128 v105, v[40:43] offset:2048
  v_mfma_f32_32x32x16_bf16 v[16:31], v[248:251], a[88:91], v[16:31]
  ds_write_b128 v105, v[44:47] offset:3072
  s_waitcnt lgkmcnt(0)
  s_barrier
  ds_read_b128 v[32:35], v104 offset:0
  ds_read_b128 v[88:91], v104 offset:4096
  ds_read_b128 v[64:67], v104 offset:8192
  ds_read_b128 v[36:39], v104 offset:1024
  ds_read_b128 v[92:95], v104 offset:5120
  ds_read_b128 v[68:71], v104 offset:9216
  ds_read_b128 v[40:43], v104 offset:2048
  ds_read_b128 v[96:99], v104 offset:6144
  ds_read_b128 v[72:75], v104 offset:10240
  ds_read_b128 v[44:47], v104 offset:3072
  ds_read_b128 v[100:103], v104 offset:7168
  ds_read_b128 v[76:79], v104 offset:11264
  v_pk_add_f32 v[16:17], v[16:17], v[48:49]
  v_pk_add_f32 v[18:19], v[18:19], v[50:51]
  v_pk_add_f32 v[20:21], v[20:21], v[52:53]
  v_pk_add_f32 v[22:23], v[22:23], v[54:55]
  v_pk_add_f32 v[24:25], v[24:25], v[56:57]
  v_pk_add_f32 v[26:27], v[26:27], v[58:59]
  v_pk_add_f32 v[28:29], v[28:29], v[60:61]
  v_pk_add_f32 v[30:31], v[30:31], v[62:63]
  s_waitcnt lgkmcnt(11)
  v_pk_add_f32 v[16:17], v[16:17], v[32:33]
  v_pk_add_f32 v[18:19], v[18:19], v[34:35]
  s_waitcnt lgkmcnt(10)
  v_pk_add_f32 v[16:17], v[16:17], v[88:89]
  v_pk_add_f32 v[18:19], v[18:19], v[90:91]
  s_waitcnt lgkmcnt(9)
  v_pk_add_f32 v[16:17], v[16:17], v[64:65]
  v_pk_add_f32 v[18:19], v[18:19], v[66:67]
  v_cvt_pk_bf16_f32 v80, v16, v17
  v_cvt_pk_bf16_f32 v81, v18, v19
  s_waitcnt lgkmcnt(8)
  v_pk_add_f32 v[20:21], v[20:21], v[36:37]
  v_pk_add_f32 v[22:23], v[22:23], v[38:39]
  s_waitcnt lgkmcnt(7)
  v_pk_add_f32 v[20:21], v[20:21], v[92:93]
  v_pk_add_f32 v[22:23], v[22:23], v[94:95]
  s_waitcnt lgkmcnt(6)
  v_pk_add_f32 v[20:21], v[20:21], v[68:69]
  v_pk_add_f32 v[22:23], v[22:23], v[70:71]
  v_cvt_pk_bf16_f32 v82, v20, v21
  v_cvt_pk_bf16_f32 v83, v22, v23
  buffer_store_dwordx4 v[80:83], v1, s[8:11], s48 offen offset:0 sc1
  s_waitcnt lgkmcnt(5)
  v_pk_add_f32 v[24:25], v[24:25], v[40:41]
  v_pk_add_f32 v[26:27], v[26:27], v[42:43]
  s_waitcnt lgkmcnt(4)
  v_pk_add_f32 v[24:25], v[24:25], v[96:97]
  v_pk_add_f32 v[26:27], v[26:27], v[98:99]
  s_waitcnt lgkmcnt(3)
  v_pk_add_f32 v[24:25], v[24:25], v[72:73]
  v_pk_add_f32 v[26:27], v[26:27], v[74:75]
  v_cvt_pk_bf16_f32 v84, v24, v25
  v_cvt_pk_bf16_f32 v85, v26, v27
  s_waitcnt lgkmcnt(2)
  v_pk_add_f32 v[28:29], v[28:29], v[44:45]
  v_pk_add_f32 v[30:31], v[30:31], v[46:47]
  s_waitcnt lgkmcnt(1)
  v_pk_add_f32 v[28:29], v[28:29], v[100:101]
  v_pk_add_f32 v[30:31], v[30:31], v[102:103]
  s_waitcnt lgkmcnt(0)
  v_pk_add_f32 v[28:29], v[28:29], v[76:77]
  v_pk_add_f32 v[30:31], v[30:31], v[78:79]
  v_cvt_pk_bf16_f32 v86, v28, v29
  v_cvt_pk_bf16_f32 v87, v30, v31
  buffer_store_dwordx4 v[84:87], v1, s[8:11], s48 offen offset:1024 sc1
  v_pk_add_f32 v[112:113], v[16:17], v[18:19]
  v_pk_add_f32 v[114:115], v[20:21], v[22:23]
  v_pk_add_f32 v[112:113], v[112:113], v[24:25]
  v_pk_add_f32 v[114:115], v[114:115], v[26:27]
  v_pk_add_f32 v[112:113], v[112:113], v[28:29]
  v_pk_add_f32 v[114:115], v[114:115], v[30:31]
  v_pk_add_f32 v[112:113], v[112:113], v[114:115]
  v_add_f32 v112, v112, v113
  v_mov_b32 v114, v112
  s_nop 1
  v_permlane32_swap_b32 v114, v112
  v_add_f32 v112, v114, v112
  v_mul_f32 v112, 0x3d000000, v112
  v_pk_add_f32 v[16:17], v[16:17], v[112:113] op_sel_hi:[1,0] neg_lo:[0,1] neg_hi:[0,1]
  v_pk_add_f32 v[18:19], v[18:19], v[112:113] op_sel_hi:[1,0] neg_lo:[0,1] neg_hi:[0,1]
  v_pk_add_f32 v[20:21], v[20:21], v[112:113] op_sel_hi:[1,0] neg_lo:[0,1] neg_hi:[0,1]
  v_pk_add_f32 v[22:23], v[22:23], v[112:113] op_sel_hi:[1,0] neg_lo:[0,1] neg_hi:[0,1]
  v_pk_add_f32 v[24:25], v[24:25], v[112:113] op_sel_hi:[1,0] neg_lo:[0,1] neg_hi:[0,1]
  v_pk_add_f32 v[26:27], v[26:27], v[112:113] op_sel_hi:[1,0] neg_lo:[0,1] neg_hi:[0,1]
  v_pk_add_f32 v[28:29], v[28:29], v[112:113] op_sel_hi:[1,0] neg_lo:[0,1] neg_hi:[0,1]
  v_pk_add_f32 v[30:31], v[30:31], v[112:113] op_sel_hi:[1,0] neg_lo:[0,1] neg_hi:[0,1]
  v_pk_mul_f32 v[114:115], v[16:17], v[16:17]
  v_pk_mul_f32 v[16:17], v[18:19], v[18:19]
  v_pk_fma_f32 v[114:115], v[20:21], v[20:21], v[114:115]
  v_pk_fma_f32 v[16:17], v[22:23], v[22:23], v[16:17]
  v_pk_fma_f32 v[114:115], v[24:25], v[24:25], v[114:115]
  v_pk_fma_f32 v[16:17], v[26:27], v[26:27], v[16:17]
  v_pk_fma_f32 v[114:115], v[28:29], v[28:29], v[114:115]
  v_pk_fma_f32 v[16:17], v[30:31], v[30:31], v[16:17]
  v_pk_add_f32 v[114:115], v[114:115], v[16:17]
  v_add_f32 v113, v114, v115
  v_min_u32 v112, -2, v112
  v_mov_b32 v114, v113
  s_nop 1
  v_permlane32_swap_b32 v114, v113
  v_add_f32 v113, v114, v113
  buffer_store_dwordx2 v[112:113], v12, s[8:11], s49 offen sc1
  s_waitcnt vmcnt(3)
  s_barrier
  ds_read_b128 v[88:91], v1 offset:0
  ds_read_b128 v[92:95], v1 offset:1024
  ds_read_b128 v[96:99], v1 offset:2048
  s_waitcnt vmcnt(0)
  v_mov_b32 v14, s50
  s_mov_b64 exec, 1
  buffer_store_dword v14, v13, s[8:11], s30 offen sc1
  s_mov_b64 exec, -1
  s_lshl_b32 s34, s23, 15
  s_add_u32 s34, s34, 11796480
  s_lshl_b32 s35, s23, 12
  s_add_u32 s35, s35, 16515072
  s_mov_b32 s58, 0
poll_80:
  buffer_load_dword v14, v138, s[8:11], s42 offen sc1
  s_waitcnt vmcnt(0)
  v_cmp_gt_u32 vcc, s50, v14
  s_add_u32 s58, s58, 1
  s_cmp_gt_u32 s58, 0x200000
  s_cbranch_scc1 poll_80_x
  s_cbranch_vccnz poll_80
poll_80_x:
  buffer_load_dwordx4 a[0:3], v1, s[8:11], s34 offen offset:0 sc1
  buffer_load_dwordx4 a[4:7], v1, s[8:11], s34 offen offset:1024 sc1
  buffer_load_dwordx4 a[8:11], v1, s[8:11], s34 offen offset:2048 sc1
  buffer_load_dwordx4 a[12:15], v1, s[8:11], s34 offen offset:3072 sc1
  s_add_u32 s34, s34, 4096
  buffer_load_dwordx4 a[16:19], v1, s[8:11], s34 offen offset:0 sc1
  buffer_load_dwordx4 a[20:23], v1, s[8:11], s34 offen offset:1024 sc1
  buffer_load_dwordx4 a[24:27], v1, s[8:11], s34 offen offset:2048 sc1
  buffer_load_dwordx4 a[28:31], v1, s[8:11], s34 offen offset:3072 sc1
  s_add_u32 s34, s34, 4096
  buffer_load_dwordx4 a[32:35], v1, s[8:11], s34 offen offset:0 sc1
  buffer_load_dwordx4 a[36:39], v1, s[8:11], s34 offen offset:1024 sc1
  s_mov_b32 s26, 1
  s_branch L_safe
L_safe_k4b:
  s_waitcnt vmcnt(12)
  v_mfma_f32_32x32x16_bf16 v[64:79], a[132:135], a[4:7], 0
  buffer_load_dwordx4 a[48:51], v8, s[8:11], s37 offen offset:0 sc1
  buffer_load_dwordx4 a[52:55], v9, s[8:11], s37 offen offset:0 sc1
  s_nop 1
  v_mul_f32 v144, v136, v48
  v_mul_f32 v145, v136, v49
  v_exp_f32 v144, v144
  v_mfma_f32_32x32x16_bf16 v[88:103], a[128:131], a[4:7], 0
  v_mul_f32 v146, v136, v50
  v_exp_f32 v145, v145
  v_fma_f32 v144, v144, v137, v137
  v_mul_f32 v147, v136, v51
  v_mfma_f32_32x32x16_bf16 v[32:47], a[132:135], a[0:3], 0
  buffer_load_dwordx4 a[56:59], v8, s[8:11], s37 offen offset:2048 sc1
  buffer_load_dwordx4 a[60:63], v9, s[8:11], s37 offen offset:2048 sc1
  s_add_u32 s37, s37, 4096
  v_exp_f32 v146, v146
  v_fma_f32 v145, v145, v137, v137
  v_rcp_f32 v144, v144
  v_mul_f32 v148, v136, v52
  v_mfma_f32_32x32x16_bf16 v[16:31], a[128:131], a[0:3], 0
  v_exp_f32 v147, v147
  v_fma_f32 v146, v146, v137, v137
  v_rcp_f32 v145, v145
  v_mul_f32 v144, v144, v56
  s_waitcnt vmcnt(14)
  v_mfma_f32_32x32x16_bf16 v[64:79], a[140:143], a[12:15], v[64:79]
  buffer_load_dwordx4 a[64:67], v8, s[8:11], s37 offen offset:0 sc1
  buffer_load_dwordx4 a[68:71], v9, s[8:11], s37 offen offset:0 sc1
  v_mul_f32 v149, v136, v53
  v_exp_f32 v148, v148
  v_fma_f32 v147, v147, v137, v137
  v_mfma_f32_32x32x16_bf16 v[88:103], a[136:139], a[12:15], v[88:103]
  v_rcp_f32 v146, v146
  v_mul_f32 v145, v145, v57
  v_cvt_pk_bf16_f32 v120, v144, v145
  v_mul_f32 v150, v136, v54
  v_mfma_f32_32x32x16_bf16 v[32:47], a[140:143], a[8:11], v[32:47]
  v_exp_f32 v149, v149
  v_fma_f32 v148, v148, v137, v137
  v_rcp_f32 v147, v147
  v_mul_f32 v146, v146, v58
  v_mfma_f32_32x32x16_bf16 v[16:31], a[136:139], a[8:11], v[16:31]
  s_barrier
  v_mul_f32 v151, v136, v55
  v_exp_f32 v150, v150
  v_fma_f32 v149, v149, v137, v137
  v_rcp_f32 v148, v148
  s_waitcnt vmcnt(14)
  v_mfma_f32_32x32x16_bf16 v[64:79], a[148:151], a[20:23], v[64:79]
  buffer_load_dwordx4 a[72:75], v8, s[8:11], s37 offen offset:2048 sc1
  buffer_load_dwordx4 a[76:79], v9, s[8:11], s37 offen offset:2048 sc1
  s_add_u32 s37, s37, 4096
  v_mul_f32 v147, v147, v59
  v_cvt_pk_bf16_f32 v121, v146, v147
  v_exp_f32 v151, v151
  v_mfma_f32_32x32x16_bf16 v[88:103], a[144:147], a[20:23], v[88:103]
  v_fma_f32 v150, v150, v137, v137
  v_rcp_f32 v149, v149
  v_mul_f32 v148, v148, v60
  v_fma_f32 v151, v151, v137, v137
  v_mfma_f32_32x32x16_bf16 v[32:47], a[148:151], a[16:19], v[32:47]
  v_rcp_f32 v150, v150
  v_mul_f32 v149, v149, v61
  v_cvt_pk_bf16_f32 v122, v148, v149
  v_rcp_f32 v151, v151
  v_mfma_f32_32x32x16_bf16 v[16:31], a[144:147], a[16:19], v[16:31]
  buffer_load_dword v158, v139, s[8:11], s51 offen sc1
  v_mul_f32 v150, v150, v62
  v_mul_f32 v151, v151, v63
  v_cvt_pk_bf16_f32 v123, v150, v151
  buffer_store_dwordx4 v[120:123], v1, s[8:11], s52 offen sc1
  s_add_u32 s52, s52, 8192
  s_waitcnt vmcnt(16)
  v_mfma_f32_32x32x16_bf16 v[64:79], a[156:159], a[28:31], v[64:79]
  buffer_load_dwordx4 a[80:83], v8, s[8:11], s37 offen offset:0 sc1
  buffer_load_dwordx4 a[84:87], v9, s[8:11], s37 offen offset:0 sc1
  v_mfma_f32_32x32x16_bf16 v[88:103], a[152:155], a[28:31], v[88:103]
  v_mfma_f32_32x32x16_bf16 v[32:47], a[156:159], a[24:27], v[32:47]
  v_mfma_f32_32x32x16_bf16 v[16:31], a[152:155], a[24:27], v[16:31]
  s_waitcnt vmcnt(16)
  v_mfma_f32_32x32x16_bf16 v[64:79], a[164:167], a[36:39], v[64:79]
  buffer_load_dwordx4 a[88:91], v8, s[8:11], s37 offen offset:2048 sc1
  buffer_load_dwordx4 a[92:95], v9, s[8:11], s37 offen offset:2048 sc1
  s_add_u32 s37, s37, 4096
  v_mfma_f32_32x32x16_bf16 v[88:103], a[160:163], a[36:39], v[88:103]
  v_mfma_f32_32x32x16_bf16 v[32:47], a[164:167], a[32:35], v[32:47]
  v_mfma_f32_32x32x16_bf16 v[16:31], a[160:163], a[32:35], v[16:31]
  s_waitcnt vmcnt(16)
  v_mfma_f32_32x32x16_bf16 v[64:79], a[172:175], a[44:47], v[64:79]
  v_mfma_f32_32x32x16_bf16 v[88:103], a[168:171], a[44:47], v[88:103]
  v_mfma_f32_32x32x16_bf16 v[32:47], a[172:175], a[40:43], v[32:47]
  v_mfma_f32_32x32x16_bf16 v[16:31], a[168:171], a[40:43], v[16:31]
  s_waitcnt vmcnt(4)
  v_mov_b32 v14, s55
  s_mov_b64 exec, 1
  buffer_store_dword v14, v13, s[8:11], s47 offen sc1
  s_mov_b64 exec, -1
  v_mfma_f32_32x32x16_bf16 v[64:79], a[180:183], a[52:55], v[64:79]
  v_cmp_gt_u32 vcc, s54, v158
  s_nop 0
  s_cbranch_vccz poll_81_x
  s_mov_b32 s58, 0
poll_81:
  buffer_load_dword v158, v139, s[8:11], s51 offen sc1
  s_waitcnt vmcnt(0)
  v_cmp_gt_u32 vcc, s54, v158
  s_add_u32 s58, s58, 1
  s_cmp_gt_u32 s58, 0x200000
  s_cbranch_scc1 poll_81_x
  s_cbranch_vccnz poll_81
poll_81_x:
  buffer_load_dwordx4 a[96:99], v8, s[8:11], s37 offen offset:0 sc1
  buffer_load_dwordx4 a[100:103], v9, s[8:11], s37 offen offset:0 sc1
  v_mfma_f32_32x32x16_bf16 v[88:103], a[176:179], a[52:55], v[88:103]
  v_mfma_f32_32x32x16_bf16 v[32:47], a[180:183], a[48:51], v[32:47]
  buffer_load_dwordx4 a[104:107], v8, s[8:11], s37 offen offset:2048 sc1
  buffer_load_dwordx4 a[108:111], v9, s[8:11], s37 offen offset:2048 sc1
  s_add_u32 s37, s37, 4096
  v_mfma_f32_32x32x16_bf16 v[16:31], a[176:179], a[48:51], v[16:31]
  v_mfma_f32_32x32x16_bf16 v[64:79], a[188:191], a[60:63], v[64:79]
  buffer_load_dwordx4 a[112:115], v8, s[8:11], s37 offen offset:0 sc1
  buffer_load_dwordx4 a[116:119], v9, s[8:11], s37 offen offset:0 sc1
  v_mfma_f32_32x32x16_bf16 v[88:103], a[184:187], a[60:63], v[88:103]
  v_mfma_f32_32x32x16_bf16 v[32:47], a[188:191], a[56:59], v[32:47]
  v_mfma_f32_32x32x16_bf16 v[16:31], a[184:187], a[56:59], v[16:31]
  v_mfma_f32_32x32x16_bf16 v[64:79], a[196:199], a[68:71], v[64:79]
  buffer_load_dwordx4 a[120:123], v8, s[8:11], s37 offen offset:2048 sc1
  buffer_load_dwordx4 a[124:127], v9, s[8:11], s37 offen offset:2048 sc1
  s_add_u32 s37, s37, 4096
  v_mfma_f32_32x32x16_bf16 v[88:103], a[192:195], a[68:71], v[88:103]
  v_mfma_f32_32x32x16_bf16 v[32:47], a[196:199], a[64:67], v[32:47]
  v_mfma_f32_32x32x16_bf16 v[16:31], a[192:195], a[64:67], v[16:31]
  v_mfma_f32_32x32x16_bf16 v[64:79], a[204:207], a[76:79], v[64:79]
  buffer_load_dwordx4 a[0:3], v8, s[8:11], s37 offen offset:0 sc1
  buffer_load_dwordx4 a[4:7], v9, s[8:11], s37 offen offset:0 sc1
  v_mfma_f32_32x32x16_bf16 v[88:103], a[200:203], a[76:79], v[88:103]
  v_mfma_f32_32x32x16_bf16 v[32:47], a[204:207], a[72:75], v[32:47]
  v_mfma_f32_32x32x16_bf16 v[16:31], a[200:203], a[72:75], v[16:31]
  buffer_load_dword v159, v139, s[8:11], s51 offen sc1
  s_waitcnt vmcnt(14)
  v_mfma_f32_32x32x16_bf16 v[64:79], a[212:215], a[84:87], v[64:79]
  buffer_load_dwordx4 a[8:11], v8, s[8:11], s37 offen offset:2048 sc1
  buffer_load_dwordx4 a[12:15], v9, s[8:11], s37 offen offset:2048 sc1
  s_add_u32 s37, s37, 4096
  v_mfma_f32_32x32x16_bf16 v[88:103], a[208:211], a[84:87], v[88:103]
  v_mfma_f32_32x32x16_bf16 v[32:47], a[212:215], a[80:83], v[32:47]
  v_mfma_f32_32x32x16_bf16 v[16:31], a[208:211], a[80:83], v[16:31]
  s_waitcnt vmcnt(14)
  v_mfma_f32_32x32x16_bf16 v[64:79], a[220:223], a[92:95], v[64:79]
  buffer_load_dwordx4 a[16:19], v8, s[8:11], s37 offen offset:0 sc1
  buffer_load_dwordx4 a[20:23], v9, s[8:11], s37 offen offset:0 sc1
  v_mfma_f32_32x32x16_bf16 v[88:103], a[216:219], a[92:95], v[88:103]
  v_mfma_f32_32x32x16_bf16 v[32:47], a[220:223], a[88:91], v[32:47]
  v_mfma_f32_32x32x16_bf16 v[16:31], a[216:219], a[88:91], v[16:31]
  s_waitcnt vmcnt(13)
  v_mfma_f32_32x32x16_bf16 v[64:79], a[228:231], a[100:103], v[64:79]
  buffer_load_dwordx4 a[24:27], v8, s[8:11], s37 offen offset:2048 sc1
  buffer_load_dwordx4 a[28:31], v9, s[8:11], s37 offen offset:2048 sc1
  s_add_u32 s37, s37, 4096
  v_mfma_f32_32x32x16_bf16 v[88:103], a[224:227], a[100:103], v[88:103]
  v_mfma_f32_32x32x16_bf16 v[32:47], a[228:231], a[96:99], v[32:47]
  v_mfma_f32_32x32x16_bf16 v[16:31], a[224:227], a[96:99], v[16:31]
  s_waitcnt vmcnt(13)
  v_mfma_f32_32x32x16_bf16 v[64:79], a[236:239], a[108:111], v[64:79]
  v_mfma_f32_32x32x16_bf16 v[88:103], a[232:235], a[108:111], v[88:103]
  v_mfma_f32_32x32x16_bf16 v[32:47], a[236:239], a[104:107], v[32:47]
  v_mfma_f32_32x32x16_bf16 v[16:31], a[232:235], a[104:107], v[16:31]
  s_waitcnt vmcnt(11)
  v_mfma_f32_32x32x16_bf16 v[64:79], a[244:247], a[116:119], v[64:79]
  s_waitcnt vmcnt(6)
  v_cmp_gt_u32 vcc, s55, v159
  s_nop 0
  s_cbranch_vccz poll_82_x
  s_mov_b32 s58, 0
poll_82:
  buffer_load_dword v159, v139, s[8:11], s51 offen sc1
  s_waitcnt vmcnt(0)
  v_cmp_gt_u32 vcc, s55, v159
  s_add_u32 s58, s58, 1
  s_cmp_gt_u32 s58, 0x200000
  s_cbranch_scc1 poll_82_x
  s_cbranch_vccnz poll_82
poll_82_x:
  buffer_load_dwordx4 a[32:35], v8, s[8:11], s37 offen offset:0 sc1
  buffer_load_dwordx4 a[36:39], v9, s[8:11], s37 offen offset:0 sc1
  v_mfma_f32_32x32x16_bf16 v[88:103], a[240:243], a[116:119], v[88:103]
  v_mfma_f32_32x32x16_bf16 v[32:47], a[244:247], a[112:115], v[32:47]
  buffer_load_dwordx4 a[40:43], v8, s[8:11], s37 offen offset:2048 sc1
  buffer_load_dwordx4 a[44:47], v9, s[8:11], s37 offen offset:2048 sc1
  s_add_u32 s37, s37, 4096
  v_mfma_f32_32x32x16_bf16 v[16:31], a[240:243], a[112:115], v[16:31]
  v_mfma_f32_32x32x16_bf16 v[64:79], a[252:255], a[124:127], v[64:79]
  buffer_load_dwordx4 a[48:51], v8, s[8:11], s37 offen offset:0 sc1
  buffer_load_dwordx4 a[52:55], v9, s[8:11], s37 offen offset:0 sc1
  v_mfma_f32_32x32x16_bf16 v[88:103], a[248:251], a[124:127], v[88:103]
  v_mfma_f32_32x32x16_bf16 v[32:47], a[252:255], a[120:123], v[32:47]
  v_mfma_f32_32x32x16_bf16 v[16:31], a[248:251], a[120:123], v[16:31]
  v_mfma_f32_32x32x16_bf16 v[64:79], v[164:167], a[4:7], v[64:79]
  buffer_load_dwordx4 a[56:59], v8, s[8:11], s37 offen offset:2048 sc1
  buffer_load_dwordx4 a[60:63], v9, s[8:11], s37 offen offset:2048 sc1
  s_add_u32 s37, s37, 4096
  s_xor_b32 s16, s20, 3
  v_mfma_f32_32x32x16_bf16 v[88:103], v[160:163], a[4:7], v[88:103]
  s_mul_i32 s16, s16, 12288
  v_mfma_f32_32x32x16_bf16 v[32:47], v[164:167], a[0:3], v[32:47]
  s_add_u32 s16, s16, 106496
  v_mfma_f32_32x32x16_bf16 v[16:31], v[160:163], a[0:3], v[16:31]
  v_add_u32 v107, s16, v1
  s_waitcnt vmcnt(12)
  v_mfma_f32_32x32x16_bf16 v[64:79], v[172:175], a[12:15], v[64:79]
  buffer_load_dwordx4 a[64:67], v8, s[8:11], s37 offen offset:0 sc1
  buffer_load_dwordx4 a[68:71], v9, s[8:11], s37 offen offset:0 sc1
  s_xor_b32 s16, s20, 2
  v_mfma_f32_32x32x16_bf16 v[88:103], v[168:171], a[12:15], v[88:103]
  s_mul_i32 s16, s16, 12288
  v_mfma_f32_32x32x16_bf16 v[32:47], v[172:175], a[8:11], v[32:47]
  s_add_u32 s16, s16, 102400
  v_mfma_f32_32x32x16_bf16 v[16:31], v[168:171], a[8:11], v[16:31]
  v_add_u32 v106, s16, v1
  s_waitcnt vmcnt(12)
  v_mfma_f32_32x32x16_bf16 v[64:79], v[180:183], a[20:23], v[64:79]
  buffer_load_dwordx4 a[72:75], v8, s[8:11], s37 offen offset:2048 sc1
  buffer_load_dwordx4 a[76:79], v9, s[8:11], s37 offen offset:2048 sc1
  s_add_u32 s37, s37, 4096
  s_xor_b32 s16, s20, 1
  v_mfma_f32_32x32x16_bf16 v[88:103], v[176:179], a[20:23], v[88:103]
  s_mul_i32 s16, s16, 12288
  v_mfma_f32_32x32x16_bf16 v[32:47], v[180:183], a[16:19], v[32:47]
  s_add_u32 s16, s16, 98304
  v_mfma_f32_32x32x16_bf16 v[16:31], v[176:179], a[16:19], v[16:31]
  v_add_u32 v105, s16, v1
  s_waitcnt vmcnt(12)
  v_mfma_f32_32x32x16_bf16 v[64:79], v[188:191], a[28:31], v[64:79]
  buffer_load_dwordx4 a[80:83], v8, s[8:11], s37 offen offset:0 sc1
  buffer_load_dwordx4 a[84:87], v9, s[8:11], s37 offen offset:0 sc1
  s_mul_i32 s16, s20, 12288
  v_mfma_f32_32x32x16_bf16 v[88:103], v[184:187], a[28:31], v[88:103]
  s_add_u32 s16, s16, 98304
  v_mfma_f32_32x32x16_bf16 v[32:47], v[188:191], a[24:27], v[32:47]
  v_add_u32 v104, s16, v1
  v_mfma_f32_32x32x16_bf16 v[16:31], v[184:187], a[24:27], v[16:31]
  s_mov_b32 s17, 0xffff0000
  s_waitcnt vmcnt(12)
  v_mfma_f32_32x32x16_bf16 v[64:79], v[196:199], a[36:39], v[64:79]
  buffer_load_dwordx4 a[88:91], v8, s[8:11], s37 offen offset:2048 sc1
  buffer_load_dwordx4 a[92:95], v9, s[8:11], s37 offen offset:2048 sc1
  s_add_u32 s37, s37, 4096
  v_lshlrev_b32 v48, 16, v80
  v_mfma_f32_32x32x16_bf16 v[88:103], v[192:195], a[36:39], v[88:103]
  v_and_b32 v49, s17, v80
  v_mfma_f32_32x32x16_bf16 v[32:47], v[196:199], a[32:35], v[32:47]
  v_lshlrev_b32 v50, 16, v81
  v_mfma_f32_32x32x16_bf16 v[16:31], v[192:195], a[32:35], v[16:31]
  v_and_b32 v51, s17, v81
  s_waitcnt vmcnt(12)
  v_mfma_f32_32x32x16_bf16 v[64:79], v[204:207], a[44:47], v[64:79]
  v_lshlrev_b32 v52, 16, v82
  v_mfma_f32_32x32x16_bf16 v[88:103], v[200:203], a[44:47], v[88:103]
  v_and_b32 v53, s17, v82
  v_mfma_f32_32x32x16_bf16 v[32:47], v[204:207], a[40:43], v[32:47]
  v_lshlrev_b32 v54, 16, v83
  v_mfma_f32_32x32x16_bf16 v[16:31], v[200:203], a[40:43], v[16:31]
  v_and_b32 v55, s17, v83
  s_waitcnt vmcnt(10)
  v_mfma_f32_32x32x16_bf16 v[64:79], v[212:215], a[52:55], v[64:79]
  v_lshlrev_b32 v56, 16, v84
  v_mfma_f32_32x32x16_bf16 v[88:103], v[208:211], a[52:55], v[88:103]
  v_and_b32 v57, s17, v84
  v_mfma_f32_32x32x16_bf16 v[32:47], v[212:215], a[48:51], v[32:47]
  v_lshlrev_b32 v58, 16, v85
  v_mfma_f32_32x32x16_bf16 v[16:31], v[208:211], a[48:51], v[16:31]
  v_and_b32 v59, s17, v85
  s_waitcnt vmcnt(8)
  v_mfma_f32_32x32x16_bf16 v[64:79], v[220:223], a[60:63], v[64:79]
  v_lshlrev_b32 v60, 16, v86
  v_mfma_f32_32x32x16_bf16 v[88:103], v[216:219], a[60:63], v[88:103]
  v_and_b32 v61, s17, v86
  v_mfma_f32_32x32x16_bf16 v[32:47], v[220:223], a[56:59], v[32:47]
  v_lshlrev_b32 v62, 16, v87
  v_mfma_f32_32x32x16_bf16 v[16:31], v[216:219], a[56:59], v[16:31]
  v_and_b32 v63, s17, v87
  s_waitcnt vmcnt(6)
  v_mfma_f32_32x32x16_bf16 v[64:79], v[228:231], a[68:71], v[64:79]
  s_waitcnt vmcnt(4)
  v_mfma_f32_32x32x16_bf16 v[64:79], v[236:239], a[76:79], v[64:79]
  s_waitcnt vmcnt(2)
  v_mfma_f32_32x32x16_bf16 v[64:79], v[244:247], a[84:87], v[64:79]
  s_waitcnt vmcnt(0)
  v_mfma_f32_32x32x16_bf16 v[64:79], v[252:255], a[92:95], v[64:79]
  v_mfma_f32_32x32x16_bf16 v[88:103], v[224:227], a[68:71], v[88:103]
  v_mfma_f32_32x32x16_bf16 v[88:103], v[232:235], a[76:79], v[88:103]
  s_nop 9
  ds_write_b128 v107, v[64:67] offset:0
  ds_write_b128 v107, v[68:71] offset:1024
  v_mfma_f32_32x32x16_bf16 v[88:103], v[240:243], a[84:87], v[88:103]
  ds_write_b128 v107, v[72:75] offset:2048
  v_mfma_f32_32x32x16_bf16 v[88:103], v[248:251], a[92:95], v[88:103]
  ds_write_b128 v107, v[76:79] offset:3072
  v_mfma_f32_32x32x16_bf16 v[32:47], v[228:231], a[64:67], v[32:47]
  v_mfma_f32_32x32x16_bf16 v[32:47], v[236:239], a[72:75], v[32:47]
  s_nop 8
  ds_write_b128 v106, v[88:91] offset:0
  ds_write_b128 v106, v[92:95] offset:1024
  v_mfma_f32_32x32x16_bf16 v[32:47], v[244:247], a[80:83], v[32:47]
  ds_write_b128 v106, v[96:99] offset:2048
  v_mfma_f32_32x32x16_bf16 v[32:47], v[252:255], a[88:91], v[32:47]
  ds_write_b128 v106, v[100:103] offset:3072
  v_mfma_f32_32x32x16_bf16 v[16:31], v[224:227], a[64:67], v[16:31]
  v_mfma_f32_32x32x16_bf16 v[16:31], v[232:235], a[72:75], v[16:31]
  s_nop 8
  ds_write_b128 v105, v[32:35] offset:0
  ds_write_b128 v105, v[36:39] offset:1024
  v_mfma_f32_32x32x16_bf16 v[16:31], v[240:243], a[80:83], v[16:31]
  ds_write_b128 v105, v[40:43] offset:2048
  v_mfma_f32_32x32x16_bf16 v[16:31], v[248:251], a[88:91], v[16:31]
  ds_write_b128 v105, v[44:47] offset:3072
  s_waitcnt lgkmcnt(0)
  s_barrier
  ds_read_b128 v[32:35], v104 offset:0
  ds_read_b128 v[88:91], v104 offset:4096
  ds_read_b128 v[64:67], v104 offset:8192
  ds_read_b128 v[36:39], v104 offset:1024
  ds_read_b128 v[92:95], v104 offset:5120
  ds_read_b128 v[68:71], v104 offset:9216
  ds_read_b128 v[40:43], v104 offset:2048
  ds_read_b128 v[96:99], v104 offset:6144
  ds_read_b128 v[72:75], v104 offset:10240
  ds_read_b128 v[44:47], v104 offset:3072
  ds_read_b128 v[100:103], v104 offset:7168
  ds_read_b128 v[76:79], v104 offset:11264
  s_mov_b64 s[12:13], s[60:61]
  s_mov_b32 s14, 2097152
  s_mov_b32 s15, 0x20000
  v_lshlrev_b32 v7, 10, v2
  v_lshl_add_u32 v7, v3, 4, v7
  v_pk_add_f32 v[16:17], v[16:17], v[48:49]
  v_pk_add_f32 v[18:19], v[18:19], v[50:51]
  v_pk_add_f32 v[20:21], v[20:21], v[52:53]
  v_pk_add_f32 v[22:23], v[22:23], v[54:55]
  v_pk_add_f32 v[24:25], v[24:25], v[56:57]
  v_pk_add_f32 v[26:27], v[26:27], v[58:59]
  v_pk_add_f32 v[28:29], v[28:29], v[60:61]
  v_pk_add_f32 v[30:31], v[30:31], v[62:63]
  s_waitcnt lgkmcnt(11)
  v_pk_add_f32 v[16:17], v[16:17], v[32:33]
  v_pk_add_f32 v[18:19], v[18:19], v[34:35]
  s_waitcnt lgkmcnt(10)
  v_pk_add_f32 v[16:17], v[16:17], v[88:89]
  v_pk_add_f32 v[18:19], v[18:19], v[90:91]
  s_waitcnt lgkmcnt(9)
  v_pk_add_f32 v[16:17], v[16:17], v[64:65]
  v_pk_add_f32 v[18:19], v[18:19], v[66:67]
  v_cvt_pk_bf16_f32 v80, v16, v17
  v_cvt_pk_bf16_f32 v81, v18, v19
  s_waitcnt lgkmcnt(8)
  v_pk_add_f32 v[20:21], v[20:21], v[36:37]
  v_pk_add_f32 v[22:23], v[22:23], v[38:39]
  s_waitcnt lgkmcnt(7)
  v_pk_add_f32 v[20:21], v[20:21], v[92:93]
  v_pk_add_f32 v[22:23], v[22:23], v[94:95]
  s_waitcnt lgkmcnt(6)
  v_pk_add_f32 v[20:21], v[20:21], v[68:69]
  v_pk_add_f32 v[22:23], v[22:23], v[70:71]
  v_cvt_pk_bf16_f32 v82, v20, v21
  v_cvt_pk_bf16_f32 v83, v22, v23
  s_nop 0
  v_permlane32_swap_b32 v80, v82
  v_permlane32_swap_b32 v81, v83
  buffer_store_dwordx4 v[80:83], v7, s[12:15], s57 offen offset:0
  s_waitcnt lgkmcnt(5)
  v_pk_add_f32 v[24:25], v[24:25], v[40:41]
  v_pk_add_f32 v[26:27], v[26:27], v[42:43]
  s_waitcnt lgkmcnt(4)
  v_pk_add_f32 v[24:25], v[24:25], v[96:97]
  v_pk_add_f32 v[26:27], v[26:27], v[98:99]
  s_waitcnt lgkmcnt(3)
  v_pk_add_f32 v[24:25], v[24:25], v[72:73]
  v_pk_add_f32 v[26:27], v[26:27], v[74:75]
  v_cvt_pk_bf16_f32 v84, v24, v25
  v_cvt_pk_bf16_f32 v85, v26, v27
  s_waitcnt lgkmcnt(2)
  v_pk_add_f32 v[28:29], v[28:29], v[44:45]
  v_pk_add_f32 v[30:31], v[30:31], v[46:47]
  s_waitcnt lgkmcnt(1)
  v_pk_add_f32 v[28:29], v[28:29], v[100:101]
  v_pk_add_f32 v[30:31], v[30:31], v[102:103]
  s_waitcnt lgkmcnt(0)
  v_pk_add_f32 v[28:29], v[28:29], v[76:77]
  v_pk_add_f32 v[30:31], v[30:31], v[78:79]
  v_cvt_pk_bf16_f32 v86, v28, v29
  v_cvt_pk_bf16_f32 v87, v30, v31
  s_nop 0
  v_permlane32_swap_b32 v84, v86
  v_permlane32_swap_b32 v85, v87
  buffer_store_dwordx4 v[84:87], v7, s[12:15], s57 offen offset:32
  s_endpgm
L_end:
  s_endpgm
.section .rodata,"a"
.p2align 6
.amdhsa_kernel interleave_layers__linear_attn_block__glu_gated_glu__prompt_kernel
  .amdhsa_next_free_vgpr 512
  .amdhsa_next_free_sgpr 102
  .amdhsa_accum_offset 256
  .amdhsa_group_segment_fixed_size 0
  .amdhsa_kernarg_size 80
  .amdhsa_user_sgpr_count 2
  .amdhsa_user_sgpr_kernarg_segment_ptr 1
  .amdhsa_system_sgpr_workgroup_id_x 1
  .amdhsa_float_denorm_mode_32 3
.end_amdhsa_kernel
```
